```python
import torch

def _softmax(x, axis=-1):
    return torch.softmax(x, dim=axis)
def _gelu(x):
    return torch.nn.functional.gelu(x, approximate="tanh")
def _silu(x):
    return torch.nn.functional.silu(x)
def _sigmoid(x):
    return torch.sigmoid(x)
def _layernorm(x, axis=-1, eps=1e-5):
    m = x.mean(dim=axis, keepdim=True)
    v = x.var(dim=axis, keepdim=True, unbiased=False)
    return (x - m) / torch.sqrt(v + eps)
def _scatter_add(tgt, idx, src, axis=0):
    return tgt.clone().index_add_(axis, idx, src)
def _segment_sum(src, seg, n):
    out = torch.zeros((n,) + src.shape[1:], dtype=src.dtype)
    return out.index_add_(0, seg, src)
def _pad(x, pw):
    flat = tuple(v for pair in reversed(pw) for v in pair)
    return torch.nn.functional.pad(x, flat)

kernel_name = 'standalone__mha_softmax__near_ridge'

def setup_inputs():

    _w = (lambda a: (lambda t: t.to(torch.bfloat16) if t.is_floating_point() else t)(torch.as_tensor(a)))
    B, H, Sq, Sk, D = 16, 16, 736, 512, 256
    return {
        "q": _w((lambda *s: torch.randn(*s, dtype=torch.bfloat16) * 0.8)(B, H, Sq, D)),
        "k": _w((lambda *s: torch.randn(*s, dtype=torch.bfloat16) * 0.8)(B, H, Sk, D)),
        "v": _w((lambda *s: torch.randn(*s, dtype=torch.bfloat16) * 0.05)(B, H, Sk, D)),
    }

def reference(q, k, v):
    scale = q.shape[-1] ** -0.5
    scores = torch.einsum("bhqd,bhkd->bhqk", q, k) * scale
    p = _softmax(scores, axis=-1)
    return torch.einsum("bhqk,bhkd->bhqd", p, v)
```

```asm
; @launch grid=(256,1,1) block=(256,1,1) lds=163840
.amdgcn_target "amdgcn-amd-amdhsa--gfx950"
.text
.globl standalone__mha_softmax__near_ridge_kernel
.p2align 8
.type standalone__mha_softmax__near_ridge_kernel,@function
standalone__mha_softmax__near_ridge_kernel:
  s_cmp_ge_u32 s2, 256
  s_cbranch_scc1 END
  s_load_dwordx2 s[4:5], s[0:1], 0
  s_load_dwordx2 s[8:9], s[0:1], 8
  s_load_dwordx2 s[12:13], s[0:1], 16
  s_load_dwordx2 s[16:17], s[0:1], 24
  s_and_b32 s43, s2, 7
  s_lshr_b32 s44, s2, 3
  v_lshrrev_b32 v1, 6, v0
  v_and_b32 v0, 63, v0
  s_nop 0
  v_readfirstlane_b32 s20, v1
  s_mov_b32 s6, 96468992
  s_mov_b32 s7, 0x20000
  s_mov_b32 s10, 67108864
  s_mov_b32 s11, 0x20000
  s_mov_b32 s14, 67108864
  s_mov_b32 s15, 0x20000
  s_mov_b32 s18, 96468992
  s_mov_b32 s19, 0x20000
  s_mov_b32 s22, 0x3db8aa3b
  s_mov_b32 s23, 0x43800000
  s_mov_b32 s27, 0x80000000
  s_lshl_b32 s21, s20, 12
  s_lshl_b32 s45, s20, 14
  s_add_u32 s45, s45, 98304
  s_add_u32 s59, s21, 81920
  s_add_u32 s95, s20, 1
  s_lshl_b32 s95, s95, 14
  s_cmp_eq_u32 s20, 2
  s_cselect_b32 s95, 65536, s95
  s_cmp_eq_u32 s20, 3
  s_cselect_b32 s95, 147456, s95
  s_mov_b32 s25, 0
  s_mov_b32 s26, 0
  s_mov_b32 s41, s27
  s_mov_b32 s42, s27
  s_lshl_b32 s46, s25, 5
  s_add_u32 s46, s46, s44
  s_mul_i32 s47, s46, 171
  s_lshr_b32 s47, s47, 9
  s_mul_i32 s48, s47, 3
  s_sub_u32 s48, s46, s48
  s_lshl_b32 s47, s47, 3
  s_add_u32 s47, s47, s43
  s_lshl_b32 s92, s47, 18
  s_and_b32 s93, s47, 15
  s_lshl_b32 s93, s93, 14
  s_add_u32 s93, s93, s21
  s_mul_i32 s49, s47, 376832
  s_lshl_b32 s50, s48, 17
  s_add_u32 s49, s49, s50
  s_add_u32 s58, s49, s21
  s_lshl_b32 s50, s20, 15
  s_add_u32 s39, s49, s50
  s_add_u32 s40, s39, 16384
  s_lshl_b32 s50, s48, 2
  s_add_u32 s50, s50, s20
  s_cmp_eq_u32 s50, 11
  s_cselect_b32 s40, s27, s40
  s_mov_b32 s98, 0xff800000
  s_cselect_b32 s98, 0x7149f2ca, s98
  s_add_u32 s99, s58, 114688
  s_cmp_eq_u32 s48, 2
  s_cselect_b32 s85, 3, 4
  s_cmp_eq_u32 s48, 2
  s_cselect_b32 s99, s27, s99
  s_cmp_ge_u32 s25, 3
  s_cselect_b32 s99, s27, s99
  s_cselect_b32 s39, s27, s39
  s_cselect_b32 s40, s27, s40
  s_cselect_b32 s92, s27, s92
  s_cselect_b32 s58, s27, s58
  s_mov_b32 s56, s58
  s_add_u32 s57, s21, 98304
  s_add_u32 s31, s93, 16384
  s_and_b32 s31, s31, 0x3ffff
  s_or_b32 s31, s31, s92
  s_add_u32 s32, s93, 32768
  s_and_b32 s32, s32, 0x3ffff
  s_or_b32 s32, s32, s92
  s_add_u32 s33, s93, 0
  s_and_b32 s33, s33, 0x3ffff
  s_or_b32 s33, s33, s92
  v_and_b32 v32, 31, v0
  v_lshrrev_b32 v33, 5, v0
  v_lshlrev_b32 v1, 4, v0
  v_add_u32 v34, 0, v33
  v_lshlrev_b32 v34, 2, v34
  s_lshl_b32 s46, s20, 1
  s_add_u32 s46, s46, 0
  s_and_b32 s46, s46, 3
  v_or_b32 v34, s46, v34
  v_xor_b32 v34, v34, v32
  v_lshlrev_b32 v34, 4, v34
  v_lshl_or_b32 v2, v33, 9, v34
  v_add_u32 v34, 2, v33
  v_lshlrev_b32 v34, 2, v34
  s_lshl_b32 s46, s20, 1
  s_add_u32 s46, s46, 0
  s_and_b32 s46, s46, 3
  v_or_b32 v34, s46, v34
  v_xor_b32 v34, v34, v32
  v_lshlrev_b32 v34, 4, v34
  v_lshl_or_b32 v3, v33, 9, v34
  v_add_u32 v34, 0, v33
  v_lshlrev_b32 v34, 2, v34
  s_lshl_b32 s46, s20, 1
  s_add_u32 s46, s46, 1
  s_and_b32 s46, s46, 3
  v_or_b32 v34, s46, v34
  v_xor_b32 v34, v34, v32
  v_lshlrev_b32 v34, 4, v34
  v_lshl_or_b32 v4, v33, 9, v34
  v_add_u32 v34, 2, v33
  v_lshlrev_b32 v34, 2, v34
  s_lshl_b32 s46, s20, 1
  s_add_u32 s46, s46, 1
  s_and_b32 s46, s46, 3
  v_or_b32 v34, s46, v34
  v_xor_b32 v34, v34, v32
  v_lshlrev_b32 v34, 4, v34
  v_lshl_or_b32 v5, v33, 9, v34
  v_and_b32 v36, 15, v0
  v_and_b32 v34, 3, v36
  v_lshlrev_b32 v34, 2, v34
  v_lshrrev_b32 v35, 2, v36
  v_or_b32 v34, v34, v35
  v_lshrrev_b32 v35, 4, v0
  v_lshlrev_b32 v35, 2, v35
  v_xor_b32 v34, v34, v35
  v_lshlrev_b32 v34, 4, v34
  v_lshl_or_b32 v34, v36, 9, v34
  v_xor_b32 v6, 0, v34
  v_xor_b32 v7, 16, v34
  v_xor_b32 v8, 32, v34
  v_xor_b32 v9, 48, v34
  s_mov_b32 s96, 0xffff0000
  s_mov_b32 s97, 0xffff0000
  v_bfe_u32 v34, v0, 4, 1
  v_bfe_u32 v35, v0, 2, 2
  v_and_b32 v36, 3, v0
  v_and_b32 v37, 1, v36
  v_lshl_or_b32 v37, v37, 1, v34
  v_lshlrev_b32 v38, 2, v35
  v_lshl_or_b32 v38, v33, 1, v38
  v_xor_b32 v37, v37, v38
  v_lshlrev_b32 v37, 4, v37
  v_lshrrev_b32 v36, 1, v36
  v_lshl_or_b32 v37, v36, 3, v37
  v_lshl_or_b32 v38, v33, 3, v35
  v_lshl_or_b32 v37, v38, 9, v37
  v_add_u32 v37, 49152, v37
  v_xor_b32 v14, 0, v37
  v_xor_b32 v15, 16, v37
  v_add_u32 v15, 2048, v15
  v_xor_b32 v16, 64, v37
  v_xor_b32 v17, 80, v37
  v_add_u32 v17, 2048, v17
  v_xor_b32 v18, 128, v37
  v_xor_b32 v19, 144, v37
  v_add_u32 v19, 2048, v19
  v_xor_b32 v20, 192, v37
  v_xor_b32 v21, 208, v37
  v_add_u32 v21, 2048, v21
  s_waitcnt lgkmcnt(0)
  s_add_u32 m0, s21, 0
  s_nop 0
  buffer_load_dwordx4 v2, s[8:11], s33 offen offset:0 lds
  buffer_load_dwordx4 v3, s[8:11], s33 offen offset:1024 lds
  buffer_load_dwordx4 v4, s[8:11], s33 offen offset:2048 lds
  buffer_load_dwordx4 v5, s[8:11], s33 offen offset:3072 lds
  s_add_u32 s46, s58, 0
  s_add_u32 m0, s21, 32768
  s_nop 0
  buffer_load_dwordx4 v2, s[4:7], s46 offen offset:0 lds
  buffer_load_dwordx4 v3, s[4:7], s46 offen offset:1024 lds
  buffer_load_dwordx4 v4, s[4:7], s46 offen offset:2048 lds
  buffer_load_dwordx4 v5, s[4:7], s46 offen offset:3072 lds
  s_add_u32 s47, s58, 32768
  s_add_u32 m0, s21, 49152
  s_nop 0
  buffer_load_dwordx4 v2, s[4:7], s47 offen offset:0 lds
  buffer_load_dwordx4 v3, s[4:7], s47 offen offset:1024 lds
  buffer_load_dwordx4 v4, s[4:7], s47 offen offset:2048 lds
  buffer_load_dwordx4 v5, s[4:7], s47 offen offset:3072 lds
  s_add_u32 s48, s58, 65536
  s_add_u32 m0, s21, 65536
  s_nop 0
  buffer_load_dwordx4 v2, s[4:7], s48 offen offset:0 lds
  buffer_load_dwordx4 v3, s[4:7], s48 offen offset:1024 lds
  buffer_load_dwordx4 v4, s[4:7], s48 offen offset:2048 lds
  buffer_load_dwordx4 v5, s[4:7], s48 offen offset:3072 lds
  s_add_u32 s49, s58, 98304
  s_add_u32 m0, s21, 81920
  s_nop 0
  buffer_load_dwordx4 v2, s[4:7], s49 offen offset:0 lds
  buffer_load_dwordx4 v3, s[4:7], s49 offen offset:1024 lds
  buffer_load_dwordx4 v4, s[4:7], s49 offen offset:2048 lds
  buffer_load_dwordx4 v5, s[4:7], s49 offen offset:3072 lds
  s_add_u32 s46, s58, 16384
  s_add_u32 m0, s21, 98304
  s_nop 0
  buffer_load_dwordx4 v2, s[4:7], s46 offen offset:0 lds
  buffer_load_dwordx4 v3, s[4:7], s46 offen offset:1024 lds
  buffer_load_dwordx4 v4, s[4:7], s46 offen offset:2048 lds
  buffer_load_dwordx4 v5, s[4:7], s46 offen offset:3072 lds
  s_add_u32 s47, s58, 49152
  s_add_u32 m0, s21, 114688
  s_nop 0
  buffer_load_dwordx4 v2, s[4:7], s47 offen offset:0 lds
  buffer_load_dwordx4 v3, s[4:7], s47 offen offset:1024 lds
  buffer_load_dwordx4 v4, s[4:7], s47 offen offset:2048 lds
  buffer_load_dwordx4 v5, s[4:7], s47 offen offset:3072 lds
  s_add_u32 s48, s58, 81920
  s_add_u32 m0, s21, 131072
  s_nop 0
  buffer_load_dwordx4 v2, s[4:7], s48 offen offset:0 lds
  buffer_load_dwordx4 v3, s[4:7], s48 offen offset:1024 lds
  buffer_load_dwordx4 v4, s[4:7], s48 offen offset:2048 lds
  buffer_load_dwordx4 v5, s[4:7], s48 offen offset:3072 lds
  s_add_u32 s49, s58, 114688
  s_add_u32 m0, s21, 147456
  s_nop 0
  buffer_load_dwordx4 v2, s[4:7], s99 offen offset:0 lds
  buffer_load_dwordx4 v3, s[4:7], s99 offen offset:1024 lds
  buffer_load_dwordx4 v4, s[4:7], s99 offen offset:2048 lds
  buffer_load_dwordx4 v5, s[4:7], s99 offen offset:3072 lds
  s_add_u32 m0, s21, 16384
  s_nop 0
  buffer_load_dwordx4 v2, s[8:11], s31 offen offset:0 lds
  buffer_load_dwordx4 v3, s[8:11], s31 offen offset:1024 lds
  buffer_load_dwordx4 v4, s[8:11], s31 offen offset:2048 lds
  buffer_load_dwordx4 v5, s[8:11], s31 offen offset:3072 lds
  v_mov_b32 v56, 0
  v_mov_b32 v57, 0
  v_mov_b32 v58, 0
  v_mov_b32 v59, 0
  s_nop 1
  v_mfma_f32_32x32x16_bf16 v[128:143], v[56:59], v[56:59], 0
  v_mfma_f32_32x32x16_bf16 v[144:159], v[56:59], v[56:59], 0
  v_mfma_f32_32x32x16_bf16 v[160:175], v[56:59], v[56:59], 0
  v_mfma_f32_32x32x16_bf16 v[176:191], v[56:59], v[56:59], 0
  v_mfma_f32_32x32x16_bf16 v[192:207], v[56:59], v[56:59], 0
  v_mfma_f32_32x32x16_bf16 v[208:223], v[56:59], v[56:59], 0
  v_mfma_f32_32x32x16_bf16 v[224:239], v[56:59], v[56:59], 0
  v_mfma_f32_32x32x16_bf16 v[240:255], v[56:59], v[56:59], 0
  v_mfma_f32_32x32x16_bf16 a[128:143], v[56:59], v[56:59], 0
  v_mfma_f32_32x32x16_bf16 a[144:159], v[56:59], v[56:59], 0
  v_mfma_f32_32x32x16_bf16 a[160:175], v[56:59], v[56:59], 0
  v_mfma_f32_32x32x16_bf16 a[176:191], v[56:59], v[56:59], 0
  v_mfma_f32_32x32x16_bf16 a[192:207], v[56:59], v[56:59], 0
  v_mfma_f32_32x32x16_bf16 a[208:223], v[56:59], v[56:59], 0
  v_mfma_f32_32x32x16_bf16 a[224:239], v[56:59], v[56:59], 0
  v_mfma_f32_32x32x16_bf16 a[240:255], v[56:59], v[56:59], 0
  s_add_u32 s50, s20, 2
  s_lshl_b32 s50, s50, 14
  s_waitcnt vmcnt(20)
  s_barrier
  v_add_u32 v112, s50, v6
  v_add_u32 v113, s50, v7
  v_add_u32 v114, s50, v8
  v_add_u32 v115, s50, v9
  ds_read_b128 a[0:3], v112 offset:0
  ds_read_b128 a[32:35], v112 offset:8192
  ds_read_b128 a[4:7], v113 offset:0
  ds_read_b128 a[36:39], v113 offset:8192
  ds_read_b128 a[8:11], v114 offset:0
  ds_read_b128 a[40:43], v114 offset:8192
  ds_read_b128 a[12:15], v115 offset:0
  ds_read_b128 a[44:47], v115 offset:8192
  ds_read_b128 a[16:19], v112 offset:256
  ds_read_b128 a[48:51], v112 offset:8448
  ds_read_b128 a[20:23], v113 offset:256
  ds_read_b128 a[52:55], v113 offset:8448
  ds_read_b128 a[24:27], v114 offset:256
  ds_read_b128 a[56:59], v114 offset:8448
  ds_read_b128 a[28:31], v115 offset:256
  ds_read_b128 a[60:63], v115 offset:8448
  s_waitcnt lgkmcnt(0)
  s_barrier
  ds_read_b128 v[32:35], v6 offset:0
  s_waitcnt lgkmcnt(0)
  v_mfma_f32_16x16x32_bf16 v[96:99], v[32:35], a[0:3], 0
  ds_read_b128 v[36:39], v6 offset:8192
  ds_read_b128 v[40:43], v7 offset:0
  v_mfma_f32_16x16x32_bf16 v[104:107], v[32:35], a[32:35], 0
  ds_read_b128 v[44:47], v7 offset:8192
  ds_read_b128 v[32:35], v8 offset:0
  s_waitcnt lgkmcnt(3)
  v_mfma_f32_16x16x32_bf16 v[100:103], v[36:39], a[0:3], 0
  s_add_u32 m0, s21, 49152
  s_nop 0
  buffer_load_dwordx4 v2, s[12:15], s33 offen offset:0 lds
  v_mfma_f32_16x16x32_bf16 v[108:111], v[36:39], a[32:35], 0
  ds_read_b128 v[36:39], v8 offset:8192
  v_add_u32 v112, s45, v6
  s_waitcnt lgkmcnt(3)
  v_mfma_f32_16x16x32_bf16 v[96:99], v[40:43], a[4:7], v[96:99]
  buffer_load_dwordx4 v3, s[12:15], s33 offen offset:1024 lds
  v_mfma_f32_16x16x32_bf16 v[104:107], v[40:43], a[36:39], v[104:107]
  ds_read_b128 v[40:43], v9 offset:0
  s_waitcnt vmcnt(6)
  s_barrier
  s_waitcnt lgkmcnt(3)
  v_mfma_f32_16x16x32_bf16 v[100:103], v[44:47], a[4:7], v[100:103]
  ds_read_b128 a[64:67], v112 offset:0
  ds_read_b128 a[96:99], v112 offset:8192
  v_mfma_f32_16x16x32_bf16 v[108:111], v[44:47], a[36:39], v[108:111]
  ds_read_b128 v[44:47], v9 offset:8192
  v_add_u32 v113, s45, v7
  s_waitcnt lgkmcnt(5)
  v_mfma_f32_16x16x32_bf16 v[96:99], v[32:35], a[8:11], v[96:99]
  buffer_load_dwordx4 v4, s[12:15], s33 offen offset:2048 lds
  v_mfma_f32_16x16x32_bf16 v[104:107], v[32:35], a[40:43], v[104:107]
  ds_read_b128 v[32:35], v6 offset:256
  ds_read_b128 a[68:71], v113 offset:0
  s_waitcnt lgkmcnt(6)
  v_mfma_f32_16x16x32_bf16 v[100:103], v[36:39], a[8:11], v[100:103]
  ds_read_b128 a[100:103], v113 offset:8192
  v_add_u32 v114, s45, v8
  v_mfma_f32_16x16x32_bf16 v[108:111], v[36:39], a[40:43], v[108:111]
  ds_read_b128 v[36:39], v6 offset:8448
  ds_read_b128 a[72:75], v114 offset:0
  s_waitcnt lgkmcnt(8)
  v_mfma_f32_16x16x32_bf16 v[96:99], v[40:43], a[12:15], v[96:99]
  buffer_load_dwordx4 v5, s[12:15], s33 offen offset:3072 lds
  v_mfma_f32_16x16x32_bf16 v[104:107], v[40:43], a[44:47], v[104:107]
  ds_read_b128 v[40:43], v7 offset:256
  ds_read_b128 a[104:107], v114 offset:8192
  s_waitcnt lgkmcnt(7)
  v_mfma_f32_16x16x32_bf16 v[100:103], v[44:47], a[12:15], v[100:103]
  v_add_u32 v115, s45, v9
  ds_read_b128 a[80:83], v112 offset:256
  v_mfma_f32_16x16x32_bf16 v[108:111], v[44:47], a[44:47], v[108:111]
  ds_read_b128 v[44:47], v7 offset:8448
  s_add_u32 m0, s21, 32768
  s_waitcnt lgkmcnt(8)
  v_mfma_f32_16x16x32_bf16 v[96:99], v[32:35], a[16:19], v[96:99]
  buffer_load_dwordx4 v2, s[8:11], s32 offen offset:0 lds
  v_mfma_f32_16x16x32_bf16 v[104:107], v[32:35], a[48:51], v[104:107]
  ds_read_b128 v[32:35], v8 offset:256
  ds_read_b128 a[76:79], v115 offset:0
  s_waitcnt lgkmcnt(7)
  v_mfma_f32_16x16x32_bf16 v[100:103], v[36:39], a[16:19], v[100:103]
  ds_read_b128 a[108:111], v115 offset:8192
  ds_read_b128 a[112:115], v112 offset:8448
  v_mfma_f32_16x16x32_bf16 v[108:111], v[36:39], a[48:51], v[108:111]
  ds_read_b128 v[36:39], v8 offset:8448
  ds_read_b128 a[84:87], v113 offset:256
  s_waitcnt lgkmcnt(9)
  v_mfma_f32_16x16x32_bf16 v[96:99], v[40:43], a[20:23], v[96:99]
  buffer_load_dwordx4 v3, s[8:11], s32 offen offset:1024 lds
  v_mfma_f32_16x16x32_bf16 v[104:107], v[40:43], a[52:55], v[104:107]
  ds_read_b128 v[40:43], v9 offset:256
  ds_read_b128 a[116:119], v113 offset:8448
  s_waitcnt lgkmcnt(8)
  v_mfma_f32_16x16x32_bf16 v[100:103], v[44:47], a[20:23], v[100:103]
  ds_read_b128 a[88:91], v114 offset:256
  ds_read_b128 a[120:123], v114 offset:8448
  v_mfma_f32_16x16x32_bf16 v[108:111], v[44:47], a[52:55], v[108:111]
  ds_read_b128 v[44:47], v9 offset:8448
  ds_read_b128 a[92:95], v115 offset:256
  s_waitcnt lgkmcnt(11)
  v_mfma_f32_16x16x32_bf16 v[96:99], v[32:35], a[24:27], v[96:99]
  buffer_load_dwordx4 v4, s[8:11], s32 offen offset:2048 lds
  v_mfma_f32_16x16x32_bf16 v[104:107], v[32:35], a[56:59], v[104:107]
  ds_read_b128 v[32:35], v6 offset:0
  ds_read_b128 a[124:127], v115 offset:8448
  s_waitcnt lgkmcnt(9)
  v_mfma_f32_16x16x32_bf16 v[100:103], v[36:39], a[24:27], v[100:103]
  s_mov_b32 s94, s92
  s_mov_b32 s78, s58
  v_mfma_f32_16x16x32_bf16 v[108:111], v[36:39], a[56:59], v[108:111]
  ds_read_b128 v[36:39], v6 offset:8192
  s_mov_b32 s41, s39
  s_waitcnt lgkmcnt(8)
  v_mfma_f32_16x16x32_bf16 v[96:99], v[40:43], a[28:31], v[96:99]
  buffer_load_dwordx4 v5, s[8:11], s32 offen offset:3072 lds
  v_mfma_f32_16x16x32_bf16 v[104:107], v[40:43], a[60:63], v[104:107]
  ds_read_b128 v[40:43], v7 offset:0
  s_mov_b32 s42, s40
  s_waitcnt lgkmcnt(5)
  v_mfma_f32_16x16x32_bf16 v[100:103], v[44:47], a[28:31], v[100:103]
  s_nop 1
  v_max3_f32 v29, v96, v97, v98
  s_mov_b32 s79, s85
  v_mfma_f32_16x16x32_bf16 v[108:111], v[44:47], a[60:63], v[108:111]
  ds_read_b128 v[44:47], v7 offset:8192
  s_add_u32 m0, s21, 65536
  s_waitcnt lgkmcnt(4)
  v_mfma_f32_16x16x32_bf16 v[80:83], v[32:35], a[64:67], 0
  buffer_load_dwordx4 v2, s[12:15], s31 offen offset:0 lds
  v_mfma_f32_16x16x32_bf16 v[88:91], v[32:35], a[96:99], 0
  ds_read_b128 v[32:35], v8 offset:0
  v_max3_f32 v24, v104, v105, v106
  s_waitcnt lgkmcnt(3)
  v_mfma_f32_16x16x32_bf16 v[84:87], v[36:39], a[64:67], 0
  v_max3_f32 v25, v107, v108, v109
  v_max3_f32 v24, v24, v110, v111
  v_mfma_f32_16x16x32_bf16 v[92:95], v[36:39], a[96:99], 0
  ds_read_b128 v[36:39], v8 offset:8192
  s_add_u32 s51, s93, 49152
  s_waitcnt lgkmcnt(3)
  v_mfma_f32_16x16x32_bf16 v[80:83], v[40:43], a[68:71], v[80:83]
  buffer_load_dwordx4 v3, s[12:15], s31 offen offset:1024 lds
  v_mfma_f32_16x16x32_bf16 v[88:91], v[40:43], a[100:103], v[88:91]
  ds_read_b128 v[40:43], v9 offset:0
  v_max_f32 v24, v24, v25
  s_waitcnt lgkmcnt(3)
  v_mfma_f32_16x16x32_bf16 v[84:87], v[44:47], a[68:71], v[84:87]
  s_and_b32 s51, s51, 0x3ffff
  v_mov_b32 v25, v24
  v_mfma_f32_16x16x32_bf16 v[92:95], v[44:47], a[100:103], v[92:95]
  ds_read_b128 v[44:47], v9 offset:8192
  s_or_b32 s51, s51, s92
  s_waitcnt lgkmcnt(3)
  v_mfma_f32_16x16x32_bf16 v[80:83], v[32:35], a[72:75], v[80:83]
  buffer_load_dwordx4 v4, s[12:15], s31 offen offset:2048 lds
  v_mfma_f32_16x16x32_bf16 v[88:91], v[32:35], a[104:107], v[88:91]
  ds_read_b128 v[32:35], v6 offset:256
  v_permlane32_swap_b32 v24, v25
  s_waitcnt lgkmcnt(3)
  v_mfma_f32_16x16x32_bf16 v[84:87], v[36:39], a[72:75], v[84:87]
  v_max_f32 v24, v24, v25
  v_max3_f32 v0, v99, v100, v101
  v_mfma_f32_16x16x32_bf16 v[92:95], v[36:39], a[104:107], v[92:95]
  ds_read_b128 v[36:39], v6 offset:8448
  v_mov_b32 v25, v24
  s_waitcnt lgkmcnt(3)
  v_mfma_f32_16x16x32_bf16 v[80:83], v[40:43], a[76:79], v[80:83]
  buffer_load_dwordx4 v5, s[12:15], s31 offen offset:3072 lds
  v_mfma_f32_16x16x32_bf16 v[88:91], v[40:43], a[108:111], v[88:91]
  ds_read_b128 v[40:43], v7 offset:256
  s_add_u32 m0, s21, 0
  s_waitcnt lgkmcnt(3)
  v_mfma_f32_16x16x32_bf16 v[84:87], v[44:47], a[76:79], v[84:87]
  s_add_u32 s28, s93, 65536
  s_and_b32 s28, s28, 0x3ffff
  v_mfma_f32_16x16x32_bf16 v[92:95], v[44:47], a[108:111], v[92:95]
  s_or_b32 s28, s28, s92
  s_add_u32 s34, s93, 32768
  s_waitcnt lgkmcnt(2)
  v_mfma_f32_16x16x32_bf16 v[80:83], v[32:35], a[80:83], v[80:83]
  ds_read_b128 v[44:47], v7 offset:8448
  s_and_b32 s34, s34, 0x3ffff
  v_mfma_f32_16x16x32_bf16 v[88:91], v[32:35], a[112:115], v[88:91]
  s_or_b32 s34, s34, s92
  v_permlane16_swap_b32 v24, v25
  s_waitcnt lgkmcnt(2)
  v_mfma_f32_16x16x32_bf16 v[84:87], v[36:39], a[80:83], v[84:87]
  s_add_u32 s29, s93, 81920
  v_max3_f32 v29, v29, v102, v103
  v_mfma_f32_16x16x32_bf16 v[92:95], v[36:39], a[112:115], v[92:95]
  s_and_b32 s29, s29, 0x3ffff
  v_max_f32 v24, v24, v25
  s_waitcnt lgkmcnt(1)
  v_mfma_f32_16x16x32_bf16 v[80:83], v[40:43], a[84:87], v[80:83]
  ds_read_b128 v[32:35], v8 offset:256
  v_max_f32 v29, v29, v0
  v_mfma_f32_16x16x32_bf16 v[88:91], v[40:43], a[116:119], v[88:91]
  s_or_b32 s29, s29, s92
  s_add_u32 s35, s93, 49152
  s_waitcnt lgkmcnt(1)
  v_mfma_f32_16x16x32_bf16 v[84:87], v[44:47], a[84:87], v[84:87]
  v_mul_f32 v11, s22, v24
  v_mov_b32 v0, v29
  v_mfma_f32_16x16x32_bf16 v[92:95], v[44:47], a[116:119], v[92:95]
  s_and_b32 s35, s35, 0x3ffff
  s_or_b32 s35, s35, s92
  s_waitcnt lgkmcnt(0)
  v_mfma_f32_16x16x32_bf16 v[80:83], v[32:35], a[88:91], v[80:83]
  v_permlane32_swap_b32 v29, v0
  s_add_u32 s30, s93, 98304
  v_mfma_f32_16x16x32_bf16 v[88:91], v[32:35], a[120:123], v[88:91]
  ds_read_b128 v[36:39], v8 offset:8448
  s_and_b32 s30, s30, 0x3ffff
  s_waitcnt lgkmcnt(0)
  v_mfma_f32_16x16x32_bf16 v[84:87], v[36:39], a[88:91], v[84:87]
  v_max_f32 v29, v29, v0
  s_or_b32 s30, s30, s92
  v_mfma_f32_16x16x32_bf16 v[92:95], v[36:39], a[120:123], v[92:95]
  s_add_u32 s36, s93, 65536
  v_mov_b32 v0, v29
  ds_read_b128 v[40:43], v9 offset:256
  s_waitcnt lgkmcnt(0)
  v_mfma_f32_16x16x32_bf16 v[80:83], v[40:43], a[92:95], v[80:83]
  s_and_b32 s36, s36, 0x3ffff
  v_permlane16_swap_b32 v29, v0
  v_mfma_f32_16x16x32_bf16 v[88:91], v[40:43], a[124:127], v[88:91]
  s_or_b32 s36, s36, s92
  s_add_u32 s25, s25, 1
  ds_read_b128 v[44:47], v9 offset:8448
  s_waitcnt lgkmcnt(0)
  v_mfma_f32_16x16x32_bf16 v[84:87], v[44:47], a[92:95], v[84:87]
  v_max_f32 v29, v29, v0
  s_lshl_b32 s46, s25, 5
  v_mfma_f32_16x16x32_bf16 v[92:95], v[44:47], a[124:127], v[92:95]
  v_max3_f32 v24, v88, v89, v90
  s_add_u32 s46, s46, s44
  v_mul_f32 v10, s22, v29
  v_max3_f32 v29, v80, v81, v82
  s_mul_i32 s47, s46, 171
  s_lshr_b32 s47, s47, 9
  v_max3_f32 v0, v83, v84, v85
  v_max3_f32 v29, v29, v86, v87
  v_max3_f32 v25, v91, v92, v93
  v_max3_f32 v24, v24, v94, v95
  s_mul_i32 s48, s47, 3
  v_max_f32 v24, v24, v25
  v_max_f32 v29, v29, v0
  v_mov_b32 v25, v24
  v_fma_f32 v96, v96, s22, -v10
  s_nop 0
  v_permlane32_swap_b32 v24, v25
  v_fma_f32 v97, v97, s22, -v10
  v_max_f32 v24, v24, v25
  s_sub_u32 s48, s46, s48
  v_mov_b32 v25, v24
  s_lshl_b32 s47, s47, 3
  s_nop 0
  v_permlane16_swap_b32 v24, v25
  v_mov_b32 v0, v29
  v_max_f32 v24, v24, v25
  v_exp_f32 v56, v96
  v_mul_f32 v13, s22, v24
  v_exp_f32 v24, v97
  v_fma_f32 v98, v98, s22, -v10
  s_add_u32 s47, s47, s43
  s_lshl_b32 s92, s47, 18
  v_permlane32_swap_b32 v29, v0
  v_exp_f32 v57, v98
  v_fma_f32 v99, v99, s22, -v10
  s_and_b32 s93, s47, 15
  s_lshl_b32 s93, s93, 14
  v_max_f32 v29, v29, v0
  v_exp_f32 v25, v99
  v_fma_f32 v100, v100, s22, -v10
  s_add_u32 s93, s93, s21
  v_add_f32 v31, v56, v24
  s_mul_i32 s49, s47, 376832
  s_lshl_b32 s50, s48, 17
  v_mov_b32 v0, v29
  v_exp_f32 v60, v100
  v_fma_f32 v101, v101, s22, -v10
  s_add_u32 s49, s49, s50
  v_cvt_pk_bf16_f32 v56, v56, v24
  v_add_f32 v31, v31, v57
  v_permlane16_swap_b32 v29, v0
  v_exp_f32 v24, v101
  v_fma_f32 v102, v102, s22, -v10
  s_add_u32 s58, s49, s21
  s_lshl_b32 s50, s20, 15
  v_add_f32 v31, v31, v25
  v_max_f32 v29, v29, v0
  v_exp_f32 v61, v102
  v_fma_f32 v103, v103, s22, -v10
  s_add_u32 s39, s49, s50
  v_cvt_pk_bf16_f32 v57, v57, v25
  v_add_f32 v31, v31, v60
  s_add_u32 s40, s39, 16384
  v_mul_f32 v12, s22, v29
  v_exp_f32 v25, v103
  v_fma_f32 v104, v104, s22, -v11
  v_fma_f32 v105, v105, s22, -v11
  s_lshl_b32 s50, s48, 2
  v_add_f32 v31, v31, v24
  v_cvt_pk_bf16_f32 v60, v60, v24
  s_add_u32 s50, s50, s20
  v_max_f32 v12, s98, v12
  v_max_f32 v13, s98, v13
  v_exp_f32 v58, v104
  v_exp_f32 v24, v105
  v_fma_f32 v106, v106, s22, -v11
  s_cmp_eq_u32 s50, 11
  s_mov_b32 s98, 0xff800000
  v_add_f32 v31, v31, v61
  v_exp_f32 v59, v106
  v_fma_f32 v107, v107, s22, -v11
  s_cselect_b32 s40, s27, s40
  s_cselect_b32 s98, 0x7149f2ca, s98
  s_add_u32 s99, s58, 114688
  v_add_f32 v31, v31, v25
  v_cvt_pk_bf16_f32 v61, v61, v25
  s_cmp_eq_u32 s48, 2
  v_exp_f32 v25, v107
  v_fma_f32 v108, v108, s22, -v11
  s_cselect_b32 s85, 3, 4
  v_add_f32 v0, v58, v24
  s_cmp_eq_u32 s48, 2
  v_exp_f32 v62, v108
  v_fma_f32 v109, v109, s22, -v11
  s_cselect_b32 s99, s27, s99
  v_cvt_pk_bf16_f32 v58, v58, v24
  v_add_f32 v0, v0, v59
  s_cmp_ge_u32 s25, 3
  v_exp_f32 v24, v109
  v_fma_f32 v110, v110, s22, -v11
  s_cselect_b32 s99, s27, s99
  s_cselect_b32 s39, s27, s39
  s_cselect_b32 s40, s27, s40
  s_cselect_b32 s92, s27, s92
  s_cselect_b32 s58, s27, s58
  v_add_f32 v0, v0, v25
  s_add_u32 s57, s21, 98304
  v_exp_f32 v63, v110
  v_fma_f32 v111, v111, s22, -v11
  s_add_u32 s31, s93, 16384
  v_cvt_pk_bf16_f32 v59, v59, v25
  v_add_f32 v0, v0, v62
  s_and_b32 s31, s31, 0x3ffff
  v_exp_f32 v25, v111
  s_or_b32 s31, s31, s92
  v_add_f32 v0, v0, v24
  s_add_u32 s32, s93, 32768
  s_waitcnt vmcnt(12)
  s_barrier
  s_and_b32 s32, s32, 0x3ffff
  v_add_f32 v0, v0, v63
  buffer_load_dwordx4 v2, s[8:11], s51 offen offset:0 lds
  s_or_b32 s32, s32, s92
  buffer_load_dwordx4 v3, s[8:11], s51 offen offset:1024 lds
  s_add_u32 s33, s93, 0
  v_mov_b32 v26, 0
  v_mov_b32 v27, 0
  v_cvt_pk_bf16_f32 v62, v62, v24
  v_add_f32 v0, v0, v25
  v_cvt_pk_bf16_f32 v63, v63, v25
  buffer_load_dwordx4 v4, s[8:11], s51 offen offset:2048 lds
  s_and_b32 s33, s33, 0x3ffff
  v_mov_b32 v22, 0
  v_mov_b32 v23, 0
  v_permlane16_swap_b32 v56, v58
  v_permlane16_swap_b32 v57, v59
  v_permlane16_swap_b32 v60, v62
  v_permlane16_swap_b32 v61, v63
  v_add_f32 v26, v26, v31
  v_add_f32 v27, v27, v0
  buffer_load_dwordx4 v5, s[8:11], s51 offen offset:3072 lds
  s_mov_b32 s77, 0
  s_mov_b32 s76, 0
  s_mov_b32 s24, 0
  s_mov_b32 s26, 0
  s_mov_b32 s56, s58
  s_or_b32 s33, s33, s92
  ds_read_b128 v[32:35], v6 offset:16384
  ds_read_b128 v[36:39], v6 offset:24576
  ds_read_b128 v[40:43], v7 offset:16384
  ds_read_b128 v[44:47], v7 offset:24576
  s_branch LOOP
MREG:
  v_mov_b32 v56, 0
  v_mov_b32 v57, 0
  v_mov_b32 v58, 0
  v_mov_b32 v59, 0
  v_mul_f32 v128, v128, v28
  v_mul_f32 v129, v129, v28
  v_mul_f32 v130, v130, v28
  v_mul_f32 v131, v131, v28
  v_mul_f32 v132, v132, v28
  v_mul_f32 v133, v133, v28
  v_mul_f32 v134, v134, v28
  v_mul_f32 v135, v135, v28
  v_mul_f32 v136, v136, v28
  v_mul_f32 v137, v137, v28
  v_mul_f32 v138, v138, v28
  v_mul_f32 v139, v139, v28
  v_mul_f32 v140, v140, v28
  v_mul_f32 v141, v141, v28
  v_mul_f32 v142, v142, v28
  v_mul_f32 v143, v143, v28
  v_cvt_pk_bf16_f32 v64, v128, v129
  v_cvt_pk_bf16_f32 v65, v130, v131
  v_cvt_pk_bf16_f32 v66, v132, v133
  v_cvt_pk_bf16_f32 v67, v134, v135
  v_cvt_pk_bf16_f32 v68, v136, v137
  v_cvt_pk_bf16_f32 v69, v138, v139
  v_cvt_pk_bf16_f32 v70, v140, v141
  v_cvt_pk_bf16_f32 v71, v142, v143
  v_mfma_f32_32x32x16_bf16 v[128:143], v[56:59], v[56:59], 0
  v_bfe_u32 v76, v1, 4, 5
  v_lshrrev_b32 v77, 9, v1
  v_and_b32 v79, 3, v76
  v_bfe_u32 v60, v76, 2, 2
  v_lshlrev_b32 v79, 2, v79
  v_and_b32 v72, 7, v76
  v_mul_f32 v144, v144, v28
  v_mul_f32 v145, v145, v28
  v_mul_f32 v146, v146, v28
  v_mul_f32 v147, v147, v28
  v_mul_f32 v148, v148, v28
  v_mul_f32 v149, v149, v28
  v_mul_f32 v150, v150, v28
  v_mul_f32 v151, v151, v28
  v_mul_f32 v152, v152, v28
  v_mul_f32 v153, v153, v28
  v_mul_f32 v154, v154, v28
  v_mul_f32 v155, v155, v28
  v_mul_f32 v156, v156, v28
  v_mul_f32 v157, v157, v28
  v_mul_f32 v158, v158, v28
  v_mul_f32 v159, v159, v28
  v_or_b32 v79, v79, v60
  v_lshlrev_b32 v60, 1, v77
  v_lshlrev_b32 v77, 1, v77
  v_xor_b32 v72, v72, v77
  v_lshlrev_b32 v72, 4, v72
  v_lshl_or_b32 v72, v76, 7, v72
  v_add_u32 v72, s59, v72
  ds_write_b128 v72, v[64:67]
  s_nop 1
  v_cvt_pk_bf16_f32 v64, v144, v145
  v_cvt_pk_bf16_f32 v65, v146, v147
  v_cvt_pk_bf16_f32 v66, v148, v149
  v_cvt_pk_bf16_f32 v67, v150, v151
  v_xor_b32 v73, 16, v72
  ds_write_b128 v73, v[68:71]
  s_nop 1
  v_cvt_pk_bf16_f32 v68, v152, v153
  v_cvt_pk_bf16_f32 v69, v154, v155
  v_cvt_pk_bf16_f32 v70, v156, v157
  v_cvt_pk_bf16_f32 v71, v158, v159
  v_mfma_f32_32x32x16_bf16 v[144:159], v[56:59], v[56:59], 0
  v_xor_b32 v79, v79, v60
  v_lshrrev_b32 v78, 4, v1
  v_lshlrev_b32 v79, 4, v79
  v_and_b32 v77, 7, v78
  v_lshl_or_b32 v79, v76, 9, v79
  v_lshrrev_b32 v76, 3, v78
  v_mul_f32 v160, v160, v28
  v_mul_f32 v161, v161, v28
  v_mul_f32 v162, v162, v28
  v_mul_f32 v163, v163, v28
  v_mul_f32 v164, v164, v28
  v_mul_f32 v165, v165, v28
  v_mul_f32 v166, v166, v28
  v_mul_f32 v167, v167, v28
  v_mul_f32 v168, v168, v28
  v_mul_f32 v169, v169, v28
  v_mul_f32 v170, v170, v28
  v_mul_f32 v171, v171, v28
  v_mul_f32 v172, v172, v28
  v_mul_f32 v173, v173, v28
  v_mul_f32 v174, v174, v28
  v_mul_f32 v175, v175, v28
  v_xor_b32 v74, 64, v72
  ds_write_b128 v74, v[64:67]
  s_nop 1
  v_cvt_pk_bf16_f32 v64, v160, v161
  v_cvt_pk_bf16_f32 v65, v162, v163
  v_cvt_pk_bf16_f32 v66, v164, v165
  v_cvt_pk_bf16_f32 v67, v166, v167
  v_xor_b32 v75, 0x50, v72
  ds_write_b128 v75, v[68:71]
  s_nop 1
  v_cvt_pk_bf16_f32 v68, v168, v169
  v_cvt_pk_bf16_f32 v69, v170, v171
  v_cvt_pk_bf16_f32 v70, v172, v173
  v_cvt_pk_bf16_f32 v71, v174, v175
  v_mfma_f32_32x32x16_bf16 v[160:175], v[56:59], v[56:59], 0
  v_xor_b32 v77, v76, v77
  v_lshlrev_b32 v78, 4, v78
  v_lshlrev_b32 v77, 4, v77
  s_add_u32 s52, s41, 0
  v_lshl_or_b32 v77, v76, 9, v77
  v_add_u32 v76, s59, v78
  v_mul_f32 v176, v176, v28
  v_mul_f32 v177, v177, v28
  v_mul_f32 v178, v178, v28
  v_mul_f32 v179, v179, v28
  v_mul_f32 v180, v180, v28
  v_mul_f32 v181, v181, v28
  v_mul_f32 v182, v182, v28
  v_mul_f32 v183, v183, v28
  v_mul_f32 v184, v184, v28
  v_mul_f32 v185, v185, v28
  v_mul_f32 v186, v186, v28
  v_mul_f32 v187, v187, v28
  v_mul_f32 v188, v188, v28
  v_mul_f32 v189, v189, v28
  v_mul_f32 v190, v190, v28
  v_mul_f32 v191, v191, v28
  ds_read_b128 v[48:51], v76 offset:0
  ds_read_b128 v[52:55], v76 offset:1024
  ds_read_b128 v[60:63], v76 offset:2048
  s_waitcnt lgkmcnt(0)
  s_barrier
  s_add_u32 s53, s41, 4096
  s_add_u32 s54, s41, 8192
  s_add_u32 s55, s41, 12288
  s_add_u32 m0, s21, 16384
  s_nop 0
  buffer_load_dwordx4 v2, s[8:11], s31 offen offset:0 lds
  buffer_load_dwordx4 v3, s[8:11], s31 offen offset:1024 lds
  buffer_load_dwordx4 v4, s[8:11], s31 offen offset:2048 lds
  buffer_load_dwordx4 v5, s[8:11], s31 offen offset:3072 lds
  buffer_store_dwordx4 v[48:51], v77, s[16:19], s52 offen offset:0
  s_nop 1
  ds_read_b128 v[48:51], v76 offset:3072
  ds_write_b128 v72, v[64:67]
  s_nop 1
  v_cvt_pk_bf16_f32 v64, v176, v177
  v_cvt_pk_bf16_f32 v65, v178, v179
  v_cvt_pk_bf16_f32 v66, v180, v181
  v_cvt_pk_bf16_f32 v67, v182, v183
  ds_write_b128 v73, v[68:71]
  s_nop 1
  v_cvt_pk_bf16_f32 v68, v184, v185
  v_cvt_pk_bf16_f32 v69, v186, v187
  v_cvt_pk_bf16_f32 v70, v188, v189
  v_cvt_pk_bf16_f32 v71, v190, v191
  v_mfma_f32_32x32x16_bf16 v[176:191], v[56:59], v[56:59], 0
  ds_write_b128 v74, v[64:67]
  ds_write_b128 v75, v[68:71]
  v_mul_f32 v192, v192, v28
  v_mul_f32 v193, v193, v28
  buffer_store_dwordx4 v[52:55], v77, s[16:19], s53 offen offset:0
  s_nop 1
  ds_read_b128 v[52:55], v76 offset:0
  v_mul_f32 v194, v194, v28
  v_mul_f32 v195, v195, v28
  v_mul_f32 v196, v196, v28
  v_mul_f32 v197, v197, v28
  v_mul_f32 v198, v198, v28
  v_mul_f32 v199, v199, v28
  v_mul_f32 v200, v200, v28
  v_mul_f32 v201, v201, v28
  v_mul_f32 v202, v202, v28
  v_mul_f32 v203, v203, v28
  v_mul_f32 v204, v204, v28
  v_mul_f32 v205, v205, v28
  v_mul_f32 v206, v206, v28
  v_mul_f32 v207, v207, v28
  v_cvt_pk_bf16_f32 v64, v192, v193
  v_cvt_pk_bf16_f32 v65, v194, v195
  v_cvt_pk_bf16_f32 v66, v196, v197
  v_cvt_pk_bf16_f32 v67, v198, v199
  v_cvt_pk_bf16_f32 v68, v200, v201
  v_cvt_pk_bf16_f32 v69, v202, v203
  v_cvt_pk_bf16_f32 v70, v204, v205
  v_cvt_pk_bf16_f32 v71, v206, v207
  v_mfma_f32_32x32x16_bf16 v[192:207], v[56:59], v[56:59], 0
  buffer_store_dwordx4 v[60:63], v77, s[16:19], s54 offen offset:0
  s_nop 1
  ds_read_b128 v[60:63], v76 offset:1024
  s_waitcnt lgkmcnt(6)
  buffer_store_dwordx4 v[48:51], v77, s[16:19], s55 offen offset:0
  s_nop 1
  ds_read_b128 v[48:51], v76 offset:2048
  v_mul_f32 v208, v208, v28
  v_mul_f32 v209, v209, v28
  v_mul_f32 v210, v210, v28
  v_mul_f32 v211, v211, v28
  v_mul_f32 v212, v212, v28
  v_mul_f32 v213, v213, v28
  v_mul_f32 v214, v214, v28
  v_mul_f32 v215, v215, v28
  v_mul_f32 v216, v216, v28
  v_mul_f32 v217, v217, v28
  v_mul_f32 v218, v218, v28
  v_mul_f32 v219, v219, v28
  v_mul_f32 v220, v220, v28
  v_mul_f32 v221, v221, v28
  v_mul_f32 v222, v222, v28
  v_mul_f32 v223, v223, v28
  s_waitcnt lgkmcnt(2)
  buffer_store_dwordx4 v[52:55], v77, s[16:19], s52 offen offset:128
  s_nop 1
  ds_read_b128 v[52:55], v76 offset:3072
  ds_write_b128 v72, v[64:67]
  s_nop 1
  v_cvt_pk_bf16_f32 v64, v208, v209
  v_cvt_pk_bf16_f32 v65, v210, v211
  v_cvt_pk_bf16_f32 v66, v212, v213
  v_cvt_pk_bf16_f32 v67, v214, v215
  ds_write_b128 v73, v[68:71]
  s_nop 1
  v_cvt_pk_bf16_f32 v68, v216, v217
  v_cvt_pk_bf16_f32 v69, v218, v219
  v_cvt_pk_bf16_f32 v70, v220, v221
  v_cvt_pk_bf16_f32 v71, v222, v223
  v_mfma_f32_32x32x16_bf16 v[208:223], v[56:59], v[56:59], 0
  ds_write_b128 v74, v[64:67]
  ds_write_b128 v75, v[68:71]
  s_waitcnt lgkmcnt(6)
  buffer_store_dwordx4 v[60:63], v77, s[16:19], s53 offen offset:128
  s_nop 1
  ds_read_b128 v[60:63], v76 offset:0
  s_waitcnt lgkmcnt(6)
  buffer_store_dwordx4 v[48:51], v77, s[16:19], s54 offen offset:128
  s_nop 1
  ds_read_b128 v[48:51], v76 offset:1024
  v_mul_f32 v224, v224, v28
  v_mul_f32 v225, v225, v28
  v_mul_f32 v226, v226, v28
  v_mul_f32 v227, v227, v28
  v_mul_f32 v228, v228, v28
  v_mul_f32 v229, v229, v28
  v_mul_f32 v230, v230, v28
  v_mul_f32 v231, v231, v28
  v_mul_f32 v232, v232, v28
  v_mul_f32 v233, v233, v28
  v_mul_f32 v234, v234, v28
  v_mul_f32 v235, v235, v28
  v_mul_f32 v236, v236, v28
  v_mul_f32 v237, v237, v28
  v_mul_f32 v238, v238, v28
  v_mul_f32 v239, v239, v28
  v_cvt_pk_bf16_f32 v64, v224, v225
  v_cvt_pk_bf16_f32 v65, v226, v227
  v_cvt_pk_bf16_f32 v66, v228, v229
  v_cvt_pk_bf16_f32 v67, v230, v231
  v_cvt_pk_bf16_f32 v68, v232, v233
  v_cvt_pk_bf16_f32 v69, v234, v235
  v_cvt_pk_bf16_f32 v70, v236, v237
  v_cvt_pk_bf16_f32 v71, v238, v239
  v_mfma_f32_32x32x16_bf16 v[224:239], v[56:59], v[56:59], 0
  s_add_u32 m0, s21, 49152
  s_waitcnt lgkmcnt(6)
  buffer_store_dwordx4 v[52:55], v77, s[16:19], s55 offen offset:128
  buffer_load_dwordx4 v2, s[12:15], s33 offen offset:0 lds
  buffer_load_dwordx4 v3, s[12:15], s33 offen offset:1024 lds
  v_mul_f32 v240, v240, v28
  v_mul_f32 v241, v241, v28
  v_mul_f32 v242, v242, v28
  v_mul_f32 v243, v243, v28
  v_mul_f32 v244, v244, v28
  v_mul_f32 v245, v245, v28
  v_mul_f32 v246, v246, v28
  v_mul_f32 v247, v247, v28
  v_mul_f32 v248, v248, v28
  v_mul_f32 v249, v249, v28
  v_mul_f32 v250, v250, v28
  v_mul_f32 v251, v251, v28
  v_mul_f32 v252, v252, v28
  v_mul_f32 v253, v253, v28
  v_mul_f32 v254, v254, v28
  v_mul_f32 v255, v255, v28
  ds_read_b128 v[52:55], v76 offset:2048
  buffer_load_dwordx4 v4, s[12:15], s33 offen offset:2048 lds
  buffer_load_dwordx4 v5, s[12:15], s33 offen offset:3072 lds
  s_waitcnt lgkmcnt(2)
  buffer_store_dwordx4 v[60:63], v77, s[16:19], s52 offen offset:256
  s_nop 1
  ds_read_b128 v[60:63], v76 offset:3072
  ds_write_b128 v72, v[64:67]
  s_nop 1
  v_cvt_pk_bf16_f32 v64, v240, v241
  v_cvt_pk_bf16_f32 v65, v242, v243
  v_cvt_pk_bf16_f32 v66, v244, v245
  v_cvt_pk_bf16_f32 v67, v246, v247
  ds_write_b128 v73, v[68:71]
  s_nop 1
  v_cvt_pk_bf16_f32 v68, v248, v249
  v_cvt_pk_bf16_f32 v69, v250, v251
  v_cvt_pk_bf16_f32 v70, v252, v253
  v_cvt_pk_bf16_f32 v71, v254, v255
  v_mfma_f32_32x32x16_bf16 v[240:255], v[56:59], v[56:59], 0
  ds_write_b128 v74, v[64:67]
  ds_write_b128 v75, v[68:71]
  s_waitcnt lgkmcnt(6)
  buffer_store_dwordx4 v[48:51], v77, s[16:19], s53 offen offset:256
  s_nop 1
  ds_read_b128 v[48:51], v76 offset:0
  s_waitcnt vmcnt(18)
  s_barrier
  ds_read_b128 v[32:35], v6 offset:0
  s_waitcnt lgkmcnt(0)
  v_mfma_f32_16x16x32_bf16 v[96:99], v[32:35], a[0:3], 0
  ds_read_b128 v[36:39], v6 offset:8192
  ds_read_b128 v[40:43], v7 offset:0
  v_mfma_f32_16x16x32_bf16 v[104:107], v[32:35], a[32:35], 0
  ds_read_b128 v[44:47], v7 offset:8192
  ds_read_b128 v[32:35], v8 offset:0
  s_waitcnt lgkmcnt(3)
  v_mfma_f32_16x16x32_bf16 v[100:103], v[36:39], a[0:3], 0
  buffer_store_dwordx4 v[52:55], v77, s[16:19], s54 offen offset:256
  s_nop 1
  ds_read_b128 v[52:55], v76 offset:1024
  v_mfma_f32_16x16x32_bf16 v[108:111], v[36:39], a[32:35], 0
  buffer_store_dwordx4 v[60:63], v77, s[16:19], s55 offen offset:256
  s_nop 1
  ds_read_b128 v[60:63], v76 offset:2048
  buffer_store_dwordx4 v[48:51], v77, s[16:19], s52 offen offset:384
  s_waitcnt lgkmcnt(1)
  buffer_store_dwordx4 v[52:55], v77, s[16:19], s53 offen offset:384
  s_waitcnt lgkmcnt(0)
  buffer_store_dwordx4 v[60:63], v77, s[16:19], s54 offen offset:384
  ds_read_b128 v[48:51], v76 offset:3072
  s_waitcnt lgkmcnt(0)
  buffer_store_dwordx4 v[48:51], v77, s[16:19], s55 offen offset:384
  s_add_u32 s52, s42, 0
  s_add_u32 s53, s42, 4096
  s_add_u32 s54, s42, 8192
  s_add_u32 s55, s42, 12288
  s_cmp_lg_u32 s20, 3
  s_cbranch_scc1 SKQB
  v_add_u32 v112, s45, v6
  v_add_u32 v113, s45, v7
  v_add_u32 v114, s45, v8
  v_add_u32 v115, s45, v9
  ds_read_b128 a[64:67], v112 offset:0
  ds_read_b128 a[96:99], v112 offset:8192
  ds_read_b128 a[68:71], v113 offset:0
  ds_read_b128 a[100:103], v113 offset:8192
  ds_read_b128 a[72:75], v114 offset:0
  ds_read_b128 a[104:107], v114 offset:8192
  ds_read_b128 a[76:79], v115 offset:0
  ds_read_b128 a[108:111], v115 offset:8192
  ds_read_b128 a[80:83], v112 offset:256
  ds_read_b128 a[112:115], v112 offset:8448
  ds_read_b128 a[84:87], v113 offset:256
  ds_read_b128 a[116:119], v113 offset:8448
  ds_read_b128 a[88:91], v114 offset:256
  ds_read_b128 a[120:123], v114 offset:8448
  ds_read_b128 a[92:95], v115 offset:256
  ds_read_b128 a[124:127], v115 offset:8448
  s_waitcnt lgkmcnt(0)
SKQB:
  v_accvgpr_read_b32 v112, a128
  v_accvgpr_read_b32 v113, a129
  v_accvgpr_read_b32 v114, a130
  v_accvgpr_read_b32 v115, a131
  v_accvgpr_read_b32 v116, a132
  v_accvgpr_read_b32 v117, a133
  v_accvgpr_read_b32 v118, a134
  v_accvgpr_read_b32 v119, a135
  v_accvgpr_read_b32 v120, a136
  v_accvgpr_read_b32 v121, a137
  v_accvgpr_read_b32 v122, a138
  v_accvgpr_read_b32 v123, a139
  v_accvgpr_read_b32 v124, a140
  v_accvgpr_read_b32 v125, a141
  v_accvgpr_read_b32 v126, a142
  v_accvgpr_read_b32 v127, a143
  v_mfma_f32_32x32x16_bf16 a[128:143], v[56:59], v[56:59], 0
  ds_read_b128 v[36:39], v8 offset:8192
  v_mul_f32 v112, v112, v30
  v_mul_f32 v113, v113, v30
  v_mul_f32 v114, v114, v30
  v_mul_f32 v115, v115, v30
  v_mul_f32 v116, v116, v30
  v_mfma_f32_16x16x32_bf16 v[96:99], v[40:43], a[4:7], v[96:99]
  v_mul_f32 v117, v117, v30
  v_mul_f32 v118, v118, v30
  v_mfma_f32_16x16x32_bf16 v[104:107], v[40:43], a[36:39], v[104:107]
  v_mul_f32 v119, v119, v30
  v_mul_f32 v120, v120, v30
  v_mfma_f32_16x16x32_bf16 v[100:103], v[44:47], a[4:7], v[100:103]
  v_mul_f32 v121, v121, v30
  v_mul_f32 v122, v122, v30
  v_mfma_f32_16x16x32_bf16 v[108:111], v[44:47], a[36:39], v[108:111]
  v_mul_f32 v123, v123, v30
  v_mul_f32 v124, v124, v30
  v_cvt_pk_bf16_f32 v64, v112, v113
  v_accvgpr_read_b32 v112, a144
  v_accvgpr_read_b32 v113, a145
  v_cvt_pk_bf16_f32 v65, v114, v115
  v_accvgpr_read_b32 v114, a146
  v_accvgpr_read_b32 v115, a147
  v_cvt_pk_bf16_f32 v66, v116, v117
  v_accvgpr_read_b32 v116, a148
  v_accvgpr_read_b32 v117, a149
  v_cvt_pk_bf16_f32 v67, v118, v119
  v_accvgpr_read_b32 v118, a150
  v_accvgpr_read_b32 v119, a151
  v_cvt_pk_bf16_f32 v68, v120, v121
  v_accvgpr_read_b32 v120, a152
  v_accvgpr_read_b32 v121, a153
  v_cvt_pk_bf16_f32 v69, v122, v123
  v_accvgpr_read_b32 v122, a154
  v_accvgpr_read_b32 v123, a155
  v_mul_f32 v125, v125, v30
  v_cvt_pk_bf16_f32 v70, v124, v125
  v_accvgpr_read_b32 v124, a156
  v_accvgpr_read_b32 v125, a157
  v_mul_f32 v126, v126, v30
  v_mul_f32 v127, v127, v30
  v_cvt_pk_bf16_f32 v71, v126, v127
  v_accvgpr_read_b32 v126, a158
  v_accvgpr_read_b32 v127, a159
  v_mfma_f32_32x32x16_bf16 a[144:159], v[56:59], v[56:59], 0
  ds_read_b128 v[40:43], v9 offset:0
  ds_read_b128 v[44:47], v9 offset:8192
  v_add_u32 v79, s45, v79
  v_mul_f32 v112, v112, v30
  v_xor_b32 v72, 0, v79
  v_xor_b32 v73, 16, v79
  v_mfma_f32_16x16x32_bf16 v[96:99], v[32:35], a[8:11], v[96:99]
  v_mul_f32 v113, v113, v30
  v_mul_f32 v114, v114, v30
  v_mfma_f32_16x16x32_bf16 v[104:107], v[32:35], a[40:43], v[104:107]
  v_mul_f32 v115, v115, v30
  v_mul_f32 v116, v116, v30
  s_waitcnt lgkmcnt(2)
  v_mfma_f32_16x16x32_bf16 v[100:103], v[36:39], a[8:11], v[100:103]
  v_mul_f32 v117, v117, v30
  v_mul_f32 v118, v118, v30
  v_mfma_f32_16x16x32_bf16 v[108:111], v[36:39], a[40:43], v[108:111]
  v_mul_f32 v119, v119, v30
  v_mul_f32 v120, v120, v30
  ds_write_b128 v72, v[64:67] offset:0
  s_nop 1
  v_cvt_pk_bf16_f32 v64, v112, v113
  v_accvgpr_read_b32 v112, a160
  v_accvgpr_read_b32 v113, a161
  v_cvt_pk_bf16_f32 v65, v114, v115
  v_accvgpr_read_b32 v114, a162
  v_accvgpr_read_b32 v115, a163
  v_cvt_pk_bf16_f32 v66, v116, v117
  v_accvgpr_read_b32 v116, a164
  v_accvgpr_read_b32 v117, a165
  v_cvt_pk_bf16_f32 v67, v118, v119
  v_accvgpr_read_b32 v118, a166
  v_accvgpr_read_b32 v119, a167
  ds_write_b128 v73, v[68:71] offset:0
  v_mul_f32 v121, v121, v30
  s_nop 0
  v_cvt_pk_bf16_f32 v68, v120, v121
  v_accvgpr_read_b32 v120, a168
  v_accvgpr_read_b32 v121, a169
  v_mul_f32 v122, v122, v30
  v_mul_f32 v123, v123, v30
  v_cvt_pk_bf16_f32 v69, v122, v123
  v_accvgpr_read_b32 v122, a170
  v_accvgpr_read_b32 v123, a171
  v_mul_f32 v124, v124, v30
  v_mul_f32 v125, v125, v30
  v_cvt_pk_bf16_f32 v70, v124, v125
  v_accvgpr_read_b32 v124, a172
  v_accvgpr_read_b32 v125, a173
  v_mul_f32 v126, v126, v30
  v_mul_f32 v127, v127, v30
  v_cvt_pk_bf16_f32 v71, v126, v127
  v_accvgpr_read_b32 v126, a174
  v_accvgpr_read_b32 v127, a175
  v_mfma_f32_32x32x16_bf16 a[160:175], v[56:59], v[56:59], 0
  ds_read_b128 v[32:35], v6 offset:256
  ds_read_b128 v[36:39], v6 offset:8448
  v_xor_b32 v72, 64, v79
  v_xor_b32 v73, 80, v79
  v_mul_f32 v112, v112, v30
  v_mul_f32 v113, v113, v30
  s_waitcnt lgkmcnt(5)
  v_mfma_f32_16x16x32_bf16 v[96:99], v[40:43], a[12:15], v[96:99]
  v_mul_f32 v114, v114, v30
  v_mul_f32 v115, v115, v30
  v_mfma_f32_16x16x32_bf16 v[104:107], v[40:43], a[44:47], v[104:107]
  v_mul_f32 v116, v116, v30
  v_mul_f32 v117, v117, v30
  s_waitcnt lgkmcnt(4)
  v_mfma_f32_16x16x32_bf16 v[100:103], v[44:47], a[12:15], v[100:103]
  v_mul_f32 v118, v118, v30
  v_mul_f32 v119, v119, v30
  v_mfma_f32_16x16x32_bf16 v[108:111], v[44:47], a[44:47], v[108:111]
  v_mul_f32 v120, v120, v30
  v_mul_f32 v121, v121, v30
  ds_write_b128 v72, v[64:67] offset:0
  s_nop 1
  v_cvt_pk_bf16_f32 v64, v112, v113
  v_accvgpr_read_b32 v112, a176
  v_accvgpr_read_b32 v113, a177
  v_cvt_pk_bf16_f32 v65, v114, v115
  v_accvgpr_read_b32 v114, a178
  v_accvgpr_read_b32 v115, a179
  v_cvt_pk_bf16_f32 v66, v116, v117
  v_accvgpr_read_b32 v116, a180
  v_accvgpr_read_b32 v117, a181
  v_cvt_pk_bf16_f32 v67, v118, v119
  v_accvgpr_read_b32 v118, a182
  v_accvgpr_read_b32 v119, a183
  ds_write_b128 v73, v[68:71] offset:0
  s_nop 1
  v_cvt_pk_bf16_f32 v68, v120, v121
  v_accvgpr_read_b32 v120, a184
  v_accvgpr_read_b32 v121, a185
  v_mul_f32 v122, v122, v30
  v_mul_f32 v123, v123, v30
  v_cvt_pk_bf16_f32 v69, v122, v123
  v_accvgpr_read_b32 v122, a186
  v_accvgpr_read_b32 v123, a187
  v_mul_f32 v124, v124, v30
  v_mul_f32 v125, v125, v30
  v_cvt_pk_bf16_f32 v70, v124, v125
  v_accvgpr_read_b32 v124, a188
  v_accvgpr_read_b32 v125, a189
  v_mul_f32 v126, v126, v30
  v_mul_f32 v127, v127, v30
  v_cvt_pk_bf16_f32 v71, v126, v127
  v_accvgpr_read_b32 v126, a190
  v_accvgpr_read_b32 v127, a191
  v_mfma_f32_32x32x16_bf16 a[176:191], v[56:59], v[56:59], 0
  ds_read_b128 v[40:43], v7 offset:256
  ds_read_b128 v[44:47], v7 offset:8448
  v_xor_b32 v72, 128, v79
  v_xor_b32 v73, 144, v79
  v_mul_f32 v112, v112, v30
  v_mul_f32 v113, v113, v30
  s_waitcnt lgkmcnt(5)
  v_mfma_f32_16x16x32_bf16 v[96:99], v[32:35], a[16:19], v[96:99]
  v_mul_f32 v114, v114, v30
  v_mul_f32 v115, v115, v30
  v_mfma_f32_16x16x32_bf16 v[104:107], v[32:35], a[48:51], v[104:107]
  v_mul_f32 v116, v116, v30
  v_mul_f32 v117, v117, v30
  s_waitcnt lgkmcnt(4)
  v_mfma_f32_16x16x32_bf16 v[100:103], v[36:39], a[16:19], v[100:103]
  v_mul_f32 v118, v118, v30
  v_mul_f32 v119, v119, v30
  v_mfma_f32_16x16x32_bf16 v[108:111], v[36:39], a[48:51], v[108:111]
  v_mul_f32 v120, v120, v30
  v_mul_f32 v121, v121, v30
  ds_write_b128 v72, v[64:67] offset:0
  s_nop 1
  v_cvt_pk_bf16_f32 v64, v112, v113
  v_accvgpr_read_b32 v112, a192
  v_accvgpr_read_b32 v113, a193
  v_cvt_pk_bf16_f32 v65, v114, v115
  v_accvgpr_read_b32 v114, a194
  v_accvgpr_read_b32 v115, a195
  v_cvt_pk_bf16_f32 v66, v116, v117
  v_accvgpr_read_b32 v116, a196
  v_accvgpr_read_b32 v117, a197
  v_cvt_pk_bf16_f32 v67, v118, v119
  v_accvgpr_read_b32 v118, a198
  v_accvgpr_read_b32 v119, a199
  ds_write_b128 v73, v[68:71] offset:0
  s_nop 1
  v_cvt_pk_bf16_f32 v68, v120, v121
  v_accvgpr_read_b32 v120, a200
  v_accvgpr_read_b32 v121, a201
  v_mul_f32 v122, v122, v30
  v_mul_f32 v123, v123, v30
  v_cvt_pk_bf16_f32 v69, v122, v123
  v_accvgpr_read_b32 v122, a202
  v_accvgpr_read_b32 v123, a203
  v_mul_f32 v124, v124, v30
  v_mul_f32 v125, v125, v30
  v_cvt_pk_bf16_f32 v70, v124, v125
  v_accvgpr_read_b32 v124, a204
  v_accvgpr_read_b32 v125, a205
  v_mul_f32 v126, v126, v30
  v_mul_f32 v127, v127, v30
  v_cvt_pk_bf16_f32 v71, v126, v127
  v_accvgpr_read_b32 v126, a206
  v_accvgpr_read_b32 v127, a207
  v_mfma_f32_32x32x16_bf16 a[192:207], v[56:59], v[56:59], 0
  ds_read_b128 v[32:35], v8 offset:256
  ds_read_b128 v[36:39], v8 offset:8448
  v_xor_b32 v72, 192, v79
  v_xor_b32 v73, 208, v79
  v_mul_f32 v112, v112, v30
  v_mul_f32 v113, v113, v30
  s_waitcnt lgkmcnt(5)
  v_mfma_f32_16x16x32_bf16 v[96:99], v[40:43], a[20:23], v[96:99]
  v_mul_f32 v114, v114, v30
  v_mul_f32 v115, v115, v30
  v_mfma_f32_16x16x32_bf16 v[104:107], v[40:43], a[52:55], v[104:107]
  v_mul_f32 v116, v116, v30
  v_mul_f32 v117, v117, v30
  s_waitcnt lgkmcnt(4)
  v_mfma_f32_16x16x32_bf16 v[100:103], v[44:47], a[20:23], v[100:103]
  v_mul_f32 v118, v118, v30
  v_mul_f32 v119, v119, v30
  v_mfma_f32_16x16x32_bf16 v[108:111], v[44:47], a[52:55], v[108:111]
  v_mul_f32 v120, v120, v30
  v_mul_f32 v121, v121, v30
  ds_write_b128 v72, v[64:67] offset:0
  s_nop 1
  v_cvt_pk_bf16_f32 v64, v112, v113
  v_accvgpr_read_b32 v112, a208
  v_accvgpr_read_b32 v113, a209
  v_cvt_pk_bf16_f32 v65, v114, v115
  v_accvgpr_read_b32 v114, a210
  v_accvgpr_read_b32 v115, a211
  v_cvt_pk_bf16_f32 v66, v116, v117
  v_accvgpr_read_b32 v116, a212
  v_accvgpr_read_b32 v117, a213
  v_cvt_pk_bf16_f32 v67, v118, v119
  v_accvgpr_read_b32 v118, a214
  v_accvgpr_read_b32 v119, a215
  ds_write_b128 v73, v[68:71] offset:0
  s_nop 1
  v_cvt_pk_bf16_f32 v68, v120, v121
  v_accvgpr_read_b32 v120, a216
  v_accvgpr_read_b32 v121, a217
  v_mul_f32 v122, v122, v30
  v_mul_f32 v123, v123, v30
  v_cvt_pk_bf16_f32 v69, v122, v123
  v_accvgpr_read_b32 v122, a218
  v_accvgpr_read_b32 v123, a219
  v_mul_f32 v124, v124, v30
  v_mul_f32 v125, v125, v30
  v_cvt_pk_bf16_f32 v70, v124, v125
  v_accvgpr_read_b32 v124, a220
  v_accvgpr_read_b32 v125, a221
  v_mul_f32 v126, v126, v30
  v_mul_f32 v127, v127, v30
  v_cvt_pk_bf16_f32 v71, v126, v127
  v_accvgpr_read_b32 v126, a222
  v_accvgpr_read_b32 v127, a223
  v_mfma_f32_32x32x16_bf16 a[208:223], v[56:59], v[56:59], 0
  ds_read_b128 v[40:43], v9 offset:256
  ds_read_b128 v[44:47], v9 offset:8448
  v_xor_b32 v72, 0, v79
  v_xor_b32 v73, 16, v79
  v_mul_f32 v112, v112, v30
  v_mul_f32 v113, v113, v30
  s_waitcnt lgkmcnt(5)
  v_mfma_f32_16x16x32_bf16 v[96:99], v[32:35], a[24:27], v[96:99]
  v_mul_f32 v114, v114, v30
  v_mul_f32 v115, v115, v30
  v_mfma_f32_16x16x32_bf16 v[104:107], v[32:35], a[56:59], v[104:107]
  v_mul_f32 v116, v116, v30
  v_mul_f32 v117, v117, v30
  s_waitcnt lgkmcnt(4)
  v_mfma_f32_16x16x32_bf16 v[100:103], v[36:39], a[24:27], v[100:103]
  v_mul_f32 v118, v118, v30
  v_mul_f32 v119, v119, v30
  v_mfma_f32_16x16x32_bf16 v[108:111], v[36:39], a[56:59], v[108:111]
  v_mul_f32 v120, v120, v30
  v_mul_f32 v121, v121, v30
  ds_write_b128 v72, v[64:67] offset:256
  s_nop 1
  v_cvt_pk_bf16_f32 v64, v112, v113
  v_accvgpr_read_b32 v112, a224
  v_accvgpr_read_b32 v113, a225
  v_cvt_pk_bf16_f32 v65, v114, v115
  v_accvgpr_read_b32 v114, a226
  v_accvgpr_read_b32 v115, a227
  v_cvt_pk_bf16_f32 v66, v116, v117
  v_accvgpr_read_b32 v116, a228
  v_accvgpr_read_b32 v117, a229
  v_cvt_pk_bf16_f32 v67, v118, v119
  v_accvgpr_read_b32 v118, a230
  v_accvgpr_read_b32 v119, a231
  ds_write_b128 v73, v[68:71] offset:256
  s_nop 1
  v_cvt_pk_bf16_f32 v68, v120, v121
  v_accvgpr_read_b32 v120, a232
  v_accvgpr_read_b32 v121, a233
  v_mul_f32 v122, v122, v30
  v_mul_f32 v123, v123, v30
  v_cvt_pk_bf16_f32 v69, v122, v123
  v_accvgpr_read_b32 v122, a234
  v_accvgpr_read_b32 v123, a235
  v_mul_f32 v124, v124, v30
  v_mul_f32 v125, v125, v30
  v_cvt_pk_bf16_f32 v70, v124, v125
  v_accvgpr_read_b32 v124, a236
  v_accvgpr_read_b32 v125, a237
  v_mul_f32 v126, v126, v30
  v_mul_f32 v127, v127, v30
  v_cvt_pk_bf16_f32 v71, v126, v127
  v_accvgpr_read_b32 v126, a238
  v_accvgpr_read_b32 v127, a239
  v_mfma_f32_32x32x16_bf16 a[224:239], v[56:59], v[56:59], 0
  ds_read_b128 v[32:35], v6 offset:0
  ds_read_b128 v[36:39], v6 offset:8192
  v_xor_b32 v72, 64, v79
  v_xor_b32 v73, 80, v79
  v_mul_f32 v112, v112, v30
  v_mul_f32 v113, v113, v30
  s_waitcnt lgkmcnt(5)
  v_mfma_f32_16x16x32_bf16 v[96:99], v[40:43], a[28:31], v[96:99]
  v_mul_f32 v114, v114, v30
  v_mul_f32 v115, v115, v30
  v_mfma_f32_16x16x32_bf16 v[104:107], v[40:43], a[60:63], v[104:107]
  ds_read_b128 v[40:43], v7 offset:0
  v_mul_f32 v116, v116, v30
  s_waitcnt lgkmcnt(5)
  v_mfma_f32_16x16x32_bf16 v[100:103], v[44:47], a[28:31], v[100:103]
  v_mul_f32 v117, v117, v30
  v_mul_f32 v118, v118, v30
  v_mfma_f32_16x16x32_bf16 v[108:111], v[44:47], a[60:63], v[108:111]
  v_mul_f32 v119, v119, v30
  v_mul_f32 v120, v120, v30
  ds_write_b128 v72, v[64:67] offset:256
  s_nop 1
  v_cvt_pk_bf16_f32 v64, v112, v113
  v_accvgpr_read_b32 v112, a240
  v_accvgpr_read_b32 v113, a241
  v_cvt_pk_bf16_f32 v65, v114, v115
  v_accvgpr_read_b32 v114, a242
  v_accvgpr_read_b32 v115, a243
  v_cvt_pk_bf16_f32 v66, v116, v117
  v_accvgpr_read_b32 v116, a244
  v_accvgpr_read_b32 v117, a245
  v_cvt_pk_bf16_f32 v67, v118, v119
  v_accvgpr_read_b32 v118, a246
  v_accvgpr_read_b32 v119, a247
  ds_write_b128 v73, v[68:71] offset:256
  v_mul_f32 v121, v121, v30
  s_nop 0
  v_cvt_pk_bf16_f32 v68, v120, v121
  v_accvgpr_read_b32 v120, a248
  v_accvgpr_read_b32 v121, a249
  v_mul_f32 v122, v122, v30
  v_mul_f32 v123, v123, v30
  v_cvt_pk_bf16_f32 v69, v122, v123
  v_accvgpr_read_b32 v122, a250
  v_accvgpr_read_b32 v123, a251
  v_mul_f32 v124, v124, v30
  v_mul_f32 v125, v125, v30
  v_cvt_pk_bf16_f32 v70, v124, v125
  v_accvgpr_read_b32 v124, a252
  v_accvgpr_read_b32 v125, a253
  v_mul_f32 v126, v126, v30
  v_mul_f32 v127, v127, v30
  v_cvt_pk_bf16_f32 v71, v126, v127
  v_accvgpr_read_b32 v126, a254
  v_accvgpr_read_b32 v127, a255
  v_mfma_f32_32x32x16_bf16 a[240:255], v[56:59], v[56:59], 0
  ds_read_b128 v[44:47], v7 offset:8192
  s_add_u32 m0, s21, 65536
  s_nop 0
  buffer_load_dwordx4 v2, s[12:15], s31 offen offset:0 lds
  buffer_load_dwordx4 v3, s[12:15], s31 offen offset:1024 lds
  s_waitcnt lgkmcnt(5)
  v_mfma_f32_16x16x32_bf16 v[80:83], v[32:35], a[64:67], 0
  buffer_load_dwordx4 v4, s[12:15], s31 offen offset:2048 lds
  v_mfma_f32_16x16x32_bf16 v[88:91], v[32:35], a[96:99], 0
  ds_read_b128 v[32:35], v8 offset:0
  v_max3_f32 v24, v104, v105, v106
  s_waitcnt lgkmcnt(5)
  v_mfma_f32_16x16x32_bf16 v[84:87], v[36:39], a[64:67], 0
  buffer_load_dwordx4 v5, s[12:15], s31 offen offset:3072 lds
  v_mfma_f32_16x16x32_bf16 v[92:95], v[36:39], a[96:99], 0
  ds_read_b128 v[36:39], v8 offset:8192
  s_add_u32 m0, s21, 32768
  s_waitcnt lgkmcnt(5)
  v_mfma_f32_16x16x32_bf16 v[80:83], v[40:43], a[68:71], v[80:83]
  buffer_load_dwordx4 v2, s[8:11], s32 offen offset:0 lds
  v_mfma_f32_16x16x32_bf16 v[88:91], v[40:43], a[100:103], v[88:91]
  ds_read_b128 v[40:43], v9 offset:0
  v_max3_f32 v25, v107, v108, v109
  s_waitcnt lgkmcnt(3)
  v_mfma_f32_16x16x32_bf16 v[84:87], v[44:47], a[68:71], v[84:87]
  buffer_load_dwordx4 v3, s[8:11], s32 offen offset:1024 lds
  v_mfma_f32_16x16x32_bf16 v[92:95], v[44:47], a[100:103], v[92:95]
  ds_read_b128 v[44:47], v9 offset:8192
  v_max3_f32 v24, v24, v110, v111
  s_waitcnt lgkmcnt(3)
  v_mfma_f32_16x16x32_bf16 v[80:83], v[32:35], a[72:75], v[80:83]
  s_add_u32 s51, s93, 49152
  buffer_load_dwordx4 v4, s[8:11], s32 offen offset:2048 lds
  v_mfma_f32_16x16x32_bf16 v[88:91], v[32:35], a[104:107], v[88:91]
  ds_read_b128 v[32:35], v6 offset:256
  v_max_f32 v24, v24, v25
  s_waitcnt lgkmcnt(3)
  v_mfma_f32_16x16x32_bf16 v[84:87], v[36:39], a[72:75], v[84:87]
  s_and_b32 s51, s51, 0x3ffff
  buffer_load_dwordx4 v5, s[8:11], s32 offen offset:3072 lds
  v_mfma_f32_16x16x32_bf16 v[92:95], v[36:39], a[104:107], v[92:95]
  ds_read_b128 v[36:39], v6 offset:8448
  s_or_b32 s51, s51, s92
  s_waitcnt lgkmcnt(3)
  v_mfma_f32_16x16x32_bf16 v[80:83], v[40:43], a[76:79], v[80:83]
  v_mov_b32 v25, v24
  s_add_u32 m0, s21, 0
  v_mfma_f32_16x16x32_bf16 v[88:91], v[40:43], a[108:111], v[88:91]
  ds_read_b128 v[40:43], v7 offset:256
  s_add_u32 s28, s93, 65536
  s_waitcnt lgkmcnt(3)
  v_mfma_f32_16x16x32_bf16 v[84:87], v[44:47], a[76:79], v[84:87]
  v_permlane32_swap_b32 v24, v25
  s_and_b32 s28, s28, 0x3ffff
  v_mfma_f32_16x16x32_bf16 v[92:95], v[44:47], a[108:111], v[92:95]
  s_or_b32 s28, s28, s92
  v_max_f32 v24, v24, v25
  s_waitcnt lgkmcnt(2)
  v_mfma_f32_16x16x32_bf16 v[80:83], v[32:35], a[80:83], v[80:83]
  s_add_u32 s34, s93, 32768
  ds_read_b128 v[44:47], v7 offset:8448
  v_mfma_f32_16x16x32_bf16 v[88:91], v[32:35], a[112:115], v[88:91]
  s_and_b32 s34, s34, 0x3ffff
  v_mov_b32 v25, v24
  s_waitcnt lgkmcnt(2)
  v_mfma_f32_16x16x32_bf16 v[84:87], v[36:39], a[80:83], v[84:87]
  v_max3_f32 v29, v96, v97, v98
  s_or_b32 s34, s34, s92
  v_mfma_f32_16x16x32_bf16 v[92:95], v[36:39], a[112:115], v[92:95]
  s_add_u32 s29, s93, 81920
  v_permlane16_swap_b32 v24, v25
  s_waitcnt lgkmcnt(1)
  v_mfma_f32_16x16x32_bf16 v[80:83], v[40:43], a[84:87], v[80:83]
  v_max3_f32 v0, v99, v100, v101
  v_max3_f32 v29, v29, v102, v103
  v_mfma_f32_16x16x32_bf16 v[88:91], v[40:43], a[116:119], v[88:91]
  s_and_b32 s29, s29, 0x3ffff
  v_max_f32 v24, v24, v25
  s_waitcnt lgkmcnt(0)
  v_mfma_f32_16x16x32_bf16 v[84:87], v[44:47], a[84:87], v[84:87]
  s_or_b32 s29, s29, s92
  ds_read_b128 v[32:35], v8 offset:256
  v_mfma_f32_16x16x32_bf16 v[92:95], v[44:47], a[116:119], v[92:95]
  v_max_f32 v29, v29, v0
  s_add_u32 s35, s93, 49152
  s_waitcnt lgkmcnt(0)
  v_mfma_f32_16x16x32_bf16 v[80:83], v[32:35], a[88:91], v[80:83]
  v_mul_f32 v11, s22, v24
  s_and_b32 s35, s35, 0x3ffff
  v_mfma_f32_16x16x32_bf16 v[88:91], v[32:35], a[120:123], v[88:91]
  v_mov_b32 v0, v29
  s_or_b32 s35, s35, s92
  ds_read_b128 v[36:39], v8 offset:8448
  s_waitcnt lgkmcnt(0)
  v_mfma_f32_16x16x32_bf16 v[84:87], v[36:39], a[88:91], v[84:87]
  s_add_u32 s30, s93, 98304
  v_permlane32_swap_b32 v29, v0
  v_mfma_f32_16x16x32_bf16 v[92:95], v[36:39], a[120:123], v[92:95]
  s_and_b32 s30, s30, 0x3ffff
  v_max_f32 v29, v29, v0
  ds_read_b128 v[40:43], v9 offset:256
  s_waitcnt lgkmcnt(0)
  v_mfma_f32_16x16x32_bf16 v[80:83], v[40:43], a[92:95], v[80:83]
  s_or_b32 s30, s30, s92
  s_add_u32 s36, s93, 65536
  v_mfma_f32_16x16x32_bf16 v[88:91], v[40:43], a[124:127], v[88:91]
  v_mov_b32 v0, v29
  s_and_b32 s36, s36, 0x3ffff
  ds_read_b128 v[44:47], v9 offset:8448
  s_waitcnt lgkmcnt(0)
  v_mfma_f32_16x16x32_bf16 v[84:87], v[44:47], a[92:95], v[84:87]
  s_or_b32 s36, s36, s92
  v_permlane16_swap_b32 v29, v0
  v_mfma_f32_16x16x32_bf16 v[92:95], v[44:47], a[124:127], v[92:95]
  v_max3_f32 v24, v88, v89, v90
  s_add_u32 s76, s78, 16384
  s_add_u32 s25, s25, 1
  v_max_f32 v29, v29, v0
  s_lshl_b32 s46, s25, 5
  s_add_u32 s46, s46, s44
  v_mul_f32 v10, s22, v29
  v_max3_f32 v29, v80, v81, v82
  v_max3_f32 v25, v91, v92, v93
  v_max3_f32 v24, v24, v94, v95
  s_mul_i32 s47, s46, 171
  v_max_f32 v24, v24, v25
  s_lshr_b32 s47, s47, 9
  v_mov_b32 v25, v24
  v_max3_f32 v0, v83, v84, v85
  s_nop 0
  v_permlane32_swap_b32 v24, v25
  v_max3_f32 v29, v29, v86, v87
  v_max_f32 v24, v24, v25
  s_mul_i32 s48, s47, 3
  v_mov_b32 v25, v24
  v_max_f32 v29, v29, v0
  s_nop 0
  v_permlane16_swap_b32 v24, v25
  v_fma_f32 v96, v96, s22, -v10
  v_max_f32 v24, v24, v25
  v_fma_f32 v97, v97, s22, -v10
  s_sub_u32 s48, s46, s48
  s_lshl_b32 s47, s47, 3
  v_mul_f32 v13, s22, v24
  v_mov_b32 v0, v29
  v_exp_f32 v56, v96
  v_exp_f32 v24, v97
  v_fma_f32 v98, v98, s22, -v10
  s_add_u32 s47, s47, s43
  s_mov_b32 s94, s92
  s_lshl_b32 s92, s47, 18
  v_permlane32_swap_b32 v29, v0
  v_exp_f32 v57, v98
  v_fma_f32 v99, v99, s22, -v10
  s_and_b32 s93, s47, 15
  s_lshl_b32 s93, s93, 14
  v_max_f32 v29, v29, v0
  v_exp_f32 v25, v99
  v_fma_f32 v100, v100, s22, -v10
  s_add_u32 s93, s93, s21
  v_add_f32 v31, v56, v24
  s_mul_i32 s49, s47, 376832
  s_lshl_b32 s50, s48, 17
  v_mov_b32 v0, v29
  v_exp_f32 v60, v100
  v_fma_f32 v101, v101, s22, -v10
  s_add_u32 s49, s49, s50
  v_cvt_pk_bf16_f32 v56, v56, v24
  v_add_f32 v31, v31, v57
  s_mov_b32 s78, s58
  v_permlane16_swap_b32 v29, v0
  v_exp_f32 v24, v101
  v_fma_f32 v102, v102, s22, -v10
  s_add_u32 s58, s49, s21
  s_lshl_b32 s50, s20, 15
  v_add_f32 v31, v31, v25
  s_mov_b32 s41, s39
  v_max_f32 v29, v29, v0
  v_exp_f32 v61, v102
  v_fma_f32 v103, v103, s22, -v10
  s_add_u32 s39, s49, s50
  s_mov_b32 s42, s40
  v_cvt_pk_bf16_f32 v57, v57, v25
  v_add_f32 v31, v31, v60
  s_add_u32 s40, s39, 16384
  v_mul_f32 v12, s22, v29
  v_exp_f32 v25, v103
  v_fma_f32 v104, v104, s22, -v11
  v_fma_f32 v105, v105, s22, -v11
  s_lshl_b32 s50, s48, 2
  v_add_f32 v31, v31, v24
  v_cvt_pk_bf16_f32 v60, v60, v24
  s_add_u32 s50, s50, s20
  v_max_f32 v12, s98, v12
  v_max_f32 v13, s98, v13
  v_exp_f32 v58, v104
  v_exp_f32 v24, v105
  v_fma_f32 v106, v106, s22, -v11
  s_cmp_eq_u32 s50, 11
  s_mov_b32 s98, 0xff800000
  v_add_f32 v31, v31, v61
  v_exp_f32 v59, v106
  v_fma_f32 v107, v107, s22, -v11
  s_cselect_b32 s40, s27, s40
  s_cselect_b32 s98, 0x7149f2ca, s98
  s_add_u32 s99, s58, 114688
  v_add_f32 v31, v31, v25
  v_cvt_pk_bf16_f32 v61, v61, v25
  s_mov_b32 s77, s79
  s_cmp_eq_u32 s48, 2
  v_exp_f32 v25, v107
  v_fma_f32 v108, v108, s22, -v11
  s_mov_b32 s79, s85
  s_cselect_b32 s85, 3, 4
  v_add_f32 v0, v58, v24
  s_cmp_eq_u32 s48, 2
  v_exp_f32 v62, v108
  v_fma_f32 v109, v109, s22, -v11
  s_cselect_b32 s99, s27, s99
  v_xor_b32 v72, 128, v79
  v_cvt_pk_bf16_f32 v58, v58, v24
  v_add_f32 v0, v0, v59
  s_cmp_ge_u32 s25, 3
  v_xor_b32 v73, 144, v79
  v_mul_f32 v112, v112, v30
  v_mul_f32 v113, v113, v30
  v_mul_f32 v114, v114, v30
  v_mul_f32 v115, v115, v30
  v_mul_f32 v116, v116, v30
  v_mul_f32 v117, v117, v30
  v_mul_f32 v118, v118, v30
  v_mul_f32 v119, v119, v30
  v_exp_f32 v24, v109
  v_fma_f32 v110, v110, s22, -v11
  v_mul_f32 v120, v120, v30
  v_mul_f32 v121, v121, v30
  v_mul_f32 v122, v122, v30
  v_mul_f32 v123, v123, v30
  v_mul_f32 v124, v124, v30
  v_mul_f32 v125, v125, v30
  v_mul_f32 v126, v126, v30
  v_mul_f32 v127, v127, v30
  s_cselect_b32 s99, s27, s99
  s_cselect_b32 s39, s27, s39
  s_cselect_b32 s40, s27, s40
  s_cselect_b32 s92, s27, s92
  s_cselect_b32 s58, s27, s58
  ds_write_b128 v72, v[64:67] offset:256
  v_add_f32 v0, v0, v25
  s_add_u32 s57, s21, 98304
  ds_write_b128 v73, v[68:71] offset:256
  v_cvt_pk_bf16_f32 v64, v112, v113
  v_cvt_pk_bf16_f32 v65, v114, v115
  v_cvt_pk_bf16_f32 v66, v116, v117
  v_cvt_pk_bf16_f32 v67, v118, v119
  v_xor_b32 v72, 192, v79
  v_exp_f32 v63, v110
  v_fma_f32 v111, v111, s22, -v11
  s_add_u32 s31, s93, 16384
  v_cvt_pk_bf16_f32 v68, v120, v121
  v_cvt_pk_bf16_f32 v69, v122, v123
  v_cvt_pk_bf16_f32 v70, v124, v125
  v_cvt_pk_bf16_f32 v71, v126, v127
  v_xor_b32 v73, 208, v79
  v_cvt_pk_bf16_f32 v59, v59, v25
  v_add_f32 v0, v0, v62
  s_and_b32 s31, s31, 0x3ffff
  ds_write_b128 v72, v[64:67] offset:256
  v_exp_f32 v25, v111
  ds_write_b128 v73, v[68:71] offset:256
  s_or_b32 s31, s31, s92
  v_add_f32 v0, v0, v24
  s_add_u32 s32, s93, 32768
  s_waitcnt vmcnt(28) lgkmcnt(0)
  s_barrier
  s_and_b32 s32, s32, 0x3ffff
  v_add_f32 v0, v0, v63
  buffer_load_dwordx4 v2, s[8:11], s51 offen offset:0 lds
  s_or_b32 s32, s32, s92
  buffer_load_dwordx4 v3, s[8:11], s51 offen offset:1024 lds
  s_add_u32 s33, s93, 0
  v_mov_b32 v26, 0
  v_mov_b32 v27, 0
  v_cvt_pk_bf16_f32 v62, v62, v24
  v_add_f32 v0, v0, v25
  v_cvt_pk_bf16_f32 v63, v63, v25
  buffer_load_dwordx4 v4, s[8:11], s51 offen offset:2048 lds
  s_and_b32 s33, s33, 0x3ffff
  v_mov_b32 v22, 0
  v_mov_b32 v23, 0
  v_permlane16_swap_b32 v56, v58
  v_permlane16_swap_b32 v57, v59
  v_permlane16_swap_b32 v60, v62
  v_permlane16_swap_b32 v61, v63
  v_add_f32 v26, v26, v31
  v_add_f32 v27, v27, v0
  buffer_load_dwordx4 v5, s[8:11], s51 offen offset:3072 lds
  s_mov_b32 s24, 0
  s_mov_b32 s26, 0
  s_mov_b32 s56, s58
  s_or_b32 s33, s33, s92
  ds_read_b128 v[32:35], v6 offset:16384
  ds_read_b128 v[36:39], v6 offset:24576
  ds_read_b128 v[40:43], v7 offset:16384
  ds_read_b128 v[44:47], v7 offset:24576
LOOP:
  s_waitcnt lgkmcnt(3)
  v_mfma_f32_16x16x32_bf16 v[112:115], v[32:35], a[0:3], 0
  ds_read_b128 v[48:51], v8 offset:16384
  ds_read_b128 v[52:55], v8 offset:24576
  v_mfma_f32_16x16x32_bf16 v[120:123], v[32:35], a[32:35], 0
  s_cmp_lg_u32 s26, 0
  s_cbranch_scc1 RARE0
RET0:
  v_mfma_f32_16x16x32_bf16 v[96:99], v[32:35], a[64:67], 0
  v_fma_f32 v80, v80, s22, -v12
  v_fma_f32 v81, v81, s22, -v12
  v_mfma_f32_16x16x32_bf16 v[104:107], v[32:35], a[96:99], 0
  ds_read_b128 v[32:35], v9 offset:16384
  v_fma_f32 v82, v82, s22, -v12
  s_waitcnt lgkmcnt(5)
  v_mfma_f32_16x16x32_bf16 v[116:119], v[36:39], a[0:3], 0
  v_exp_f32 v72, v80
  v_mfma_f32_16x16x32_bf16 v[124:127], v[36:39], a[32:35], 0
  v_exp_f32 v24, v81
  v_mfma_f32_16x16x32_bf16 v[100:103], v[36:39], a[64:67], 0
  v_exp_f32 v73, v82
  v_mfma_f32_16x16x32_bf16 v[108:111], v[36:39], a[96:99], 0
  ds_read_b128 v[36:39], v9 offset:24576
  v_fma_f32 v83, v83, s22, -v12
  s_waitcnt lgkmcnt(5)
  v_mfma_f32_16x16x32_bf16 v[112:115], v[40:43], a[4:7], v[112:115]
  v_exp_f32 v25, v83
  v_mfma_f32_16x16x32_bf16 v[120:123], v[40:43], a[36:39], v[120:123]
  v_fma_f32 v84, v84, s22, -v12
  v_add_f32 v31, v72, v24
  v_mfma_f32_16x16x32_bf16 v[96:99], v[40:43], a[68:71], v[96:99]
  v_exp_f32 v76, v84
  v_mfma_f32_16x16x32_bf16 v[104:107], v[40:43], a[100:103], v[104:107]
  ds_read_b128 v[40:43], v6 offset:16640
  v_fma_f32 v85, v85, s22, -v12
  s_waitcnt lgkmcnt(5)
  v_mfma_f32_16x16x32_bf16 v[116:119], v[44:47], a[4:7], v[116:119]
  v_cvt_pk_bf16_f32 v72, v72, v24
  v_add_f32 v31, v31, v73
  v_mfma_f32_16x16x32_bf16 v[124:127], v[44:47], a[36:39], v[124:127]
  v_exp_f32 v24, v85
  v_mfma_f32_16x16x32_bf16 v[100:103], v[44:47], a[68:71], v[100:103]
  v_fma_f32 v86, v86, s22, -v12
  v_add_f32 v31, v31, v25
  v_mfma_f32_16x16x32_bf16 v[108:111], v[44:47], a[100:103], v[108:111]
  ds_read_b128 v[44:47], v6 offset:24832
  v_fma_f32 v87, v87, s22, -v12
  s_waitcnt lgkmcnt(5)
  v_mfma_f32_16x16x32_bf16 v[112:115], v[48:51], a[8:11], v[112:115]
  v_exp_f32 v77, v86
  v_mfma_f32_16x16x32_bf16 v[120:123], v[48:51], a[40:43], v[120:123]
  v_cvt_pk_bf16_f32 v73, v73, v25
  v_add_f32 v31, v31, v76
  v_mfma_f32_16x16x32_bf16 v[96:99], v[48:51], a[72:75], v[96:99]
  v_exp_f32 v25, v87
  v_mfma_f32_16x16x32_bf16 v[104:107], v[48:51], a[104:107], v[104:107]
  s_waitcnt vmcnt(12)
  s_barrier
  s_add_u32 m0, s21, 81920
  s_waitcnt lgkmcnt(4)
  v_mfma_f32_16x16x32_bf16 v[116:119], v[52:55], a[8:11], v[116:119]
  buffer_load_dwordx4 v2, s[12:15], s34 offen offset:0 lds
  v_mfma_f32_16x16x32_bf16 v[124:127], v[52:55], a[40:43], v[124:127]
  ds_read_b128 v[48:51], v7 offset:16640
  v_fma_f32 v88, v88, s22, -v13
  v_mfma_f32_16x16x32_bf16 v[100:103], v[52:55], a[72:75], v[100:103]
  v_fma_f32 v89, v89, s22, -v13
  v_add_f32 v31, v31, v24
  v_mfma_f32_16x16x32_bf16 v[108:111], v[52:55], a[104:107], v[108:111]
  buffer_load_dwordx4 v3, s[12:15], s34 offen offset:1024 lds
  s_waitcnt lgkmcnt(4)
  v_mfma_f32_16x16x32_bf16 v[112:115], v[32:35], a[12:15], v[112:115]
  ds_read_b128 v[52:55], v7 offset:24832
  v_cvt_pk_bf16_f32 v76, v76, v24
  v_mfma_f32_16x16x32_bf16 v[120:123], v[32:35], a[44:47], v[120:123]
  v_exp_f32 v74, v88
  v_mfma_f32_16x16x32_bf16 v[96:99], v[32:35], a[76:79], v[96:99]
  v_exp_f32 v24, v89
  v_mfma_f32_16x16x32_bf16 v[104:107], v[32:35], a[108:111], v[104:107]
  buffer_load_dwordx4 v4, s[12:15], s34 offen offset:2048 lds
  s_waitcnt lgkmcnt(4)
  v_mfma_f32_16x16x32_bf16 v[116:119], v[36:39], a[12:15], v[116:119]
  ds_read_b128 v[32:35], v8 offset:16640
  v_fma_f32 v90, v90, s22, -v13
  v_mfma_f32_16x16x32_bf16 v[124:127], v[36:39], a[44:47], v[124:127]
  v_add_f32 v31, v31, v77
  v_fma_f32 v91, v91, s22, -v13
  v_mfma_f32_16x16x32_bf16 v[100:103], v[36:39], a[76:79], v[100:103]
  v_exp_f32 v75, v90
  v_mfma_f32_16x16x32_bf16 v[108:111], v[36:39], a[108:111], v[108:111]
  buffer_load_dwordx4 v5, s[12:15], s34 offen offset:3072 lds
  s_waitcnt lgkmcnt(4)
  v_mfma_f32_16x16x32_bf16 v[112:115], v[40:43], a[16:19], v[112:115]
  ds_read_b128 v[36:39], v8 offset:24832
  v_add_f32 v31, v31, v25
  v_mfma_f32_16x16x32_bf16 v[120:123], v[40:43], a[48:51], v[120:123]
  v_cvt_pk_bf16_f32 v77, v77, v25
  v_fma_f32 v92, v92, s22, -v13
  v_mfma_f32_16x16x32_bf16 v[96:99], v[40:43], a[80:83], v[96:99]
  v_exp_f32 v25, v91
  v_mfma_f32_16x16x32_bf16 v[104:107], v[40:43], a[112:115], v[104:107]
  ds_read_b128 v[40:43], v9 offset:16640
  v_add_f32 v0, v74, v24
  s_waitcnt lgkmcnt(5)
  v_mfma_f32_16x16x32_bf16 v[116:119], v[44:47], a[16:19], v[116:119]
  v_exp_f32 v78, v92
  v_mfma_f32_16x16x32_bf16 v[124:127], v[44:47], a[48:51], v[124:127]
  v_fma_f32 v93, v93, s22, -v13
  v_cvt_pk_bf16_f32 v74, v74, v24
  v_mfma_f32_16x16x32_bf16 v[100:103], v[44:47], a[80:83], v[100:103]
  v_add_f32 v0, v0, v75
  v_fma_f32 v94, v94, s22, -v13
  v_mfma_f32_16x16x32_bf16 v[108:111], v[44:47], a[112:115], v[108:111]
  ds_read_b128 v[44:47], v9 offset:24832
  v_add_f32 v0, v0, v25
  s_waitcnt lgkmcnt(5)
  v_mfma_f32_16x16x32_bf16 v[112:115], v[48:51], a[20:23], v[112:115]
  v_exp_f32 v24, v93
  v_mfma_f32_16x16x32_bf16 v[120:123], v[48:51], a[52:55], v[120:123]
  v_exp_f32 v79, v94
  v_mfma_f32_16x16x32_bf16 v[96:99], v[48:51], a[84:87], v[96:99]
  v_fma_f32 v95, v95, s22, -v13
  v_cvt_pk_bf16_f32 v75, v75, v25
  v_mfma_f32_16x16x32_bf16 v[104:107], v[48:51], a[116:119], v[104:107]
  ds_read_b64_tr_b16 v[48:49], v14 offset:0
  ds_read_b64_tr_b16 v[50:51], v15 offset:0
  s_waitcnt lgkmcnt(6)
  v_mfma_f32_16x16x32_bf16 v[116:119], v[52:55], a[20:23], v[116:119]
  v_add_f32 v0, v0, v78
  v_cvt_pk_bf16_f32 v78, v78, v24
  v_mfma_f32_16x16x32_bf16 v[124:127], v[52:55], a[52:55], v[124:127]
  v_exp_f32 v25, v95
  v_mfma_f32_16x16x32_bf16 v[100:103], v[52:55], a[84:87], v[100:103]
  v_add_f32 v0, v0, v24
  v_permlane16_swap_b32 v72, v74
  v_mfma_f32_16x16x32_bf16 v[108:111], v[52:55], a[116:119], v[108:111]
  ds_read_b64_tr_b16 v[52:53], v14 offset:8192
  ds_read_b64_tr_b16 v[54:55], v15 offset:8192
  s_waitcnt lgkmcnt(7)
  v_mfma_f32_16x16x32_bf16 v[112:115], v[32:35], a[24:27], v[112:115]
  v_add_f32 v0, v0, v79
  v_cvt_pk_bf16_f32 v79, v79, v25
  v_mfma_f32_16x16x32_bf16 v[120:123], v[32:35], a[56:59], v[120:123]
  v_add_f32 v0, v0, v25
  v_permlane16_swap_b32 v73, v75
  v_mfma_f32_16x16x32_bf16 v[96:99], v[32:35], a[88:91], v[96:99]
  v_max_f32 v29, v31, v0
  v_permlane16_swap_b32 v76, v78
  v_mfma_f32_16x16x32_bf16 v[104:107], v[32:35], a[120:123], v[104:107]
  v_permlane16_swap_b32 v77, v79
  v_cmp_lt_f32 vcc, s23, v29
  s_waitcnt lgkmcnt(6)
  v_mfma_f32_16x16x32_bf16 v[116:119], v[36:39], a[24:27], v[116:119]
  ds_read_b64_tr_b16 v[32:33], v16 offset:0
  ds_read_b64_tr_b16 v[34:35], v17 offset:0
  v_mfma_f32_16x16x32_bf16 v[124:127], v[36:39], a[56:59], v[124:127]
  s_cbranch_vccnz RARE1
RET1:
  v_add_f32 v22, v22, v31
  v_mfma_f32_16x16x32_bf16 v[100:103], v[36:39], a[88:91], v[100:103]
  v_add_f32 v23, v23, v0
  v_mfma_f32_16x16x32_bf16 v[108:111], v[36:39], a[120:123], v[108:111]
  ds_read_b64_tr_b16 v[36:37], v16 offset:8192
  ds_read_b64_tr_b16 v[38:39], v17 offset:8192
  s_waitcnt lgkmcnt(9)
  v_mfma_f32_16x16x32_bf16 v[112:115], v[40:43], a[28:31], v[112:115]
  v_mfma_f32_16x16x32_bf16 v[120:123], v[40:43], a[60:63], v[120:123]
  v_mfma_f32_16x16x32_bf16 v[96:99], v[40:43], a[92:95], v[96:99]
  s_nop 5
  v_fma_f32 v112, v112, s22, -v10
  v_fma_f32 v113, v113, s22, -v10
  v_mfma_f32_16x16x32_bf16 v[104:107], v[40:43], a[124:127], v[104:107]
  v_exp_f32 v64, v112
  s_waitcnt lgkmcnt(8)
  v_mfma_f32_16x16x32_bf16 v[116:119], v[44:47], a[28:31], v[116:119]
  v_exp_f32 v24, v113
  v_mfma_f32_16x16x32_bf16 v[124:127], v[44:47], a[60:63], v[124:127]
  v_fma_f32 v114, v114, s22, -v10
  v_fma_f32 v115, v115, s22, -v10
  v_mfma_f32_16x16x32_bf16 v[100:103], v[44:47], a[92:95], v[100:103]
  v_exp_f32 v65, v114
  v_mfma_f32_16x16x32_bf16 v[108:111], v[44:47], a[124:127], v[108:111]
  v_exp_f32 v25, v115
  s_waitcnt lgkmcnt(6)
  v_mfma_f32_32x32x16_bf16 v[128:143], v[48:51], v[56:59], v[128:143]
  v_fma_f32 v116, v116, s22, -v10
  v_add_f32 v31, v64, v24
  v_exp_f32 v68, v116
  v_fma_f32 v117, v117, s22, -v10
  v_mfma_f32_32x32x16_bf16 a[128:143], v[48:51], v[72:75], a[128:143]
  v_cvt_pk_bf16_f32 v64, v64, v24
  v_add_f32 v31, v31, v65
  v_exp_f32 v24, v117
  v_fma_f32 v118, v118, s22, -v10
  s_waitcnt lgkmcnt(4)
  v_mfma_f32_32x32x16_bf16 v[128:143], v[52:55], v[60:63], v[128:143]
  v_add_f32 v31, v31, v25
  v_exp_f32 v69, v118
  v_fma_f32 v119, v119, s22, -v10
  v_cvt_pk_bf16_f32 v65, v65, v25
  v_mfma_f32_32x32x16_bf16 a[128:143], v[52:55], v[76:79], a[128:143]
  v_add_f32 v31, v31, v68
  v_exp_f32 v25, v119
  v_fma_f32 v120, v120, s22, -v11
  v_fma_f32 v121, v121, s22, -v11
  s_waitcnt lgkmcnt(2)
  v_mfma_f32_32x32x16_bf16 v[144:159], v[32:35], v[56:59], v[144:159]
  v_add_f32 v31, v31, v24
  v_cvt_pk_bf16_f32 v68, v68, v24
  v_exp_f32 v66, v120
  v_fma_f32 v122, v122, s22, -v11
  v_mfma_f32_32x32x16_bf16 a[144:159], v[32:35], v[72:75], a[144:159]
  v_exp_f32 v24, v121
  v_add_f32 v31, v31, v69
  v_fma_f32 v123, v123, s22, -v11
  v_add_f32 v31, v31, v25
  s_waitcnt lgkmcnt(0)
  v_mfma_f32_32x32x16_bf16 v[144:159], v[36:39], v[60:63], v[144:159]
  v_exp_f32 v67, v122
  v_cvt_pk_bf16_f32 v69, v69, v25
  v_fma_f32 v124, v124, s22, -v11
  v_add_f32 v0, v66, v24
  v_mfma_f32_32x32x16_bf16 a[144:159], v[36:39], v[76:79], a[144:159]
  v_exp_f32 v25, v123
  v_fma_f32 v125, v125, s22, -v11
  ds_read_b64_tr_b16 v[44:45], v18 offset:0
  ds_read_b64_tr_b16 v[46:47], v19 offset:0
  s_waitcnt lgkmcnt(0)
  v_mfma_f32_32x32x16_bf16 v[160:175], v[44:47], v[56:59], v[160:175]
  v_exp_f32 v70, v124
  v_cvt_pk_bf16_f32 v66, v66, v24
  v_add_f32 v0, v0, v67
  v_fma_f32 v126, v126, s22, -v11
  v_mfma_f32_32x32x16_bf16 a[160:175], v[44:47], v[72:75], a[160:175]
  v_exp_f32 v24, v125
  v_add_f32 v0, v0, v25
  v_fma_f32 v127, v127, s22, -v11
  v_cvt_pk_bf16_f32 v67, v67, v25
  ds_read_b64_tr_b16 v[48:49], v18 offset:8192
  ds_read_b64_tr_b16 v[50:51], v19 offset:8192
  s_waitcnt lgkmcnt(0)
  v_mfma_f32_32x32x16_bf16 v[160:175], v[48:51], v[60:63], v[160:175]
  v_exp_f32 v71, v126
  v_add_f32 v0, v0, v70
  v_cvt_pk_bf16_f32 v70, v70, v24
  v_add_f32 v0, v0, v24
  v_mfma_f32_32x32x16_bf16 a[160:175], v[48:51], v[76:79], a[160:175]
  v_exp_f32 v25, v127
  v_add_f32 v0, v0, v71
  v_permlane16_swap_b32 v64, v66
  v_permlane16_swap_b32 v65, v67
  ds_read_b64_tr_b16 v[52:53], v20 offset:0
  ds_read_b64_tr_b16 v[54:55], v21 offset:0
  s_waitcnt lgkmcnt(0)
  v_mfma_f32_32x32x16_bf16 v[176:191], v[52:55], v[56:59], v[176:191]
  v_add_f32 v0, v0, v25
  v_cvt_pk_bf16_f32 v71, v71, v25
  v_max_f32 v29, v31, v0
  v_permlane16_swap_b32 v68, v70
  v_permlane16_swap_b32 v69, v71
  v_mfma_f32_32x32x16_bf16 a[176:191], v[52:55], v[72:75], a[176:191]
  v_cmp_lt_f32 vcc, s23, v29
  ds_read_b64_tr_b16 v[36:37], v20 offset:8192
  s_cbranch_vccnz RARE2
RET2:
  v_add_u32 v30, s57, v1
  ds_read_b64_tr_b16 v[38:39], v21 offset:8192
  s_waitcnt lgkmcnt(0)
  v_mfma_f32_32x32x16_bf16 v[176:191], v[36:39], v[60:63], v[176:191]
  ds_read_b128 v[40:43], v30 offset:0
  s_waitcnt vmcnt(8)
  s_barrier
  s_add_u32 m0, s21, 16384
  s_nop 0
  buffer_load_dwordx4 v2, s[8:11], s28 offen offset:0 lds
  s_cmp_lt_u32 s24, s77
  v_mfma_f32_32x32x16_bf16 a[176:191], v[36:39], v[76:79], a[176:191]
  buffer_load_dwordx4 v3, s[8:11], s28 offen offset:1024 lds
  buffer_load_dwordx4 v4, s[8:11], s28 offen offset:2048 lds
  buffer_load_dwordx4 v5, s[8:11], s28 offen offset:3072 lds
  s_cselect_b32 s86, s76, s27
  s_waitcnt lgkmcnt(0)
  buffer_store_dwordx4 v[40:43], v2, s[16:19], s86 offen offset:0 sc0 sc1
  s_nop 1
  ds_read_b64_tr_b16 v[40:41], v14 offset:256
  ds_read_b64_tr_b16 v[42:43], v15 offset:256
  s_waitcnt lgkmcnt(0)
  v_mfma_f32_32x32x16_bf16 v[192:207], v[40:43], v[56:59], v[192:207]
  ds_read_b128 v[32:35], v30 offset:1024
  ds_read_b64_tr_b16 v[44:45], v14 offset:8448
  ds_read_b64_tr_b16 v[46:47], v15 offset:8448
  ds_read_b64_tr_b16 v[52:53], v16 offset:256
  ds_read_b64_tr_b16 v[54:55], v17 offset:256
  v_mfma_f32_32x32x16_bf16 a[192:207], v[40:43], v[72:75], a[192:207]
  ds_read_b128 v[48:51], v30 offset:2048
  ds_read_b64_tr_b16 v[36:37], v18 offset:256
  ds_read_b64_tr_b16 v[38:39], v19 offset:256
  ds_read_b128 v[40:43], v30 offset:3072
  s_cmp_lg_u32 s26, 0
  s_waitcnt lgkmcnt(6)
  v_mfma_f32_32x32x16_bf16 v[192:207], v[44:47], v[60:63], v[192:207]
  v_fma_f32 v96, v96, s22, -v12
  v_fma_f32 v97, v97, s22, -v12
  v_fma_f32 v98, v98, s22, -v12
  v_fma_f32 v99, v99, s22, -v12
  v_fma_f32 v100, v100, s22, -v12
  v_mfma_f32_32x32x16_bf16 a[192:207], v[44:47], v[76:79], a[192:207]
  ds_read_b64_tr_b16 v[44:45], v18 offset:8448
  ds_read_b64_tr_b16 v[46:47], v19 offset:8448
  v_add_f32 v26, v26, v31
  v_fma_f32 v101, v101, s22, -v12
  v_fma_f32 v102, v102, s22, -v12
  s_waitcnt lgkmcnt(6)
  v_mfma_f32_32x32x16_bf16 v[208:223], v[52:55], v[56:59], v[208:223]
  v_fma_f32 v103, v103, s22, -v12
  buffer_store_dwordx4 v[32:35], v3, s[16:19], s86 offen offset:1024 sc0 sc1
  s_nop 1
  ds_read_b64_tr_b16 v[32:33], v16 offset:8448
  ds_read_b64_tr_b16 v[34:35], v17 offset:8448
  v_fma_f32 v104, v104, s22, -v13
  v_mfma_f32_32x32x16_bf16 a[208:223], v[52:55], v[72:75], a[208:223]
  ds_read_b128 v[52:55], v7 offset:40960
  s_waitcnt lgkmcnt(8)
  buffer_store_dwordx4 v[48:51], v4, s[16:19], s86 offen offset:2048 sc0 sc1
  s_nop 1
  ds_read_b64_tr_b16 v[48:49], v20 offset:256
  ds_read_b64_tr_b16 v[50:51], v21 offset:256
  s_waitcnt lgkmcnt(7)
  buffer_store_dwordx4 v[40:43], v5, s[16:19], s86 offen offset:3072 sc0 sc1
  s_waitcnt lgkmcnt(3)
  v_mfma_f32_32x32x16_bf16 v[208:223], v[32:35], v[60:63], v[208:223]
  ds_read_b128 v[40:43], v6 offset:32768
  v_fma_f32 v105, v105, s22, -v13
  v_fma_f32 v106, v106, s22, -v13
  v_fma_f32 v107, v107, s22, -v13
  v_fma_f32 v108, v108, s22, -v13
  v_mfma_f32_32x32x16_bf16 a[208:223], v[32:35], v[76:79], a[208:223]
  ds_read_b64_tr_b16 v[32:33], v20 offset:8448
  ds_read_b64_tr_b16 v[34:35], v21 offset:8448
  v_add_f32 v27, v27, v0
  v_fma_f32 v109, v109, s22, -v13
  v_fma_f32 v110, v110, s22, -v13
  v_mfma_f32_32x32x16_bf16 v[224:239], v[36:39], v[56:59], v[224:239]
  v_fma_f32 v111, v111, s22, -v13
  v_mfma_f32_32x32x16_bf16 a[224:239], v[36:39], v[72:75], a[224:239]
  ds_read_b128 v[36:39], v8 offset:40960
  v_mfma_f32_32x32x16_bf16 v[224:239], v[44:47], v[60:63], v[224:239]
  v_mfma_f32_32x32x16_bf16 a[224:239], v[44:47], v[76:79], a[224:239]
  ds_read_b128 v[44:47], v6 offset:40960
  s_waitcnt lgkmcnt(5)
  v_mfma_f32_32x32x16_bf16 v[240:255], v[48:51], v[56:59], v[240:255]
  v_exp_f32 v56, v96
  v_mfma_f32_32x32x16_bf16 a[240:255], v[48:51], v[72:75], a[240:255]
  ds_read_b128 v[48:51], v7 offset:32768
  v_exp_f32 v57, v98
  s_waitcnt lgkmcnt(3)
  v_mfma_f32_32x32x16_bf16 v[240:255], v[32:35], v[60:63], v[240:255]
  v_exp_f32 v60, v100
  v_mfma_f32_32x32x16_bf16 a[240:255], v[32:35], v[76:79], a[240:255]
  ds_read_b128 v[32:35], v8 offset:32768
  v_exp_f32 v61, v102
  v_mfma_f32_16x16x32_bf16 v[80:83], v[40:43], a[0:3], 0
  s_cbranch_scc1 RARE3
RET3:
  v_mfma_f32_16x16x32_bf16 v[88:91], v[40:43], a[32:35], 0
  v_exp_f32 v24, v97
  v_mfma_f32_16x16x32_bf16 v[112:115], v[40:43], a[64:67], 0
  v_exp_f32 v25, v99
  v_mfma_f32_16x16x32_bf16 v[120:123], v[40:43], a[96:99], 0
  ds_read_b128 v[40:43], v9 offset:32768
  v_add_f32 v31, v56, v24
  s_waitcnt lgkmcnt(3)
  v_mfma_f32_16x16x32_bf16 v[84:87], v[44:47], a[0:3], 0
  v_cvt_pk_bf16_f32 v56, v56, v24
  v_add_f32 v31, v31, v57
  v_mfma_f32_16x16x32_bf16 v[92:95], v[44:47], a[32:35], 0
  v_exp_f32 v24, v101
  v_mfma_f32_16x16x32_bf16 v[116:119], v[44:47], a[64:67], 0
  v_add_f32 v31, v31, v25
  v_cvt_pk_bf16_f32 v57, v57, v25
  v_mfma_f32_16x16x32_bf16 v[124:127], v[44:47], a[96:99], 0
  ds_read_b128 v[44:47], v9 offset:40960
  v_add_f32 v31, v31, v60
  s_waitcnt lgkmcnt(3)
  v_mfma_f32_16x16x32_bf16 v[80:83], v[48:51], a[4:7], v[80:83]
  v_exp_f32 v25, v103
  v_mfma_f32_16x16x32_bf16 v[88:91], v[48:51], a[36:39], v[88:91]
  v_add_f32 v31, v31, v24
  v_cvt_pk_bf16_f32 v60, v60, v24
  v_mfma_f32_16x16x32_bf16 v[112:115], v[48:51], a[68:71], v[112:115]
  v_exp_f32 v58, v104
  v_mfma_f32_16x16x32_bf16 v[120:123], v[48:51], a[100:103], v[120:123]
  ds_read_b128 v[48:51], v6 offset:33024
  v_add_f32 v31, v31, v61
  v_mfma_f32_16x16x32_bf16 v[84:87], v[52:55], a[4:7], v[84:87]
  v_exp_f32 v24, v105
  v_mfma_f32_16x16x32_bf16 v[92:95], v[52:55], a[36:39], v[92:95]
  v_exp_f32 v59, v106
  v_mfma_f32_16x16x32_bf16 v[116:119], v[52:55], a[68:71], v[116:119]
  v_add_f32 v31, v31, v25
  v_cvt_pk_bf16_f32 v61, v61, v25
  v_mfma_f32_16x16x32_bf16 v[124:127], v[52:55], a[100:103], v[124:127]
  ds_read_b128 v[52:55], v6 offset:41216
  v_add_f32 v0, v58, v24
  s_waitcnt lgkmcnt(4)
  v_mfma_f32_16x16x32_bf16 v[80:83], v[32:35], a[8:11], v[80:83]
  v_exp_f32 v25, v107
  v_mfma_f32_16x16x32_bf16 v[88:91], v[32:35], a[40:43], v[88:91]
  v_exp_f32 v62, v108
  v_mfma_f32_16x16x32_bf16 v[112:115], v[32:35], a[72:75], v[112:115]
  v_cvt_pk_bf16_f32 v58, v58, v24
  v_add_f32 v0, v0, v59
  v_mfma_f32_16x16x32_bf16 v[120:123], v[32:35], a[104:107], v[120:123]
  s_barrier
  s_add_u32 m0, s21, 49152
  v_mfma_f32_16x16x32_bf16 v[84:87], v[36:39], a[8:11], v[84:87]
  buffer_load_dwordx4 v2, s[12:15], s35 offen offset:0 lds
  v_mfma_f32_16x16x32_bf16 v[92:95], v[36:39], a[40:43], v[92:95]
  ds_read_b128 v[32:35], v7 offset:33024
  v_add_f32 v0, v0, v25
  v_mfma_f32_16x16x32_bf16 v[116:119], v[36:39], a[72:75], v[116:119]
  v_exp_f32 v24, v109
  v_mfma_f32_16x16x32_bf16 v[124:127], v[36:39], a[104:107], v[124:127]
  buffer_load_dwordx4 v3, s[12:15], s35 offen offset:1024 lds
  s_waitcnt lgkmcnt(4)
  v_mfma_f32_16x16x32_bf16 v[80:83], v[40:43], a[12:15], v[80:83]
  ds_read_b128 v[36:39], v7 offset:41216
  v_cvt_pk_bf16_f32 v59, v59, v25
  v_mfma_f32_16x16x32_bf16 v[88:91], v[40:43], a[44:47], v[88:91]
  v_exp_f32 v63, v110
  v_mfma_f32_16x16x32_bf16 v[112:115], v[40:43], a[76:79], v[112:115]
  v_add_f32 v0, v0, v62
  v_cvt_pk_bf16_f32 v62, v62, v24
  v_mfma_f32_16x16x32_bf16 v[120:123], v[40:43], a[108:111], v[120:123]
  buffer_load_dwordx4 v4, s[12:15], s35 offen offset:2048 lds
  s_waitcnt lgkmcnt(4)
  v_mfma_f32_16x16x32_bf16 v[84:87], v[44:47], a[12:15], v[84:87]
  ds_read_b128 v[40:43], v8 offset:33024
  v_add_f32 v0, v0, v24
  v_mfma_f32_16x16x32_bf16 v[92:95], v[44:47], a[44:47], v[92:95]
  v_exp_f32 v25, v111
  v_mfma_f32_16x16x32_bf16 v[116:119], v[44:47], a[76:79], v[116:119]
  v_add_f32 v0, v0, v63
  v_permlane16_swap_b32 v56, v58
  v_mfma_f32_16x16x32_bf16 v[124:127], v[44:47], a[108:111], v[124:127]
  buffer_load_dwordx4 v5, s[12:15], s35 offen offset:3072 lds
  s_waitcnt lgkmcnt(4)
  v_mfma_f32_16x16x32_bf16 v[80:83], v[48:51], a[16:19], v[80:83]
  ds_read_b128 v[44:47], v8 offset:41216
  v_add_f32 v0, v0, v25
  v_mfma_f32_16x16x32_bf16 v[88:91], v[48:51], a[48:51], v[88:91]
  v_cvt_pk_bf16_f32 v63, v63, v25
  v_max_f32 v29, v31, v0
  v_mfma_f32_16x16x32_bf16 v[112:115], v[48:51], a[80:83], v[112:115]
  v_permlane16_swap_b32 v57, v59
  v_permlane16_swap_b32 v60, v62
  v_mfma_f32_16x16x32_bf16 v[120:123], v[48:51], a[112:115], v[120:123]
  ds_read_b128 v[48:51], v9 offset:33024
  v_permlane16_swap_b32 v61, v63
  s_waitcnt lgkmcnt(5)
  v_mfma_f32_16x16x32_bf16 v[84:87], v[52:55], a[16:19], v[84:87]
  v_cmp_lt_f32 vcc, s23, v29
  v_mfma_f32_16x16x32_bf16 v[92:95], v[52:55], a[48:51], v[92:95]
  s_cbranch_vccnz RARE4
RET4:
  v_add_f32 v22, v22, v31
  v_mfma_f32_16x16x32_bf16 v[116:119], v[52:55], a[80:83], v[116:119]
  v_add_f32 v23, v23, v0
  v_mfma_f32_16x16x32_bf16 v[124:127], v[52:55], a[112:115], v[124:127]
  ds_read_b128 v[52:55], v9 offset:41216
  s_waitcnt lgkmcnt(5)
  v_mfma_f32_16x16x32_bf16 v[80:83], v[32:35], a[20:23], v[80:83]
  v_mfma_f32_16x16x32_bf16 v[88:91], v[32:35], a[52:55], v[88:91]
  v_mfma_f32_16x16x32_bf16 v[112:115], v[32:35], a[84:87], v[112:115]
  v_mfma_f32_16x16x32_bf16 v[120:123], v[32:35], a[116:119], v[120:123]
  ds_read_b64_tr_b16 v[32:33], v14 offset:16384
  ds_read_b64_tr_b16 v[34:35], v15 offset:16384
  s_waitcnt lgkmcnt(6)
  v_mfma_f32_16x16x32_bf16 v[84:87], v[36:39], a[20:23], v[84:87]
  v_mfma_f32_16x16x32_bf16 v[92:95], v[36:39], a[52:55], v[92:95]
  v_mfma_f32_16x16x32_bf16 v[116:119], v[36:39], a[84:87], v[116:119]
  v_mfma_f32_16x16x32_bf16 v[124:127], v[36:39], a[116:119], v[124:127]
  ds_read_b64_tr_b16 v[36:37], v14 offset:24576
  ds_read_b64_tr_b16 v[38:39], v15 offset:24576
  s_waitcnt lgkmcnt(7)
  v_mfma_f32_16x16x32_bf16 v[80:83], v[40:43], a[24:27], v[80:83]
  v_mfma_f32_16x16x32_bf16 v[88:91], v[40:43], a[56:59], v[88:91]
  v_mfma_f32_16x16x32_bf16 v[112:115], v[40:43], a[88:91], v[112:115]
  v_mfma_f32_16x16x32_bf16 v[120:123], v[40:43], a[120:123], v[120:123]
  ds_read_b64_tr_b16 v[40:41], v16 offset:16384
  ds_read_b64_tr_b16 v[42:43], v17 offset:16384
  s_waitcnt lgkmcnt(8)
  v_mfma_f32_16x16x32_bf16 v[84:87], v[44:47], a[24:27], v[84:87]
  v_mfma_f32_16x16x32_bf16 v[92:95], v[44:47], a[56:59], v[92:95]
  v_mfma_f32_16x16x32_bf16 v[116:119], v[44:47], a[88:91], v[116:119]
  v_mfma_f32_16x16x32_bf16 v[124:127], v[44:47], a[120:123], v[124:127]
  ds_read_b64_tr_b16 v[44:45], v16 offset:24576
  ds_read_b64_tr_b16 v[46:47], v17 offset:24576
  s_waitcnt lgkmcnt(9)
  v_mfma_f32_16x16x32_bf16 v[80:83], v[48:51], a[28:31], v[80:83]
  v_mfma_f32_16x16x32_bf16 v[88:91], v[48:51], a[60:63], v[88:91]
  v_mfma_f32_16x16x32_bf16 v[112:115], v[48:51], a[92:95], v[112:115]
  s_nop 5
  v_fma_f32 v80, v80, s22, -v10
  v_fma_f32 v81, v81, s22, -v10
  v_mfma_f32_16x16x32_bf16 v[120:123], v[48:51], a[124:127], v[120:123]
  ds_read_b64_tr_b16 v[48:49], v18 offset:16384
  ds_read_b64_tr_b16 v[50:51], v19 offset:16384
  s_waitcnt lgkmcnt(10)
  v_mfma_f32_16x16x32_bf16 v[84:87], v[52:55], a[28:31], v[84:87]
  v_exp_f32 v72, v80
  v_mfma_f32_16x16x32_bf16 v[92:95], v[52:55], a[60:63], v[92:95]
  v_exp_f32 v24, v81
  v_mfma_f32_16x16x32_bf16 v[116:119], v[52:55], a[92:95], v[116:119]
  v_fma_f32 v82, v82, s22, -v10
  v_fma_f32 v83, v83, s22, -v10
  v_mfma_f32_16x16x32_bf16 v[124:127], v[52:55], a[124:127], v[124:127]
  ds_read_b64_tr_b16 v[52:53], v18 offset:24576
  ds_read_b64_tr_b16 v[54:55], v19 offset:24576
  s_waitcnt lgkmcnt(10)
  v_mfma_f32_32x32x16_bf16 v[128:143], v[32:35], v[64:67], v[128:143]
  v_exp_f32 v73, v82
  v_fma_f32 v84, v84, s22, -v10
  v_add_f32 v31, v72, v24
  v_fma_f32 v85, v85, s22, -v10
  v_mfma_f32_32x32x16_bf16 a[128:143], v[32:35], v[56:59], a[128:143]
  ds_read_b64_tr_b16 v[32:33], v20 offset:16384
  ds_read_b64_tr_b16 v[34:35], v21 offset:16384
  v_exp_f32 v25, v83
  v_cvt_pk_bf16_f32 v72, v72, v24
  s_waitcnt lgkmcnt(10)
  v_mfma_f32_32x32x16_bf16 v[128:143], v[36:39], v[68:71], v[128:143]
  v_exp_f32 v76, v84
  v_add_f32 v31, v31, v73
  v_fma_f32 v86, v86, s22, -v10
  v_add_f32 v31, v31, v25
  v_mfma_f32_32x32x16_bf16 a[128:143], v[36:39], v[60:63], a[128:143]
  ds_read_b64_tr_b16 v[36:37], v20 offset:24576
  ds_read_b64_tr_b16 v[38:39], v21 offset:24576
  v_exp_f32 v24, v85
  v_fma_f32 v87, v87, s22, -v10
  s_waitcnt lgkmcnt(10)
  v_mfma_f32_32x32x16_bf16 v[144:159], v[40:43], v[64:67], v[144:159]
  v_exp_f32 v77, v86
  v_cvt_pk_bf16_f32 v73, v73, v25
  v_add_f32 v31, v31, v76
  v_fma_f32 v88, v88, s22, -v11
  v_mfma_f32_32x32x16_bf16 a[144:159], v[40:43], v[56:59], a[144:159]
  ds_read_b64_tr_b16 v[40:41], v14 offset:16640
  ds_read_b64_tr_b16 v[42:43], v15 offset:16640
  v_exp_f32 v25, v87
  v_fma_f32 v89, v89, s22, -v11
  s_waitcnt lgkmcnt(10)
  v_mfma_f32_32x32x16_bf16 v[144:159], v[44:47], v[68:71], v[144:159]
  v_add_f32 v31, v31, v24
  v_cvt_pk_bf16_f32 v76, v76, v24
  v_exp_f32 v74, v88
  v_fma_f32 v90, v90, s22, -v11
  v_mfma_f32_32x32x16_bf16 a[144:159], v[44:47], v[60:63], a[144:159]
  ds_read_b64_tr_b16 v[44:45], v14 offset:24832
  ds_read_b64_tr_b16 v[46:47], v15 offset:24832
  v_exp_f32 v24, v89
  v_add_f32 v31, v31, v77
  s_waitcnt lgkmcnt(10)
  v_mfma_f32_32x32x16_bf16 v[160:175], v[48:51], v[64:67], v[160:175]
  v_exp_f32 v75, v90
  v_fma_f32 v91, v91, s22, -v11
  v_add_f32 v31, v31, v25
  v_cvt_pk_bf16_f32 v77, v77, v25
  v_mfma_f32_32x32x16_bf16 a[160:175], v[48:51], v[56:59], a[160:175]
  s_waitcnt vmcnt(16)
  s_barrier
  s_add_u32 m0, s21, 32768
  s_nop 0
  buffer_load_dwordx4 v2, s[8:11], s29 offen offset:0 lds
  ds_read_b64_tr_b16 v[48:49], v16 offset:16640
  ds_read_b64_tr_b16 v[50:51], v17 offset:16640
  s_waitcnt lgkmcnt(10)
  v_mfma_f32_32x32x16_bf16 v[160:175], v[52:55], v[68:71], v[160:175]
  v_exp_f32 v25, v91
  v_fma_f32 v92, v92, s22, -v11
  v_add_f32 v0, v74, v24
  v_fma_f32 v93, v93, s22, -v11
  v_mfma_f32_32x32x16_bf16 a[160:175], v[52:55], v[60:63], a[160:175]
  buffer_load_dwordx4 v3, s[8:11], s29 offen offset:1024 lds
  ds_read_b64_tr_b16 v[52:53], v16 offset:24832
  ds_read_b64_tr_b16 v[54:55], v17 offset:24832
  v_exp_f32 v78, v92
  s_waitcnt lgkmcnt(10)
  v_mfma_f32_32x32x16_bf16 v[176:191], v[32:35], v[64:67], v[176:191]
  v_cvt_pk_bf16_f32 v74, v74, v24
  v_add_f32 v0, v0, v75
  v_exp_f32 v24, v93
  v_fma_f32 v94, v94, s22, -v11
  v_mfma_f32_32x32x16_bf16 a[176:191], v[32:35], v[56:59], a[176:191]
  buffer_load_dwordx4 v4, s[8:11], s29 offen offset:2048 lds
  ds_read_b64_tr_b16 v[32:33], v18 offset:16640
  ds_read_b64_tr_b16 v[34:35], v19 offset:16640
  v_add_f32 v0, v0, v25
  s_waitcnt lgkmcnt(10)
  v_mfma_f32_32x32x16_bf16 v[176:191], v[36:39], v[68:71], v[176:191]
  v_exp_f32 v79, v94
  v_fma_f32 v95, v95, s22, -v11
  v_cvt_pk_bf16_f32 v75, v75, v25
  v_add_f32 v0, v0, v78
  v_mfma_f32_32x32x16_bf16 a[176:191], v[36:39], v[60:63], a[176:191]
  buffer_load_dwordx4 v5, s[8:11], s29 offen offset:3072 lds
  ds_read_b64_tr_b16 v[36:37], v18 offset:24832
  ds_read_b64_tr_b16 v[38:39], v19 offset:24832
  v_exp_f32 v25, v95
  s_waitcnt lgkmcnt(10)
  v_mfma_f32_32x32x16_bf16 v[192:207], v[40:43], v[64:67], v[192:207]
  v_add_f32 v0, v0, v24
  v_cvt_pk_bf16_f32 v78, v78, v24
  v_add_f32 v0, v0, v79
  v_cvt_pk_bf16_f32 v79, v79, v25
  v_add_f32 v0, v0, v25
  v_mfma_f32_32x32x16_bf16 a[192:207], v[40:43], v[56:59], a[192:207]
  ds_read_b64_tr_b16 v[40:41], v20 offset:16640
  ds_read_b64_tr_b16 v[42:43], v21 offset:16640
  v_max_f32 v29, v31, v0
  v_permlane16_swap_b32 v72, v74
  v_permlane16_swap_b32 v73, v75
  s_waitcnt lgkmcnt(10)
  v_mfma_f32_32x32x16_bf16 v[192:207], v[44:47], v[68:71], v[192:207]
  s_mov_b32 m0, s57
  s_nop 0
  buffer_load_dwordx4 v2, s[4:7], s56 offen offset:0 lds
  v_permlane16_swap_b32 v76, v78
  v_permlane16_swap_b32 v77, v79
  v_cmp_lt_f32 vcc, s23, v29
  v_mfma_f32_32x32x16_bf16 a[192:207], v[44:47], v[60:63], a[192:207]
  ds_read_b64_tr_b16 v[44:45], v20 offset:24832
  ds_read_b64_tr_b16 v[46:47], v21 offset:24832
  s_cbranch_vccnz RARE5
RET5:
  s_cmp_lg_u32 s26, 0
  v_fma_f32 v112, v112, s22, -v12
  s_waitcnt lgkmcnt(10)
  v_mfma_f32_32x32x16_bf16 v[208:223], v[48:51], v[64:67], v[208:223]
  buffer_load_dwordx4 v3, s[4:7], s56 offen offset:1024 lds
  v_fma_f32 v113, v113, s22, -v12
  v_fma_f32 v114, v114, s22, -v12
  v_fma_f32 v115, v115, s22, -v12
  v_mfma_f32_32x32x16_bf16 a[208:223], v[48:51], v[56:59], a[208:223]
  ds_read_b128 v[48:51], v6 offset:0
  v_fma_f32 v116, v116, s22, -v12
  v_add_f32 v26, v26, v31
  v_fma_f32 v117, v117, s22, -v12
  v_fma_f32 v118, v118, s22, -v12
  s_waitcnt lgkmcnt(9)
  v_mfma_f32_32x32x16_bf16 v[208:223], v[52:55], v[68:71], v[208:223]
  buffer_load_dwordx4 v4, s[4:7], s56 offen offset:2048 lds
  v_fma_f32 v119, v119, s22, -v12
  v_fma_f32 v120, v120, s22, -v13
  v_fma_f32 v121, v121, s22, -v13
  v_mfma_f32_32x32x16_bf16 a[208:223], v[52:55], v[60:63], a[208:223]
  ds_read_b128 v[52:55], v6 offset:8192
  v_fma_f32 v122, v122, s22, -v13
  v_fma_f32 v123, v123, s22, -v13
  v_fma_f32 v124, v124, s22, -v13
  v_add_f32 v27, v27, v0
  s_waitcnt lgkmcnt(8)
  v_mfma_f32_32x32x16_bf16 v[224:239], v[32:35], v[64:67], v[224:239]
  buffer_load_dwordx4 v5, s[4:7], s56 offen offset:3072 lds
  v_fma_f32 v125, v125, s22, -v13
  v_fma_f32 v126, v126, s22, -v13
  v_fma_f32 v127, v127, s22, -v13
  v_mfma_f32_32x32x16_bf16 a[224:239], v[32:35], v[56:59], a[224:239]
  ds_read_b128 v[32:35], v7 offset:0
  s_waitcnt lgkmcnt(7)
  v_mfma_f32_32x32x16_bf16 v[224:239], v[36:39], v[68:71], v[224:239]
  v_mfma_f32_32x32x16_bf16 a[224:239], v[36:39], v[60:63], a[224:239]
  ds_read_b128 v[36:39], v7 offset:8192
  s_waitcnt lgkmcnt(6)
  v_mfma_f32_32x32x16_bf16 v[240:255], v[40:43], v[64:67], v[240:255]
  v_exp_f32 v64, v112
  v_mfma_f32_32x32x16_bf16 a[240:255], v[40:43], v[56:59], a[240:255]
  ds_read_b128 v[40:43], v8 offset:0
  v_exp_f32 v65, v114
  s_waitcnt lgkmcnt(5)
  v_mfma_f32_32x32x16_bf16 v[240:255], v[44:47], v[68:71], v[240:255]
  v_exp_f32 v68, v116
  v_mfma_f32_32x32x16_bf16 a[240:255], v[44:47], v[60:63], a[240:255]
  ds_read_b128 v[44:47], v8 offset:8192
  v_exp_f32 v69, v118
  s_waitcnt lgkmcnt(5)
  v_mfma_f32_16x16x32_bf16 v[96:99], v[48:51], a[0:3], 0
  s_cbranch_scc1 RARE6
RET6:
  v_mfma_f32_16x16x32_bf16 v[104:107], v[48:51], a[32:35], 0
  v_exp_f32 v24, v113
  v_mfma_f32_16x16x32_bf16 v[80:83], v[48:51], a[64:67], 0
  v_exp_f32 v25, v115
  v_mfma_f32_16x16x32_bf16 v[88:91], v[48:51], a[96:99], 0
  ds_read_b128 v[48:51], v9 offset:0
  v_add_f32 v31, v64, v24
  s_waitcnt lgkmcnt(5)
  v_mfma_f32_16x16x32_bf16 v[100:103], v[52:55], a[0:3], 0
  v_cvt_pk_bf16_f32 v64, v64, v24
  v_add_f32 v31, v31, v65
  v_mfma_f32_16x16x32_bf16 v[108:111], v[52:55], a[32:35], 0
  v_exp_f32 v24, v117
  v_mfma_f32_16x16x32_bf16 v[84:87], v[52:55], a[64:67], 0
  v_add_f32 v31, v31, v25
  v_cvt_pk_bf16_f32 v65, v65, v25
  v_mfma_f32_16x16x32_bf16 v[92:95], v[52:55], a[96:99], 0
  ds_read_b128 v[52:55], v9 offset:8192
  v_add_f32 v31, v31, v68
  s_waitcnt lgkmcnt(5)
  v_mfma_f32_16x16x32_bf16 v[96:99], v[32:35], a[4:7], v[96:99]
  v_exp_f32 v25, v119
  v_mfma_f32_16x16x32_bf16 v[104:107], v[32:35], a[36:39], v[104:107]
  v_add_f32 v31, v31, v24
  v_cvt_pk_bf16_f32 v68, v68, v24
  v_mfma_f32_16x16x32_bf16 v[80:83], v[32:35], a[68:71], v[80:83]
  v_exp_f32 v66, v120
  v_mfma_f32_16x16x32_bf16 v[88:91], v[32:35], a[100:103], v[88:91]
  ds_read_b128 v[32:35], v6 offset:256
  v_add_f32 v31, v31, v69
  s_waitcnt lgkmcnt(5)
  v_mfma_f32_16x16x32_bf16 v[100:103], v[36:39], a[4:7], v[100:103]
  v_exp_f32 v24, v121
  v_mfma_f32_16x16x32_bf16 v[108:111], v[36:39], a[36:39], v[108:111]
  v_exp_f32 v67, v122
  v_mfma_f32_16x16x32_bf16 v[84:87], v[36:39], a[68:71], v[84:87]
  v_add_f32 v31, v31, v25
  v_cvt_pk_bf16_f32 v69, v69, v25
  v_mfma_f32_16x16x32_bf16 v[92:95], v[36:39], a[100:103], v[92:95]
  ds_read_b128 v[36:39], v6 offset:8448
  v_add_f32 v0, v66, v24
  s_waitcnt lgkmcnt(5)
  v_mfma_f32_16x16x32_bf16 v[96:99], v[40:43], a[8:11], v[96:99]
  v_exp_f32 v25, v123
  v_mfma_f32_16x16x32_bf16 v[104:107], v[40:43], a[40:43], v[104:107]
  v_exp_f32 v70, v124
  v_mfma_f32_16x16x32_bf16 v[80:83], v[40:43], a[72:75], v[80:83]
  v_cvt_pk_bf16_f32 v66, v66, v24
  v_add_f32 v0, v0, v67
  v_mfma_f32_16x16x32_bf16 v[88:91], v[40:43], a[104:107], v[88:91]
  s_waitcnt vmcnt(20)
  s_barrier
  s_add_u32 m0, s21, 65536
  s_waitcnt lgkmcnt(4)
  v_mfma_f32_16x16x32_bf16 v[100:103], v[44:47], a[8:11], v[100:103]
  buffer_load_dwordx4 v2, s[12:15], s36 offen offset:0 lds
  v_mfma_f32_16x16x32_bf16 v[108:111], v[44:47], a[40:43], v[108:111]
  ds_read_b128 v[40:43], v7 offset:256
  v_add_f32 v0, v0, v25
  v_mfma_f32_16x16x32_bf16 v[84:87], v[44:47], a[72:75], v[84:87]
  v_exp_f32 v24, v125
  v_mfma_f32_16x16x32_bf16 v[92:95], v[44:47], a[104:107], v[92:95]
  buffer_load_dwordx4 v3, s[12:15], s36 offen offset:1024 lds
  s_waitcnt lgkmcnt(4)
  v_mfma_f32_16x16x32_bf16 v[96:99], v[48:51], a[12:15], v[96:99]
  ds_read_b128 v[44:47], v7 offset:8448
  v_cvt_pk_bf16_f32 v67, v67, v25
  v_mfma_f32_16x16x32_bf16 v[104:107], v[48:51], a[44:47], v[104:107]
  v_exp_f32 v71, v126
  v_mfma_f32_16x16x32_bf16 v[80:83], v[48:51], a[76:79], v[80:83]
  v_add_f32 v0, v0, v70
  v_cvt_pk_bf16_f32 v70, v70, v24
  v_mfma_f32_16x16x32_bf16 v[88:91], v[48:51], a[108:111], v[88:91]
  buffer_load_dwordx4 v4, s[12:15], s36 offen offset:2048 lds
  s_waitcnt lgkmcnt(4)
  v_mfma_f32_16x16x32_bf16 v[100:103], v[52:55], a[12:15], v[100:103]
  ds_read_b128 v[48:51], v8 offset:256
  v_add_f32 v0, v0, v24
  v_mfma_f32_16x16x32_bf16 v[108:111], v[52:55], a[44:47], v[108:111]
  v_exp_f32 v25, v127
  v_mfma_f32_16x16x32_bf16 v[84:87], v[52:55], a[76:79], v[84:87]
  v_add_f32 v0, v0, v71
  v_permlane16_swap_b32 v64, v66
  v_mfma_f32_16x16x32_bf16 v[92:95], v[52:55], a[108:111], v[92:95]
  buffer_load_dwordx4 v5, s[12:15], s36 offen offset:3072 lds
  s_waitcnt lgkmcnt(4)
  v_mfma_f32_16x16x32_bf16 v[96:99], v[32:35], a[16:19], v[96:99]
  ds_read_b128 v[52:55], v8 offset:8448
  v_add_f32 v0, v0, v25
  v_mfma_f32_16x16x32_bf16 v[104:107], v[32:35], a[48:51], v[104:107]
  v_cvt_pk_bf16_f32 v71, v71, v25
  v_max_f32 v29, v31, v0
  v_mfma_f32_16x16x32_bf16 v[80:83], v[32:35], a[80:83], v[80:83]
  v_permlane16_swap_b32 v65, v67
  v_permlane16_swap_b32 v68, v70
  v_mfma_f32_16x16x32_bf16 v[88:91], v[32:35], a[112:115], v[88:91]
  ds_read_b128 v[32:35], v9 offset:256
  v_permlane16_swap_b32 v69, v71
  s_waitcnt lgkmcnt(5)
  v_mfma_f32_16x16x32_bf16 v[100:103], v[36:39], a[16:19], v[100:103]
  v_cmp_lt_f32 vcc, s23, v29
  v_mfma_f32_16x16x32_bf16 v[108:111], v[36:39], a[48:51], v[108:111]
  s_cbranch_vccnz RARE7
RET7:
  v_add_f32 v22, v22, v31
  v_mfma_f32_16x16x32_bf16 v[84:87], v[36:39], a[80:83], v[84:87]
  v_add_f32 v23, v23, v0
  v_mfma_f32_16x16x32_bf16 v[92:95], v[36:39], a[112:115], v[92:95]
  ds_read_b128 v[36:39], v9 offset:8448
  s_waitcnt lgkmcnt(5)
  v_mfma_f32_16x16x32_bf16 v[96:99], v[40:43], a[20:23], v[96:99]
  v_mfma_f32_16x16x32_bf16 v[104:107], v[40:43], a[52:55], v[104:107]
  v_mfma_f32_16x16x32_bf16 v[80:83], v[40:43], a[84:87], v[80:83]
  v_mfma_f32_16x16x32_bf16 v[88:91], v[40:43], a[116:119], v[88:91]
  ds_read_b64_tr_b16 v[40:41], v14 offset:32768
  ds_read_b64_tr_b16 v[42:43], v15 offset:32768
  s_waitcnt lgkmcnt(6)
  v_mfma_f32_16x16x32_bf16 v[100:103], v[44:47], a[20:23], v[100:103]
  v_mfma_f32_16x16x32_bf16 v[108:111], v[44:47], a[52:55], v[108:111]
  v_mfma_f32_16x16x32_bf16 v[84:87], v[44:47], a[84:87], v[84:87]
  v_mfma_f32_16x16x32_bf16 v[92:95], v[44:47], a[116:119], v[92:95]
  ds_read_b64_tr_b16 v[44:45], v14 offset:40960
  ds_read_b64_tr_b16 v[46:47], v15 offset:40960
  s_waitcnt lgkmcnt(7)
  v_mfma_f32_16x16x32_bf16 v[96:99], v[48:51], a[24:27], v[96:99]
  v_mfma_f32_16x16x32_bf16 v[104:107], v[48:51], a[56:59], v[104:107]
  v_mfma_f32_16x16x32_bf16 v[80:83], v[48:51], a[88:91], v[80:83]
  v_mfma_f32_16x16x32_bf16 v[88:91], v[48:51], a[120:123], v[88:91]
  ds_read_b64_tr_b16 v[48:49], v16 offset:32768
  ds_read_b64_tr_b16 v[50:51], v17 offset:32768
  s_waitcnt lgkmcnt(8)
  v_mfma_f32_16x16x32_bf16 v[100:103], v[52:55], a[24:27], v[100:103]
  v_mfma_f32_16x16x32_bf16 v[108:111], v[52:55], a[56:59], v[108:111]
  v_mfma_f32_16x16x32_bf16 v[84:87], v[52:55], a[88:91], v[84:87]
  v_mfma_f32_16x16x32_bf16 v[92:95], v[52:55], a[120:123], v[92:95]
  ds_read_b64_tr_b16 v[52:53], v16 offset:40960
  ds_read_b64_tr_b16 v[54:55], v17 offset:40960
  s_waitcnt lgkmcnt(9)
  v_mfma_f32_16x16x32_bf16 v[96:99], v[32:35], a[28:31], v[96:99]
  v_mfma_f32_16x16x32_bf16 v[104:107], v[32:35], a[60:63], v[104:107]
  v_mfma_f32_16x16x32_bf16 v[80:83], v[32:35], a[92:95], v[80:83]
  s_nop 5
  v_fma_f32 v96, v96, s22, -v10
  v_fma_f32 v97, v97, s22, -v10
  v_mfma_f32_16x16x32_bf16 v[88:91], v[32:35], a[124:127], v[88:91]
  ds_read_b64_tr_b16 v[32:33], v18 offset:32768
  ds_read_b64_tr_b16 v[34:35], v19 offset:32768
  s_waitcnt lgkmcnt(10)
  v_mfma_f32_16x16x32_bf16 v[100:103], v[36:39], a[28:31], v[100:103]
  v_exp_f32 v56, v96
  v_mfma_f32_16x16x32_bf16 v[108:111], v[36:39], a[60:63], v[108:111]
  v_exp_f32 v24, v97
  v_mfma_f32_16x16x32_bf16 v[84:87], v[36:39], a[92:95], v[84:87]
  v_fma_f32 v98, v98, s22, -v10
  v_fma_f32 v99, v99, s22, -v10
  v_mfma_f32_16x16x32_bf16 v[92:95], v[36:39], a[124:127], v[92:95]
  ds_read_b64_tr_b16 v[36:37], v18 offset:40960
  ds_read_b64_tr_b16 v[38:39], v19 offset:40960
  s_waitcnt lgkmcnt(10)
  v_mfma_f32_32x32x16_bf16 v[128:143], v[40:43], v[72:75], v[128:143]
  v_exp_f32 v57, v98
  v_fma_f32 v100, v100, s22, -v10
  v_add_f32 v31, v56, v24
  v_fma_f32 v101, v101, s22, -v10
  v_mfma_f32_32x32x16_bf16 a[128:143], v[40:43], v[64:67], a[128:143]
  ds_read_b64_tr_b16 v[40:41], v20 offset:32768
  ds_read_b64_tr_b16 v[42:43], v21 offset:32768
  v_exp_f32 v25, v99
  v_cvt_pk_bf16_f32 v56, v56, v24
  s_waitcnt lgkmcnt(10)
  v_mfma_f32_32x32x16_bf16 v[128:143], v[44:47], v[76:79], v[128:143]
  v_exp_f32 v60, v100
  v_add_f32 v31, v31, v57
  v_fma_f32 v102, v102, s22, -v10
  v_add_f32 v31, v31, v25
  v_mfma_f32_32x32x16_bf16 a[128:143], v[44:47], v[68:71], a[128:143]
  ds_read_b64_tr_b16 v[44:45], v20 offset:40960
  ds_read_b64_tr_b16 v[46:47], v21 offset:40960
  v_exp_f32 v24, v101
  v_fma_f32 v103, v103, s22, -v10
  s_waitcnt lgkmcnt(10)
  v_mfma_f32_32x32x16_bf16 v[144:159], v[48:51], v[72:75], v[144:159]
  v_exp_f32 v61, v102
  v_cvt_pk_bf16_f32 v57, v57, v25
  v_add_f32 v31, v31, v60
  v_fma_f32 v104, v104, s22, -v11
  v_mfma_f32_32x32x16_bf16 a[144:159], v[48:51], v[64:67], a[144:159]
  ds_read_b64_tr_b16 v[48:49], v14 offset:33024
  ds_read_b64_tr_b16 v[50:51], v15 offset:33024
  v_exp_f32 v25, v103
  v_fma_f32 v105, v105, s22, -v11
  s_waitcnt lgkmcnt(10)
  v_mfma_f32_32x32x16_bf16 v[144:159], v[52:55], v[76:79], v[144:159]
  v_add_f32 v31, v31, v24
  v_cvt_pk_bf16_f32 v60, v60, v24
  v_exp_f32 v58, v104
  v_fma_f32 v106, v106, s22, -v11
  v_mfma_f32_32x32x16_bf16 a[144:159], v[52:55], v[68:71], a[144:159]
  ds_read_b64_tr_b16 v[52:53], v14 offset:41216
  ds_read_b64_tr_b16 v[54:55], v15 offset:41216
  v_exp_f32 v24, v105
  v_add_f32 v31, v31, v61
  s_waitcnt lgkmcnt(10)
  v_mfma_f32_32x32x16_bf16 v[160:175], v[32:35], v[72:75], v[160:175]
  v_exp_f32 v59, v106
  v_fma_f32 v107, v107, s22, -v11
  v_add_f32 v31, v31, v25
  v_cvt_pk_bf16_f32 v61, v61, v25
  v_mfma_f32_32x32x16_bf16 a[160:175], v[32:35], v[64:67], a[160:175]
  s_waitcnt vmcnt(20)
  s_barrier
  s_add_u32 m0, s21, 0
  s_nop 0
  buffer_load_dwordx4 v2, s[8:11], s30 offen offset:0 lds
  ds_read_b64_tr_b16 v[32:33], v16 offset:33024
  ds_read_b64_tr_b16 v[34:35], v17 offset:33024
  s_waitcnt lgkmcnt(10)
  v_mfma_f32_32x32x16_bf16 v[160:175], v[36:39], v[76:79], v[160:175]
  s_add_u32 s28, s28, 49152
  v_exp_f32 v25, v107
  v_fma_f32 v108, v108, s22, -v11
  s_and_b32 s28, s28, 0x3ffff
  v_add_f32 v0, v58, v24
  v_mfma_f32_32x32x16_bf16 a[160:175], v[36:39], v[68:71], a[160:175]
  buffer_load_dwordx4 v3, s[8:11], s30 offen offset:1024 lds
  ds_read_b64_tr_b16 v[36:37], v16 offset:41216
  ds_read_b64_tr_b16 v[38:39], v17 offset:41216
  s_or_b32 s28, s28, s94
  v_fma_f32 v109, v109, s22, -v11
  s_waitcnt lgkmcnt(10)
  v_mfma_f32_32x32x16_bf16 v[176:191], v[40:43], v[72:75], v[176:191]
  v_exp_f32 v62, v108
  s_add_u32 s34, s34, 49152
  v_cvt_pk_bf16_f32 v58, v58, v24
  v_add_f32 v0, v0, v59
  s_and_b32 s34, s34, 0x3ffff
  v_mfma_f32_32x32x16_bf16 a[176:191], v[40:43], v[64:67], a[176:191]
  buffer_load_dwordx4 v4, s[8:11], s30 offen offset:2048 lds
  ds_read_b64_tr_b16 v[40:41], v18 offset:33024
  ds_read_b64_tr_b16 v[42:43], v19 offset:33024
  v_exp_f32 v24, v109
  s_waitcnt lgkmcnt(10)
  v_mfma_f32_32x32x16_bf16 v[176:191], v[44:47], v[76:79], v[176:191]
  v_fma_f32 v110, v110, s22, -v11
  s_or_b32 s34, s34, s94
  v_add_f32 v0, v0, v25
  s_add_u32 s29, s29, 49152
  v_exp_f32 v63, v110
  v_mfma_f32_32x32x16_bf16 a[176:191], v[44:47], v[68:71], a[176:191]
  buffer_load_dwordx4 v5, s[8:11], s30 offen offset:3072 lds
  ds_read_b64_tr_b16 v[44:45], v18 offset:41216
  ds_read_b64_tr_b16 v[46:47], v19 offset:41216
  v_fma_f32 v111, v111, s22, -v11
  s_waitcnt lgkmcnt(10)
  v_mfma_f32_32x32x16_bf16 v[192:207], v[48:51], v[72:75], v[192:207]
  s_and_b32 s29, s29, 0x3ffff
  v_cvt_pk_bf16_f32 v59, v59, v25
  v_add_f32 v0, v0, v62
  v_exp_f32 v25, v111
  s_or_b32 s29, s29, s94
  v_mfma_f32_32x32x16_bf16 a[192:207], v[48:51], v[64:67], a[192:207]
  ds_read_b64_tr_b16 v[48:49], v20 offset:33024
  ds_read_b64_tr_b16 v[50:51], v21 offset:33024
  s_add_u32 s35, s35, 49152
  v_add_f32 v0, v0, v24
  s_and_b32 s35, s35, 0x3ffff
  s_waitcnt lgkmcnt(10)
  v_mfma_f32_32x32x16_bf16 v[192:207], v[52:55], v[76:79], v[192:207]
  v_add_f32 v0, v0, v63
  s_or_b32 s35, s35, s94
  s_add_u32 s30, s30, 49152
  v_add_f32 v0, v0, v25
  s_and_b32 s30, s30, 0x3ffff
  v_mfma_f32_32x32x16_bf16 a[192:207], v[52:55], v[68:71], a[192:207]
  ds_read_b64_tr_b16 v[52:53], v20 offset:41216
  ds_read_b64_tr_b16 v[54:55], v21 offset:41216
  s_or_b32 s30, s30, s94
  v_cvt_pk_bf16_f32 v62, v62, v24
  v_cvt_pk_bf16_f32 v63, v63, v25
  s_waitcnt lgkmcnt(10)
  v_mfma_f32_32x32x16_bf16 v[208:223], v[32:35], v[72:75], v[208:223]
  v_max_f32 v29, v31, v0
  s_add_u32 s36, s36, 49152
  s_and_b32 s36, s36, 0x3ffff
  v_permlane16_swap_b32 v56, v58
  v_permlane16_swap_b32 v57, v59
  v_mfma_f32_32x32x16_bf16 a[208:223], v[32:35], v[64:67], a[208:223]
  v_permlane16_swap_b32 v60, v62
  v_permlane16_swap_b32 v61, v63
  v_cmp_lt_f32 vcc, s23, v29
  s_or_b32 s36, s36, s94
  s_add_u32 s56, s56, 32768
  s_waitcnt lgkmcnt(8)
  v_mfma_f32_32x32x16_bf16 v[208:223], v[36:39], v[76:79], v[208:223]
  s_cbranch_vccnz RARE8
RET8:
  s_add_u32 s57, s57, 16384
  s_add_u32 s76, s76, 32768
  v_add_f32 v26, v26, v31
  v_add_f32 v27, v27, v0
  v_mfma_f32_32x32x16_bf16 a[208:223], v[36:39], v[68:71], a[208:223]
  ds_read_b128 v[32:35], v6 offset:16384
  ds_read_b128 v[36:39], v6 offset:24576
  s_add_u32 s24, s24, 1
  s_waitcnt lgkmcnt(8)
  v_mfma_f32_32x32x16_bf16 v[224:239], v[40:43], v[72:75], v[224:239]
  v_mfma_f32_32x32x16_bf16 a[224:239], v[40:43], v[64:67], a[224:239]
  ds_read_b128 v[40:43], v7 offset:16384
  s_waitcnt lgkmcnt(7)
  v_mfma_f32_32x32x16_bf16 v[224:239], v[44:47], v[76:79], v[224:239]
  v_mfma_f32_32x32x16_bf16 a[224:239], v[44:47], v[68:71], a[224:239]
  ds_read_b128 v[44:47], v7 offset:24576
  s_waitcnt lgkmcnt(6)
  v_mfma_f32_32x32x16_bf16 v[240:255], v[48:51], v[72:75], v[240:255]
  v_mfma_f32_32x32x16_bf16 a[240:255], v[48:51], v[64:67], a[240:255]
  s_waitcnt lgkmcnt(4)
  v_mfma_f32_32x32x16_bf16 v[240:255], v[52:55], v[76:79], v[240:255]
  v_mfma_f32_32x32x16_bf16 a[240:255], v[52:55], v[68:71], a[240:255]
  s_cmp_lt_u32 s24, 4
  s_cbranch_scc1 LOOP
  s_waitcnt lgkmcnt(3)
  v_mfma_f32_16x16x32_bf16 v[112:115], v[32:35], a[0:3], 0
  ds_read_b128 v[48:51], v8 offset:16384
  ds_read_b128 v[52:55], v8 offset:24576
  v_mfma_f32_16x16x32_bf16 v[120:123], v[32:35], a[32:35], 0
  s_cmp_lg_u32 s26, 0
  s_cbranch_scc1 RARE9
RET9:
  v_mfma_f32_16x16x32_bf16 v[96:99], v[32:35], a[64:67], 0
  v_fma_f32 v80, v80, s22, -v12
  v_fma_f32 v81, v81, s22, -v12
  v_mfma_f32_16x16x32_bf16 v[104:107], v[32:35], a[96:99], 0
  ds_read_b128 v[32:35], v9 offset:16384
  v_fma_f32 v82, v82, s22, -v12
  s_waitcnt lgkmcnt(5)
  v_mfma_f32_16x16x32_bf16 v[116:119], v[36:39], a[0:3], 0
  v_exp_f32 v72, v80
  v_mfma_f32_16x16x32_bf16 v[124:127], v[36:39], a[32:35], 0
  v_exp_f32 v24, v81
  v_mfma_f32_16x16x32_bf16 v[100:103], v[36:39], a[64:67], 0
  v_exp_f32 v73, v82
  v_mfma_f32_16x16x32_bf16 v[108:111], v[36:39], a[96:99], 0
  ds_read_b128 v[36:39], v9 offset:24576
  v_fma_f32 v83, v83, s22, -v12
  s_waitcnt lgkmcnt(5)
  v_mfma_f32_16x16x32_bf16 v[112:115], v[40:43], a[4:7], v[112:115]
  v_exp_f32 v25, v83
  v_mfma_f32_16x16x32_bf16 v[120:123], v[40:43], a[36:39], v[120:123]
  v_fma_f32 v84, v84, s22, -v12
  v_add_f32 v31, v72, v24
  v_mfma_f32_16x16x32_bf16 v[96:99], v[40:43], a[68:71], v[96:99]
  v_exp_f32 v76, v84
  v_mfma_f32_16x16x32_bf16 v[104:107], v[40:43], a[100:103], v[104:107]
  ds_read_b128 v[40:43], v6 offset:16640
  v_fma_f32 v85, v85, s22, -v12
  s_waitcnt lgkmcnt(5)
  v_mfma_f32_16x16x32_bf16 v[116:119], v[44:47], a[4:7], v[116:119]
  v_cvt_pk_bf16_f32 v72, v72, v24
  v_add_f32 v31, v31, v73
  v_mfma_f32_16x16x32_bf16 v[124:127], v[44:47], a[36:39], v[124:127]
  v_exp_f32 v24, v85
  v_mfma_f32_16x16x32_bf16 v[100:103], v[44:47], a[68:71], v[100:103]
  v_fma_f32 v86, v86, s22, -v12
  v_add_f32 v31, v31, v25
  v_mfma_f32_16x16x32_bf16 v[108:111], v[44:47], a[100:103], v[108:111]
  ds_read_b128 v[44:47], v6 offset:24832
  v_fma_f32 v87, v87, s22, -v12
  s_waitcnt lgkmcnt(5)
  v_mfma_f32_16x16x32_bf16 v[112:115], v[48:51], a[8:11], v[112:115]
  v_exp_f32 v77, v86
  v_mfma_f32_16x16x32_bf16 v[120:123], v[48:51], a[40:43], v[120:123]
  v_cvt_pk_bf16_f32 v73, v73, v25
  v_add_f32 v31, v31, v76
  v_mfma_f32_16x16x32_bf16 v[96:99], v[48:51], a[72:75], v[96:99]
  v_exp_f32 v25, v87
  v_mfma_f32_16x16x32_bf16 v[104:107], v[48:51], a[104:107], v[104:107]
  s_waitcnt vmcnt(8)
  s_barrier
  s_add_u32 m0, s21, 81920
  s_waitcnt lgkmcnt(4)
  v_mfma_f32_16x16x32_bf16 v[116:119], v[52:55], a[8:11], v[116:119]
  buffer_load_dwordx4 v2, s[12:15], s34 offen offset:0 lds
  v_mfma_f32_16x16x32_bf16 v[124:127], v[52:55], a[40:43], v[124:127]
  ds_read_b128 v[48:51], v7 offset:16640
  v_fma_f32 v88, v88, s22, -v13
  v_mfma_f32_16x16x32_bf16 v[100:103], v[52:55], a[72:75], v[100:103]
  v_fma_f32 v89, v89, s22, -v13
  v_add_f32 v31, v31, v24
  v_mfma_f32_16x16x32_bf16 v[108:111], v[52:55], a[104:107], v[108:111]
  buffer_load_dwordx4 v3, s[12:15], s34 offen offset:1024 lds
  s_waitcnt lgkmcnt(4)
  v_mfma_f32_16x16x32_bf16 v[112:115], v[32:35], a[12:15], v[112:115]
  ds_read_b128 v[52:55], v7 offset:24832
  v_cvt_pk_bf16_f32 v76, v76, v24
  v_mfma_f32_16x16x32_bf16 v[120:123], v[32:35], a[44:47], v[120:123]
  v_exp_f32 v74, v88
  v_mfma_f32_16x16x32_bf16 v[96:99], v[32:35], a[76:79], v[96:99]
  v_exp_f32 v24, v89
  v_mfma_f32_16x16x32_bf16 v[104:107], v[32:35], a[108:111], v[104:107]
  buffer_load_dwordx4 v4, s[12:15], s34 offen offset:2048 lds
  s_waitcnt lgkmcnt(4)
  v_mfma_f32_16x16x32_bf16 v[116:119], v[36:39], a[12:15], v[116:119]
  ds_read_b128 v[32:35], v8 offset:16640
  v_fma_f32 v90, v90, s22, -v13
  v_mfma_f32_16x16x32_bf16 v[124:127], v[36:39], a[44:47], v[124:127]
  v_add_f32 v31, v31, v77
  v_fma_f32 v91, v91, s22, -v13
  v_mfma_f32_16x16x32_bf16 v[100:103], v[36:39], a[76:79], v[100:103]
  v_exp_f32 v75, v90
  v_mfma_f32_16x16x32_bf16 v[108:111], v[36:39], a[108:111], v[108:111]
  buffer_load_dwordx4 v5, s[12:15], s34 offen offset:3072 lds
  s_waitcnt lgkmcnt(4)
  v_mfma_f32_16x16x32_bf16 v[112:115], v[40:43], a[16:19], v[112:115]
  ds_read_b128 v[36:39], v8 offset:24832
  v_add_f32 v31, v31, v25
  v_mfma_f32_16x16x32_bf16 v[120:123], v[40:43], a[48:51], v[120:123]
  v_cvt_pk_bf16_f32 v77, v77, v25
  v_fma_f32 v92, v92, s22, -v13
  v_mfma_f32_16x16x32_bf16 v[96:99], v[40:43], a[80:83], v[96:99]
  v_exp_f32 v25, v91
  v_mfma_f32_16x16x32_bf16 v[104:107], v[40:43], a[112:115], v[104:107]
  ds_read_b128 v[40:43], v9 offset:16640
  v_add_f32 v0, v74, v24
  s_waitcnt lgkmcnt(5)
  v_mfma_f32_16x16x32_bf16 v[116:119], v[44:47], a[16:19], v[116:119]
  v_exp_f32 v78, v92
  v_mfma_f32_16x16x32_bf16 v[124:127], v[44:47], a[48:51], v[124:127]
  v_fma_f32 v93, v93, s22, -v13
  v_cvt_pk_bf16_f32 v74, v74, v24
  v_mfma_f32_16x16x32_bf16 v[100:103], v[44:47], a[80:83], v[100:103]
  v_add_f32 v0, v0, v75
  v_fma_f32 v94, v94, s22, -v13
  v_mfma_f32_16x16x32_bf16 v[108:111], v[44:47], a[112:115], v[108:111]
  ds_read_b128 v[44:47], v9 offset:24832
  v_add_f32 v0, v0, v25
  s_waitcnt lgkmcnt(5)
  v_mfma_f32_16x16x32_bf16 v[112:115], v[48:51], a[20:23], v[112:115]
  v_exp_f32 v24, v93
  v_mfma_f32_16x16x32_bf16 v[120:123], v[48:51], a[52:55], v[120:123]
  v_exp_f32 v79, v94
  v_mfma_f32_16x16x32_bf16 v[96:99], v[48:51], a[84:87], v[96:99]
  v_fma_f32 v95, v95, s22, -v13
  v_cvt_pk_bf16_f32 v75, v75, v25
  v_mfma_f32_16x16x32_bf16 v[104:107], v[48:51], a[116:119], v[104:107]
  ds_read_b64_tr_b16 v[48:49], v14 offset:0
  ds_read_b64_tr_b16 v[50:51], v15 offset:0
  s_waitcnt lgkmcnt(6)
  v_mfma_f32_16x16x32_bf16 v[116:119], v[52:55], a[20:23], v[116:119]
  v_add_f32 v0, v0, v78
  v_cvt_pk_bf16_f32 v78, v78, v24
  v_mfma_f32_16x16x32_bf16 v[124:127], v[52:55], a[52:55], v[124:127]
  v_exp_f32 v25, v95
  v_mfma_f32_16x16x32_bf16 v[100:103], v[52:55], a[84:87], v[100:103]
  v_add_f32 v0, v0, v24
  v_permlane16_swap_b32 v72, v74
  v_mfma_f32_16x16x32_bf16 v[108:111], v[52:55], a[116:119], v[108:111]
  ds_read_b64_tr_b16 v[52:53], v14 offset:8192
  ds_read_b64_tr_b16 v[54:55], v15 offset:8192
  s_waitcnt lgkmcnt(7)
  v_mfma_f32_16x16x32_bf16 v[112:115], v[32:35], a[24:27], v[112:115]
  v_add_f32 v0, v0, v79
  v_cvt_pk_bf16_f32 v79, v79, v25
  v_mfma_f32_16x16x32_bf16 v[120:123], v[32:35], a[56:59], v[120:123]
  v_add_f32 v0, v0, v25
  v_permlane16_swap_b32 v73, v75
  v_mfma_f32_16x16x32_bf16 v[96:99], v[32:35], a[88:91], v[96:99]
  v_max_f32 v29, v31, v0
  v_permlane16_swap_b32 v76, v78
  v_mfma_f32_16x16x32_bf16 v[104:107], v[32:35], a[120:123], v[104:107]
  ds_read_b64_tr_b16 v[32:33], v16 offset:0
  ds_read_b64_tr_b16 v[34:35], v17 offset:0
  s_waitcnt lgkmcnt(8)
  v_mfma_f32_16x16x32_bf16 v[116:119], v[36:39], a[24:27], v[116:119]
  v_permlane16_swap_b32 v77, v79
  v_cmp_lt_f32 vcc, s23, v29
  v_mfma_f32_16x16x32_bf16 v[124:127], v[36:39], a[56:59], v[124:127]
  s_cbranch_vccnz RARE10
RET10:
  s_add_u32 s46, s58, 16384
  v_mfma_f32_16x16x32_bf16 v[100:103], v[36:39], a[88:91], v[100:103]
  v_add_f32 v22, v22, v31
  v_add_f32 v23, v23, v0
  v_mfma_f32_16x16x32_bf16 v[108:111], v[36:39], a[120:123], v[108:111]
  ds_read_b64_tr_b16 v[36:37], v16 offset:8192
  ds_read_b64_tr_b16 v[38:39], v17 offset:8192
  s_waitcnt lgkmcnt(9)
  v_mfma_f32_16x16x32_bf16 v[112:115], v[40:43], a[28:31], v[112:115]
  v_mfma_f32_16x16x32_bf16 v[120:123], v[40:43], a[60:63], v[120:123]
  v_mfma_f32_16x16x32_bf16 v[96:99], v[40:43], a[92:95], v[96:99]
  s_nop 5
  v_fma_f32 v112, v112, s22, -v10
  v_fma_f32 v113, v113, s22, -v10
  v_mfma_f32_16x16x32_bf16 v[104:107], v[40:43], a[124:127], v[104:107]
  ds_read_b64_tr_b16 v[40:41], v18 offset:0
  ds_read_b64_tr_b16 v[42:43], v19 offset:0
  s_waitcnt lgkmcnt(10)
  v_mfma_f32_16x16x32_bf16 v[116:119], v[44:47], a[28:31], v[116:119]
  v_exp_f32 v64, v112
  v_mfma_f32_16x16x32_bf16 v[124:127], v[44:47], a[60:63], v[124:127]
  v_exp_f32 v24, v113
  v_mfma_f32_16x16x32_bf16 v[100:103], v[44:47], a[92:95], v[100:103]
  v_fma_f32 v114, v114, s22, -v10
  v_fma_f32 v115, v115, s22, -v10
  v_mfma_f32_16x16x32_bf16 v[108:111], v[44:47], a[124:127], v[108:111]
  ds_read_b64_tr_b16 v[44:45], v18 offset:8192
  ds_read_b64_tr_b16 v[46:47], v19 offset:8192
  s_waitcnt lgkmcnt(10)
  v_mfma_f32_32x32x16_bf16 v[128:143], v[48:51], v[56:59], v[128:143]
  v_exp_f32 v65, v114
  v_fma_f32 v116, v116, s22, -v10
  v_add_f32 v31, v64, v24
  v_fma_f32 v117, v117, s22, -v10
  v_mfma_f32_32x32x16_bf16 a[128:143], v[48:51], v[72:75], a[128:143]
  ds_read_b64_tr_b16 v[48:49], v20 offset:0
  ds_read_b64_tr_b16 v[50:51], v21 offset:0
  v_exp_f32 v25, v115
  v_cvt_pk_bf16_f32 v64, v64, v24
  s_waitcnt lgkmcnt(10)
  v_mfma_f32_32x32x16_bf16 v[128:143], v[52:55], v[60:63], v[128:143]
  v_exp_f32 v68, v116
  v_add_f32 v31, v31, v65
  v_fma_f32 v118, v118, s22, -v10
  v_add_f32 v31, v31, v25
  v_mfma_f32_32x32x16_bf16 a[128:143], v[52:55], v[76:79], a[128:143]
  ds_read_b64_tr_b16 v[52:53], v20 offset:8192
  ds_read_b64_tr_b16 v[54:55], v21 offset:8192
  v_exp_f32 v24, v117
  v_fma_f32 v119, v119, s22, -v10
  s_waitcnt lgkmcnt(10)
  v_mfma_f32_32x32x16_bf16 v[144:159], v[32:35], v[56:59], v[144:159]
  v_exp_f32 v69, v118
  v_cvt_pk_bf16_f32 v65, v65, v25
  v_add_f32 v31, v31, v68
  v_fma_f32 v120, v120, s22, -v11
  v_mfma_f32_32x32x16_bf16 a[144:159], v[32:35], v[72:75], a[144:159]
  ds_read_b64_tr_b16 v[32:33], v14 offset:256
  ds_read_b64_tr_b16 v[34:35], v15 offset:256
  v_exp_f32 v25, v119
  v_fma_f32 v121, v121, s22, -v11
  s_waitcnt lgkmcnt(10)
  v_mfma_f32_32x32x16_bf16 v[144:159], v[36:39], v[60:63], v[144:159]
  v_add_f32 v31, v31, v24
  v_cvt_pk_bf16_f32 v68, v68, v24
  v_exp_f32 v66, v120
  v_fma_f32 v122, v122, s22, -v11
  v_mfma_f32_32x32x16_bf16 a[144:159], v[36:39], v[76:79], a[144:159]
  ds_read_b64_tr_b16 v[36:37], v14 offset:8448
  ds_read_b64_tr_b16 v[38:39], v15 offset:8448
  v_exp_f32 v24, v121
  v_add_f32 v31, v31, v69
  s_waitcnt lgkmcnt(10)
  v_mfma_f32_32x32x16_bf16 v[160:175], v[40:43], v[56:59], v[160:175]
  v_exp_f32 v67, v122
  v_fma_f32 v123, v123, s22, -v11
  v_add_f32 v31, v31, v25
  v_cvt_pk_bf16_f32 v69, v69, v25
  v_mfma_f32_32x32x16_bf16 a[160:175], v[40:43], v[72:75], a[160:175]
  s_barrier
  s_add_u32 m0, s21, 16384
  s_nop 0
  buffer_load_dwordx4 v2, s[4:7], s46 offen offset:0 lds
  ds_read_b64_tr_b16 v[40:41], v16 offset:256
  ds_read_b64_tr_b16 v[42:43], v17 offset:256
  s_waitcnt lgkmcnt(10)
  v_mfma_f32_32x32x16_bf16 v[160:175], v[44:47], v[60:63], v[160:175]
  v_exp_f32 v25, v123
  v_fma_f32 v124, v124, s22, -v11
  v_add_f32 v0, v66, v24
  v_fma_f32 v125, v125, s22, -v11
  v_mfma_f32_32x32x16_bf16 a[160:175], v[44:47], v[76:79], a[160:175]
  buffer_load_dwordx4 v3, s[4:7], s46 offen offset:1024 lds
  ds_read_b64_tr_b16 v[44:45], v16 offset:8448
  ds_read_b64_tr_b16 v[46:47], v17 offset:8448
  v_exp_f32 v70, v124
  s_waitcnt lgkmcnt(10)
  v_mfma_f32_32x32x16_bf16 v[176:191], v[48:51], v[56:59], v[176:191]
  v_cvt_pk_bf16_f32 v66, v66, v24
  v_add_f32 v0, v0, v67
  v_exp_f32 v24, v125
  v_fma_f32 v126, v126, s22, -v11
  v_mfma_f32_32x32x16_bf16 a[176:191], v[48:51], v[72:75], a[176:191]
  buffer_load_dwordx4 v4, s[4:7], s46 offen offset:2048 lds
  ds_read_b64_tr_b16 v[48:49], v18 offset:256
  ds_read_b64_tr_b16 v[50:51], v19 offset:256
  v_add_f32 v0, v0, v25
  s_waitcnt lgkmcnt(10)
  v_mfma_f32_32x32x16_bf16 v[176:191], v[52:55], v[60:63], v[176:191]
  v_exp_f32 v71, v126
  v_fma_f32 v127, v127, s22, -v11
  v_cvt_pk_bf16_f32 v67, v67, v25
  v_add_f32 v0, v0, v70
  v_mfma_f32_32x32x16_bf16 a[176:191], v[52:55], v[76:79], a[176:191]
  buffer_load_dwordx4 v5, s[4:7], s46 offen offset:3072 lds
  ds_read_b64_tr_b16 v[52:53], v18 offset:8448
  ds_read_b64_tr_b16 v[54:55], v19 offset:8448
  v_exp_f32 v25, v127
  s_waitcnt lgkmcnt(10)
  v_mfma_f32_32x32x16_bf16 v[192:207], v[32:35], v[56:59], v[192:207]
  v_add_f32 v0, v0, v24
  v_cvt_pk_bf16_f32 v70, v70, v24
  v_add_f32 v0, v0, v71
  v_cvt_pk_bf16_f32 v71, v71, v25
  v_add_f32 v0, v0, v25
  v_mfma_f32_32x32x16_bf16 a[192:207], v[32:35], v[72:75], a[192:207]
  ds_read_b64_tr_b16 v[32:33], v20 offset:256
  ds_read_b64_tr_b16 v[34:35], v21 offset:256
  v_max_f32 v29, v31, v0
  v_permlane16_swap_b32 v64, v66
  v_permlane16_swap_b32 v65, v67
  s_waitcnt lgkmcnt(10)
  v_mfma_f32_32x32x16_bf16 v[192:207], v[36:39], v[60:63], v[192:207]
  v_permlane16_swap_b32 v68, v70
  v_permlane16_swap_b32 v69, v71
  v_cmp_lt_f32 vcc, s23, v29
  v_fma_f32 v96, v96, s22, -v12
  s_cbranch_vccnz RARE11
RET11:
  v_mfma_f32_32x32x16_bf16 a[192:207], v[36:39], v[76:79], a[192:207]
  ds_read_b64_tr_b16 v[36:37], v20 offset:8448
  ds_read_b64_tr_b16 v[38:39], v21 offset:8448
  s_cmp_lg_u32 s26, 0
  v_fma_f32 v97, v97, s22, -v12
  v_fma_f32 v98, v98, s22, -v12
  s_waitcnt lgkmcnt(10)
  v_mfma_f32_32x32x16_bf16 v[208:223], v[40:43], v[56:59], v[208:223]
  v_fma_f32 v99, v99, s22, -v12
  v_fma_f32 v100, v100, s22, -v12
  v_add_f32 v26, v26, v31
  v_fma_f32 v101, v101, s22, -v12
  v_fma_f32 v102, v102, s22, -v12
  v_mfma_f32_32x32x16_bf16 a[208:223], v[40:43], v[72:75], a[208:223]
  ds_read_b128 v[40:43], v6 offset:32768
  v_fma_f32 v103, v103, s22, -v12
  v_fma_f32 v104, v104, s22, -v13
  v_fma_f32 v105, v105, s22, -v13
  v_fma_f32 v106, v106, s22, -v13
  s_waitcnt lgkmcnt(9)
  v_mfma_f32_32x32x16_bf16 v[208:223], v[44:47], v[60:63], v[208:223]
  v_fma_f32 v107, v107, s22, -v13
  v_fma_f32 v108, v108, s22, -v13
  v_add_f32 v27, v27, v0
  v_fma_f32 v109, v109, s22, -v13
  v_fma_f32 v110, v110, s22, -v13
  v_mfma_f32_32x32x16_bf16 a[208:223], v[44:47], v[76:79], a[208:223]
  ds_read_b128 v[44:47], v6 offset:40960
  v_fma_f32 v111, v111, s22, -v13
  s_waitcnt lgkmcnt(8)
  v_mfma_f32_32x32x16_bf16 v[224:239], v[48:51], v[56:59], v[224:239]
  v_mfma_f32_32x32x16_bf16 a[224:239], v[48:51], v[72:75], a[224:239]
  ds_read_b128 v[48:51], v7 offset:32768
  s_waitcnt lgkmcnt(7)
  v_mfma_f32_32x32x16_bf16 v[224:239], v[52:55], v[60:63], v[224:239]
  v_mfma_f32_32x32x16_bf16 a[224:239], v[52:55], v[76:79], a[224:239]
  ds_read_b128 v[52:55], v7 offset:40960
  s_waitcnt lgkmcnt(6)
  v_mfma_f32_32x32x16_bf16 v[240:255], v[32:35], v[56:59], v[240:255]
  v_exp_f32 v56, v96
  v_mfma_f32_32x32x16_bf16 a[240:255], v[32:35], v[72:75], a[240:255]
  ds_read_b128 v[32:35], v8 offset:32768
  v_exp_f32 v57, v98
  s_waitcnt lgkmcnt(5)
  v_mfma_f32_32x32x16_bf16 v[240:255], v[36:39], v[60:63], v[240:255]
  v_exp_f32 v60, v100
  v_mfma_f32_32x32x16_bf16 a[240:255], v[36:39], v[76:79], a[240:255]
  ds_read_b128 v[36:39], v8 offset:40960
  v_exp_f32 v61, v102
  s_waitcnt lgkmcnt(5)
  v_mfma_f32_16x16x32_bf16 v[80:83], v[40:43], a[0:3], 0
  s_cbranch_scc1 RARE12
RET12:
  v_mfma_f32_16x16x32_bf16 v[88:91], v[40:43], a[32:35], 0
  v_exp_f32 v24, v97
  v_mfma_f32_16x16x32_bf16 v[112:115], v[40:43], a[64:67], 0
  v_exp_f32 v25, v99
  v_mfma_f32_16x16x32_bf16 v[120:123], v[40:43], a[96:99], 0
  ds_read_b128 v[40:43], v9 offset:32768
  v_add_f32 v31, v56, v24
  s_waitcnt lgkmcnt(5)
  v_mfma_f32_16x16x32_bf16 v[84:87], v[44:47], a[0:3], 0
  v_cvt_pk_bf16_f32 v56, v56, v24
  v_add_f32 v31, v31, v57
  v_mfma_f32_16x16x32_bf16 v[92:95], v[44:47], a[32:35], 0
  v_exp_f32 v24, v101
  v_mfma_f32_16x16x32_bf16 v[116:119], v[44:47], a[64:67], 0
  v_add_f32 v31, v31, v25
  v_cvt_pk_bf16_f32 v57, v57, v25
  v_mfma_f32_16x16x32_bf16 v[124:127], v[44:47], a[96:99], 0
  ds_read_b128 v[44:47], v9 offset:40960
  v_add_f32 v31, v31, v60
  s_waitcnt lgkmcnt(5)
  v_mfma_f32_16x16x32_bf16 v[80:83], v[48:51], a[4:7], v[80:83]
  v_exp_f32 v25, v103
  v_mfma_f32_16x16x32_bf16 v[88:91], v[48:51], a[36:39], v[88:91]
  v_add_f32 v31, v31, v24
  v_cvt_pk_bf16_f32 v60, v60, v24
  v_mfma_f32_16x16x32_bf16 v[112:115], v[48:51], a[68:71], v[112:115]
  v_exp_f32 v58, v104
  v_mfma_f32_16x16x32_bf16 v[120:123], v[48:51], a[100:103], v[120:123]
  ds_read_b128 v[48:51], v6 offset:33024
  v_add_f32 v31, v31, v61
  s_waitcnt lgkmcnt(5)
  v_mfma_f32_16x16x32_bf16 v[84:87], v[52:55], a[4:7], v[84:87]
  v_exp_f32 v24, v105
  v_mfma_f32_16x16x32_bf16 v[92:95], v[52:55], a[36:39], v[92:95]
  v_exp_f32 v59, v106
  v_mfma_f32_16x16x32_bf16 v[116:119], v[52:55], a[68:71], v[116:119]
  v_add_f32 v31, v31, v25
  v_cvt_pk_bf16_f32 v61, v61, v25
  v_mfma_f32_16x16x32_bf16 v[124:127], v[52:55], a[100:103], v[124:127]
  ds_read_b128 v[52:55], v6 offset:41216
  v_add_f32 v0, v58, v24
  s_waitcnt lgkmcnt(5)
  v_mfma_f32_16x16x32_bf16 v[80:83], v[32:35], a[8:11], v[80:83]
  v_exp_f32 v25, v107
  v_mfma_f32_16x16x32_bf16 v[88:91], v[32:35], a[40:43], v[88:91]
  v_exp_f32 v62, v108
  v_mfma_f32_16x16x32_bf16 v[112:115], v[32:35], a[72:75], v[112:115]
  v_cvt_pk_bf16_f32 v58, v58, v24
  v_add_f32 v0, v0, v59
  v_mfma_f32_16x16x32_bf16 v[120:123], v[32:35], a[104:107], v[120:123]
  s_waitcnt vmcnt(12)
  s_barrier
  s_add_u32 m0, s21, 49152
  s_waitcnt lgkmcnt(4)
  v_mfma_f32_16x16x32_bf16 v[84:87], v[36:39], a[8:11], v[84:87]
  buffer_load_dwordx4 v2, s[12:15], s35 offen offset:0 lds
  v_mfma_f32_16x16x32_bf16 v[92:95], v[36:39], a[40:43], v[92:95]
  ds_read_b128 v[32:35], v7 offset:33024
  v_add_f32 v0, v0, v25
  v_mfma_f32_16x16x32_bf16 v[116:119], v[36:39], a[72:75], v[116:119]
  v_exp_f32 v24, v109
  v_mfma_f32_16x16x32_bf16 v[124:127], v[36:39], a[104:107], v[124:127]
  buffer_load_dwordx4 v3, s[12:15], s35 offen offset:1024 lds
  s_waitcnt lgkmcnt(4)
  v_mfma_f32_16x16x32_bf16 v[80:83], v[40:43], a[12:15], v[80:83]
  ds_read_b128 v[36:39], v7 offset:41216
  v_cvt_pk_bf16_f32 v59, v59, v25
  v_mfma_f32_16x16x32_bf16 v[88:91], v[40:43], a[44:47], v[88:91]
  v_exp_f32 v63, v110
  v_mfma_f32_16x16x32_bf16 v[112:115], v[40:43], a[76:79], v[112:115]
  v_add_f32 v0, v0, v62
  v_cvt_pk_bf16_f32 v62, v62, v24
  v_mfma_f32_16x16x32_bf16 v[120:123], v[40:43], a[108:111], v[120:123]
  buffer_load_dwordx4 v4, s[12:15], s35 offen offset:2048 lds
  s_waitcnt lgkmcnt(4)
  v_mfma_f32_16x16x32_bf16 v[84:87], v[44:47], a[12:15], v[84:87]
  ds_read_b128 v[40:43], v8 offset:33024
  v_add_f32 v0, v0, v24
  v_mfma_f32_16x16x32_bf16 v[92:95], v[44:47], a[44:47], v[92:95]
  v_exp_f32 v25, v111
  v_mfma_f32_16x16x32_bf16 v[116:119], v[44:47], a[76:79], v[116:119]
  v_add_f32 v0, v0, v63
  v_permlane16_swap_b32 v56, v58
  v_mfma_f32_16x16x32_bf16 v[124:127], v[44:47], a[108:111], v[124:127]
  buffer_load_dwordx4 v5, s[12:15], s35 offen offset:3072 lds
  s_waitcnt lgkmcnt(4)
  v_mfma_f32_16x16x32_bf16 v[80:83], v[48:51], a[16:19], v[80:83]
  ds_read_b128 v[44:47], v8 offset:41216
  v_add_f32 v0, v0, v25
  v_mfma_f32_16x16x32_bf16 v[88:91], v[48:51], a[48:51], v[88:91]
  v_cvt_pk_bf16_f32 v63, v63, v25
  v_max_f32 v29, v31, v0
  v_mfma_f32_16x16x32_bf16 v[112:115], v[48:51], a[80:83], v[112:115]
  v_permlane16_swap_b32 v57, v59
  v_permlane16_swap_b32 v60, v62
  v_mfma_f32_16x16x32_bf16 v[120:123], v[48:51], a[112:115], v[120:123]
  ds_read_b128 v[48:51], v9 offset:33024
  v_permlane16_swap_b32 v61, v63
  s_waitcnt lgkmcnt(5)
  v_mfma_f32_16x16x32_bf16 v[84:87], v[52:55], a[16:19], v[84:87]
  v_cmp_lt_f32 vcc, s23, v29
  s_add_u32 s47, s58, 49152
  v_mfma_f32_16x16x32_bf16 v[92:95], v[52:55], a[48:51], v[92:95]
  s_cbranch_vccnz RARE13
RET13:
  v_add_f32 v22, v22, v31
  v_mfma_f32_16x16x32_bf16 v[116:119], v[52:55], a[80:83], v[116:119]
  v_add_f32 v23, v23, v0
  v_mfma_f32_16x16x32_bf16 v[124:127], v[52:55], a[112:115], v[124:127]
  ds_read_b128 v[52:55], v9 offset:41216
  s_waitcnt lgkmcnt(5)
  v_mfma_f32_16x16x32_bf16 v[80:83], v[32:35], a[20:23], v[80:83]
  v_mfma_f32_16x16x32_bf16 v[88:91], v[32:35], a[52:55], v[88:91]
  v_mfma_f32_16x16x32_bf16 v[112:115], v[32:35], a[84:87], v[112:115]
  v_mfma_f32_16x16x32_bf16 v[120:123], v[32:35], a[116:119], v[120:123]
  ds_read_b64_tr_b16 v[32:33], v14 offset:16384
  ds_read_b64_tr_b16 v[34:35], v15 offset:16384
  s_waitcnt lgkmcnt(6)
  v_mfma_f32_16x16x32_bf16 v[84:87], v[36:39], a[20:23], v[84:87]
  v_mfma_f32_16x16x32_bf16 v[92:95], v[36:39], a[52:55], v[92:95]
  v_mfma_f32_16x16x32_bf16 v[116:119], v[36:39], a[84:87], v[116:119]
  v_mfma_f32_16x16x32_bf16 v[124:127], v[36:39], a[116:119], v[124:127]
  ds_read_b64_tr_b16 v[36:37], v14 offset:24576
  ds_read_b64_tr_b16 v[38:39], v15 offset:24576
  s_waitcnt lgkmcnt(7)
  v_mfma_f32_16x16x32_bf16 v[80:83], v[40:43], a[24:27], v[80:83]
  v_mfma_f32_16x16x32_bf16 v[88:91], v[40:43], a[56:59], v[88:91]
  v_mfma_f32_16x16x32_bf16 v[112:115], v[40:43], a[88:91], v[112:115]
  v_mfma_f32_16x16x32_bf16 v[120:123], v[40:43], a[120:123], v[120:123]
  ds_read_b64_tr_b16 v[40:41], v16 offset:16384
  ds_read_b64_tr_b16 v[42:43], v17 offset:16384
  s_waitcnt lgkmcnt(8)
  v_mfma_f32_16x16x32_bf16 v[84:87], v[44:47], a[24:27], v[84:87]
  v_mfma_f32_16x16x32_bf16 v[92:95], v[44:47], a[56:59], v[92:95]
  v_mfma_f32_16x16x32_bf16 v[116:119], v[44:47], a[88:91], v[116:119]
  v_mfma_f32_16x16x32_bf16 v[124:127], v[44:47], a[120:123], v[124:127]
  ds_read_b64_tr_b16 v[44:45], v16 offset:24576
  ds_read_b64_tr_b16 v[46:47], v17 offset:24576
  s_waitcnt lgkmcnt(9)
  v_mfma_f32_16x16x32_bf16 v[80:83], v[48:51], a[28:31], v[80:83]
  v_mfma_f32_16x16x32_bf16 v[88:91], v[48:51], a[60:63], v[88:91]
  v_mfma_f32_16x16x32_bf16 v[112:115], v[48:51], a[92:95], v[112:115]
  s_nop 5
  v_fma_f32 v80, v80, s22, -v10
  v_fma_f32 v81, v81, s22, -v10
  v_mfma_f32_16x16x32_bf16 v[120:123], v[48:51], a[124:127], v[120:123]
  ds_read_b64_tr_b16 v[48:49], v18 offset:16384
  ds_read_b64_tr_b16 v[50:51], v19 offset:16384
  s_waitcnt lgkmcnt(10)
  v_mfma_f32_16x16x32_bf16 v[84:87], v[52:55], a[28:31], v[84:87]
  v_exp_f32 v72, v80
  v_mfma_f32_16x16x32_bf16 v[92:95], v[52:55], a[60:63], v[92:95]
  v_exp_f32 v24, v81
  v_mfma_f32_16x16x32_bf16 v[116:119], v[52:55], a[92:95], v[116:119]
  v_fma_f32 v82, v82, s22, -v10
  v_fma_f32 v83, v83, s22, -v10
  v_mfma_f32_16x16x32_bf16 v[124:127], v[52:55], a[124:127], v[124:127]
  ds_read_b64_tr_b16 v[52:53], v18 offset:24576
  ds_read_b64_tr_b16 v[54:55], v19 offset:24576
  s_waitcnt lgkmcnt(10)
  v_mfma_f32_32x32x16_bf16 v[128:143], v[32:35], v[64:67], v[128:143]
  v_exp_f32 v73, v82
  v_fma_f32 v84, v84, s22, -v10
  v_add_f32 v31, v72, v24
  v_fma_f32 v85, v85, s22, -v10
  v_mfma_f32_32x32x16_bf16 a[128:143], v[32:35], v[56:59], a[128:143]
  ds_read_b64_tr_b16 v[32:33], v20 offset:16384
  ds_read_b64_tr_b16 v[34:35], v21 offset:16384
  v_exp_f32 v25, v83
  v_cvt_pk_bf16_f32 v72, v72, v24
  s_waitcnt lgkmcnt(10)
  v_mfma_f32_32x32x16_bf16 v[128:143], v[36:39], v[68:71], v[128:143]
  v_exp_f32 v76, v84
  v_add_f32 v31, v31, v73
  v_fma_f32 v86, v86, s22, -v10
  v_add_f32 v31, v31, v25
  v_mfma_f32_32x32x16_bf16 a[128:143], v[36:39], v[60:63], a[128:143]
  ds_read_b64_tr_b16 v[36:37], v20 offset:24576
  ds_read_b64_tr_b16 v[38:39], v21 offset:24576
  v_exp_f32 v24, v85
  v_fma_f32 v87, v87, s22, -v10
  s_waitcnt lgkmcnt(10)
  v_mfma_f32_32x32x16_bf16 v[144:159], v[40:43], v[64:67], v[144:159]
  v_exp_f32 v77, v86
  v_cvt_pk_bf16_f32 v73, v73, v25
  v_add_f32 v31, v31, v76
  v_fma_f32 v88, v88, s22, -v11
  v_mfma_f32_32x32x16_bf16 a[144:159], v[40:43], v[56:59], a[144:159]
  ds_read_b64_tr_b16 v[40:41], v14 offset:16640
  ds_read_b64_tr_b16 v[42:43], v15 offset:16640
  v_exp_f32 v25, v87
  v_fma_f32 v89, v89, s22, -v11
  s_waitcnt lgkmcnt(10)
  v_mfma_f32_32x32x16_bf16 v[144:159], v[44:47], v[68:71], v[144:159]
  v_add_f32 v31, v31, v24
  v_cvt_pk_bf16_f32 v76, v76, v24
  v_exp_f32 v74, v88
  v_fma_f32 v90, v90, s22, -v11
  v_mfma_f32_32x32x16_bf16 a[144:159], v[44:47], v[60:63], a[144:159]
  ds_read_b64_tr_b16 v[44:45], v14 offset:24832
  ds_read_b64_tr_b16 v[46:47], v15 offset:24832
  v_exp_f32 v24, v89
  v_add_f32 v31, v31, v77
  s_waitcnt lgkmcnt(10)
  v_mfma_f32_32x32x16_bf16 v[160:175], v[48:51], v[64:67], v[160:175]
  v_exp_f32 v75, v90
  v_fma_f32 v91, v91, s22, -v11
  v_add_f32 v31, v31, v25
  v_cvt_pk_bf16_f32 v77, v77, v25
  v_mfma_f32_32x32x16_bf16 a[160:175], v[48:51], v[56:59], a[160:175]
  s_waitcnt vmcnt(12)
  s_barrier
  s_add_u32 m0, s21, 32768
  s_nop 0
  buffer_load_dwordx4 v2, s[4:7], s47 offen offset:0 lds
  ds_read_b64_tr_b16 v[48:49], v16 offset:16640
  ds_read_b64_tr_b16 v[50:51], v17 offset:16640
  s_waitcnt lgkmcnt(10)
  v_mfma_f32_32x32x16_bf16 v[160:175], v[52:55], v[68:71], v[160:175]
  v_exp_f32 v25, v91
  v_fma_f32 v92, v92, s22, -v11
  v_add_f32 v0, v74, v24
  v_fma_f32 v93, v93, s22, -v11
  v_mfma_f32_32x32x16_bf16 a[160:175], v[52:55], v[60:63], a[160:175]
  buffer_load_dwordx4 v3, s[4:7], s47 offen offset:1024 lds
  ds_read_b64_tr_b16 v[52:53], v16 offset:24832
  ds_read_b64_tr_b16 v[54:55], v17 offset:24832
  v_exp_f32 v78, v92
  s_waitcnt lgkmcnt(10)
  v_mfma_f32_32x32x16_bf16 v[176:191], v[32:35], v[64:67], v[176:191]
  v_cvt_pk_bf16_f32 v74, v74, v24
  v_add_f32 v0, v0, v75
  v_exp_f32 v24, v93
  v_fma_f32 v94, v94, s22, -v11
  v_mfma_f32_32x32x16_bf16 a[176:191], v[32:35], v[56:59], a[176:191]
  buffer_load_dwordx4 v4, s[4:7], s47 offen offset:2048 lds
  ds_read_b64_tr_b16 v[32:33], v18 offset:16640
  ds_read_b64_tr_b16 v[34:35], v19 offset:16640
  v_add_f32 v0, v0, v25
  s_waitcnt lgkmcnt(10)
  v_mfma_f32_32x32x16_bf16 v[176:191], v[36:39], v[68:71], v[176:191]
  v_exp_f32 v79, v94
  v_fma_f32 v95, v95, s22, -v11
  v_cvt_pk_bf16_f32 v75, v75, v25
  v_add_f32 v0, v0, v78
  v_mfma_f32_32x32x16_bf16 a[176:191], v[36:39], v[60:63], a[176:191]
  buffer_load_dwordx4 v5, s[4:7], s47 offen offset:3072 lds
  ds_read_b64_tr_b16 v[36:37], v18 offset:24832
  ds_read_b64_tr_b16 v[38:39], v19 offset:24832
  v_exp_f32 v25, v95
  s_waitcnt lgkmcnt(10)
  v_mfma_f32_32x32x16_bf16 v[192:207], v[40:43], v[64:67], v[192:207]
  v_add_f32 v0, v0, v24
  v_cvt_pk_bf16_f32 v78, v78, v24
  v_add_f32 v0, v0, v79
  v_cvt_pk_bf16_f32 v79, v79, v25
  v_add_f32 v0, v0, v25
  v_mfma_f32_32x32x16_bf16 a[192:207], v[40:43], v[56:59], a[192:207]
  ds_read_b64_tr_b16 v[40:41], v20 offset:16640
  ds_read_b64_tr_b16 v[42:43], v21 offset:16640
  v_max_f32 v29, v31, v0
  v_permlane16_swap_b32 v72, v74
  v_permlane16_swap_b32 v73, v75
  s_waitcnt lgkmcnt(10)
  v_mfma_f32_32x32x16_bf16 v[192:207], v[44:47], v[68:71], v[192:207]
  v_permlane16_swap_b32 v76, v78
  v_permlane16_swap_b32 v77, v79
  v_cmp_lt_f32 vcc, s23, v29
  v_fma_f32 v112, v112, s22, -v12
  s_cbranch_vccnz RARE14
RET14:
  v_mfma_f32_32x32x16_bf16 a[192:207], v[44:47], v[60:63], a[192:207]
  ds_read_b64_tr_b16 v[44:45], v20 offset:24832
  ds_read_b64_tr_b16 v[46:47], v21 offset:24832
  s_cmp_lg_u32 s26, 0
  v_fma_f32 v113, v113, s22, -v12
  v_fma_f32 v114, v114, s22, -v12
  s_waitcnt lgkmcnt(10)
  v_mfma_f32_32x32x16_bf16 v[208:223], v[48:51], v[64:67], v[208:223]
  v_fma_f32 v115, v115, s22, -v12
  v_fma_f32 v116, v116, s22, -v12
  v_add_f32 v26, v26, v31
  v_fma_f32 v117, v117, s22, -v12
  v_fma_f32 v118, v118, s22, -v12
  v_mfma_f32_32x32x16_bf16 a[208:223], v[48:51], v[56:59], a[208:223]
  ds_read_b128 v[48:51], v6 offset:0
  v_fma_f32 v119, v119, s22, -v12
  v_fma_f32 v120, v120, s22, -v13
  v_fma_f32 v121, v121, s22, -v13
  v_fma_f32 v122, v122, s22, -v13
  s_waitcnt lgkmcnt(9)
  v_mfma_f32_32x32x16_bf16 v[208:223], v[52:55], v[68:71], v[208:223]
  v_fma_f32 v123, v123, s22, -v13
  v_fma_f32 v124, v124, s22, -v13
  v_add_f32 v27, v27, v0
  v_fma_f32 v125, v125, s22, -v13
  v_fma_f32 v126, v126, s22, -v13
  v_mfma_f32_32x32x16_bf16 a[208:223], v[52:55], v[60:63], a[208:223]
  ds_read_b128 v[52:55], v6 offset:8192
  v_fma_f32 v127, v127, s22, -v13
  s_waitcnt lgkmcnt(8)
  v_mfma_f32_32x32x16_bf16 v[224:239], v[32:35], v[64:67], v[224:239]
  v_mfma_f32_32x32x16_bf16 a[224:239], v[32:35], v[56:59], a[224:239]
  ds_read_b128 v[32:35], v7 offset:0
  s_waitcnt lgkmcnt(7)
  v_mfma_f32_32x32x16_bf16 v[224:239], v[36:39], v[68:71], v[224:239]
  v_mfma_f32_32x32x16_bf16 a[224:239], v[36:39], v[60:63], a[224:239]
  ds_read_b128 v[36:39], v7 offset:8192
  s_waitcnt lgkmcnt(6)
  v_mfma_f32_32x32x16_bf16 v[240:255], v[40:43], v[64:67], v[240:255]
  v_exp_f32 v64, v112
  v_mfma_f32_32x32x16_bf16 a[240:255], v[40:43], v[56:59], a[240:255]
  ds_read_b128 v[40:43], v8 offset:0
  v_exp_f32 v65, v114
  s_waitcnt lgkmcnt(5)
  v_mfma_f32_32x32x16_bf16 v[240:255], v[44:47], v[68:71], v[240:255]
  v_exp_f32 v68, v116
  v_mfma_f32_32x32x16_bf16 a[240:255], v[44:47], v[60:63], a[240:255]
  ds_read_b128 v[44:47], v8 offset:8192
  v_exp_f32 v69, v118
  s_waitcnt lgkmcnt(5)
  v_mfma_f32_16x16x32_bf16 v[96:99], v[48:51], a[0:3], 0
  s_cbranch_scc1 RARE15
RET15:
  s_add_u32 s48, s58, 81920
  v_mfma_f32_16x16x32_bf16 v[104:107], v[48:51], a[32:35], 0
  v_exp_f32 v24, v113
  v_mfma_f32_16x16x32_bf16 v[80:83], v[48:51], a[64:67], 0
  v_exp_f32 v25, v115
  v_mfma_f32_16x16x32_bf16 v[88:91], v[48:51], a[96:99], 0
  ds_read_b128 v[48:51], v9 offset:0
  v_add_f32 v31, v64, v24
  s_waitcnt lgkmcnt(5)
  v_mfma_f32_16x16x32_bf16 v[100:103], v[52:55], a[0:3], 0
  v_cvt_pk_bf16_f32 v64, v64, v24
  v_add_f32 v31, v31, v65
  v_mfma_f32_16x16x32_bf16 v[108:111], v[52:55], a[32:35], 0
  v_exp_f32 v24, v117
  v_mfma_f32_16x16x32_bf16 v[84:87], v[52:55], a[64:67], 0
  v_add_f32 v31, v31, v25
  v_cvt_pk_bf16_f32 v65, v65, v25
  v_mfma_f32_16x16x32_bf16 v[92:95], v[52:55], a[96:99], 0
  ds_read_b128 v[52:55], v9 offset:8192
  v_add_f32 v31, v31, v68
  s_waitcnt lgkmcnt(5)
  v_mfma_f32_16x16x32_bf16 v[96:99], v[32:35], a[4:7], v[96:99]
  v_exp_f32 v25, v119
  v_mfma_f32_16x16x32_bf16 v[104:107], v[32:35], a[36:39], v[104:107]
  v_add_f32 v31, v31, v24
  v_cvt_pk_bf16_f32 v68, v68, v24
  v_mfma_f32_16x16x32_bf16 v[80:83], v[32:35], a[68:71], v[80:83]
  v_exp_f32 v66, v120
  v_mfma_f32_16x16x32_bf16 v[88:91], v[32:35], a[100:103], v[88:91]
  ds_read_b128 v[32:35], v6 offset:256
  v_add_f32 v31, v31, v69
  s_waitcnt lgkmcnt(5)
  v_mfma_f32_16x16x32_bf16 v[100:103], v[36:39], a[4:7], v[100:103]
  v_exp_f32 v24, v121
  v_mfma_f32_16x16x32_bf16 v[108:111], v[36:39], a[36:39], v[108:111]
  v_exp_f32 v67, v122
  v_mfma_f32_16x16x32_bf16 v[84:87], v[36:39], a[68:71], v[84:87]
  v_add_f32 v31, v31, v25
  v_cvt_pk_bf16_f32 v69, v69, v25
  v_mfma_f32_16x16x32_bf16 v[92:95], v[36:39], a[100:103], v[92:95]
  ds_read_b128 v[36:39], v6 offset:8448
  v_add_f32 v0, v66, v24
  s_waitcnt lgkmcnt(5)
  v_mfma_f32_16x16x32_bf16 v[96:99], v[40:43], a[8:11], v[96:99]
  v_exp_f32 v25, v123
  v_mfma_f32_16x16x32_bf16 v[104:107], v[40:43], a[40:43], v[104:107]
  v_exp_f32 v70, v124
  v_mfma_f32_16x16x32_bf16 v[80:83], v[40:43], a[72:75], v[80:83]
  v_cvt_pk_bf16_f32 v66, v66, v24
  v_add_f32 v0, v0, v67
  v_mfma_f32_16x16x32_bf16 v[88:91], v[40:43], a[104:107], v[88:91]
  s_waitcnt vmcnt(12)
  s_barrier
  s_add_u32 m0, s21, 65536
  s_waitcnt lgkmcnt(4)
  v_mfma_f32_16x16x32_bf16 v[100:103], v[44:47], a[8:11], v[100:103]
  buffer_load_dwordx4 v2, s[4:7], s48 offen offset:0 lds
  v_mfma_f32_16x16x32_bf16 v[108:111], v[44:47], a[40:43], v[108:111]
  ds_read_b128 v[40:43], v7 offset:256
  v_add_f32 v0, v0, v25
  v_mfma_f32_16x16x32_bf16 v[84:87], v[44:47], a[72:75], v[84:87]
  v_exp_f32 v24, v125
  v_mfma_f32_16x16x32_bf16 v[92:95], v[44:47], a[104:107], v[92:95]
  buffer_load_dwordx4 v3, s[4:7], s48 offen offset:1024 lds
  s_waitcnt lgkmcnt(4)
  v_mfma_f32_16x16x32_bf16 v[96:99], v[48:51], a[12:15], v[96:99]
  ds_read_b128 v[44:47], v7 offset:8448
  v_cvt_pk_bf16_f32 v67, v67, v25
  v_mfma_f32_16x16x32_bf16 v[104:107], v[48:51], a[44:47], v[104:107]
  v_exp_f32 v71, v126
  v_mfma_f32_16x16x32_bf16 v[80:83], v[48:51], a[76:79], v[80:83]
  v_add_f32 v0, v0, v70
  v_cvt_pk_bf16_f32 v70, v70, v24
  v_mfma_f32_16x16x32_bf16 v[88:91], v[48:51], a[108:111], v[88:91]
  buffer_load_dwordx4 v4, s[4:7], s48 offen offset:2048 lds
  s_waitcnt lgkmcnt(4)
  v_mfma_f32_16x16x32_bf16 v[100:103], v[52:55], a[12:15], v[100:103]
  ds_read_b128 v[48:51], v8 offset:256
  v_add_f32 v0, v0, v24
  v_mfma_f32_16x16x32_bf16 v[108:111], v[52:55], a[44:47], v[108:111]
  v_exp_f32 v25, v127
  v_mfma_f32_16x16x32_bf16 v[84:87], v[52:55], a[76:79], v[84:87]
  v_add_f32 v0, v0, v71
  v_permlane16_swap_b32 v64, v66
  v_mfma_f32_16x16x32_bf16 v[92:95], v[52:55], a[108:111], v[92:95]
  buffer_load_dwordx4 v5, s[4:7], s48 offen offset:3072 lds
  s_waitcnt lgkmcnt(4)
  v_mfma_f32_16x16x32_bf16 v[96:99], v[32:35], a[16:19], v[96:99]
  ds_read_b128 v[52:55], v8 offset:8448
  v_add_f32 v0, v0, v25
  v_mfma_f32_16x16x32_bf16 v[104:107], v[32:35], a[48:51], v[104:107]
  v_cvt_pk_bf16_f32 v71, v71, v25
  v_max_f32 v29, v31, v0
  v_mfma_f32_16x16x32_bf16 v[80:83], v[32:35], a[80:83], v[80:83]
  v_permlane16_swap_b32 v65, v67
  v_permlane16_swap_b32 v68, v70
  v_mfma_f32_16x16x32_bf16 v[88:91], v[32:35], a[112:115], v[88:91]
  ds_read_b128 v[32:35], v9 offset:256
  v_permlane16_swap_b32 v69, v71
  s_waitcnt lgkmcnt(5)
  v_mfma_f32_16x16x32_bf16 v[100:103], v[36:39], a[16:19], v[100:103]
  v_cmp_lt_f32 vcc, s23, v29
  v_mfma_f32_16x16x32_bf16 v[108:111], v[36:39], a[48:51], v[108:111]
  s_cbranch_vccnz RARE16
RET16:
  v_add_u32 v112, s45, v6
  v_mfma_f32_16x16x32_bf16 v[84:87], v[36:39], a[80:83], v[84:87]
  v_add_u32 v113, s45, v7
  v_add_u32 v114, s45, v8
  v_mfma_f32_16x16x32_bf16 v[92:95], v[36:39], a[112:115], v[92:95]
  ds_read_b128 v[36:39], v9 offset:8448
  v_add_u32 v115, s45, v9
  s_waitcnt lgkmcnt(5)
  v_mfma_f32_16x16x32_bf16 v[96:99], v[40:43], a[20:23], v[96:99]
  ds_read_b128 a[0:3], v112 offset:0
  ds_read_b128 a[32:35], v112 offset:8192
  v_mfma_f32_16x16x32_bf16 v[104:107], v[40:43], a[52:55], v[104:107]
  ds_read_b128 a[4:7], v113 offset:0
  ds_read_b128 a[36:39], v113 offset:8192
  v_mfma_f32_16x16x32_bf16 v[80:83], v[40:43], a[84:87], v[80:83]
  ds_read_b128 a[8:11], v114 offset:0
  ds_read_b128 a[40:43], v114 offset:8192
  v_mfma_f32_16x16x32_bf16 v[88:91], v[40:43], a[116:119], v[88:91]
  ds_read_b64_tr_b16 v[40:41], v14 offset:32768
  ds_read_b64_tr_b16 v[42:43], v15 offset:32768
  s_waitcnt lgkmcnt(12)
  v_mfma_f32_16x16x32_bf16 v[100:103], v[44:47], a[20:23], v[100:103]
  ds_read_b128 a[12:15], v115 offset:0
  ds_read_b128 a[44:47], v115 offset:8192
  v_mfma_f32_16x16x32_bf16 v[108:111], v[44:47], a[52:55], v[108:111]
  ds_read_b128 a[16:19], v112 offset:256
  ds_read_b128 a[48:51], v112 offset:8448
  v_mfma_f32_16x16x32_bf16 v[84:87], v[44:47], a[84:87], v[84:87]
  ds_read_b128 a[20:23], v113 offset:256
  ds_read_b128 a[52:55], v113 offset:8448
  v_mfma_f32_16x16x32_bf16 v[92:95], v[44:47], a[116:119], v[92:95]
  ds_read_b64_tr_b16 v[44:45], v14 offset:40960
  ds_read_b64_tr_b16 v[46:47], v15 offset:40960
  s_waitcnt lgkmcnt(15)
  v_mfma_f32_16x16x32_bf16 v[96:99], v[48:51], a[24:27], v[96:99]
  v_add_f32 v22, v22, v31
  v_add_f32 v23, v23, v0
  v_mfma_f32_16x16x32_bf16 v[104:107], v[48:51], a[56:59], v[104:107]
  v_add_u32 v116, s95, v6
  v_add_u32 v117, s95, v7
  v_mfma_f32_16x16x32_bf16 v[80:83], v[48:51], a[88:91], v[80:83]
  v_add_u32 v118, s95, v8
  v_add_u32 v119, s95, v9
  v_mfma_f32_16x16x32_bf16 v[88:91], v[48:51], a[120:123], v[88:91]
  ds_read_b64_tr_b16 v[48:49], v16 offset:32768
  ds_read_b64_tr_b16 v[50:51], v17 offset:32768
  v_mfma_f32_16x16x32_bf16 v[100:103], v[52:55], a[24:27], v[100:103]
  ds_read_b128 a[24:27], v114 offset:256
  v_mfma_f32_16x16x32_bf16 v[108:111], v[52:55], a[56:59], v[108:111]
  ds_read_b128 a[56:59], v114 offset:8448
  v_mfma_f32_16x16x32_bf16 v[84:87], v[52:55], a[88:91], v[84:87]
  v_mfma_f32_16x16x32_bf16 v[92:95], v[52:55], a[120:123], v[92:95]
  ds_read_b64_tr_b16 v[52:53], v16 offset:40960
  ds_read_b64_tr_b16 v[54:55], v17 offset:40960
  v_mfma_f32_16x16x32_bf16 v[96:99], v[32:35], a[28:31], v[96:99]
  v_mfma_f32_16x16x32_bf16 v[104:107], v[32:35], a[60:63], v[104:107]
  v_mfma_f32_16x16x32_bf16 v[80:83], v[32:35], a[92:95], v[80:83]
  s_nop 5
  v_fma_f32 v96, v96, s22, -v10
  v_fma_f32 v97, v97, s22, -v10
  v_mfma_f32_16x16x32_bf16 v[88:91], v[32:35], a[124:127], v[88:91]
  ds_read_b64_tr_b16 v[32:33], v18 offset:32768
  ds_read_b64_tr_b16 v[34:35], v19 offset:32768
  v_mfma_f32_16x16x32_bf16 v[100:103], v[36:39], a[28:31], v[100:103]
  ds_read_b128 a[28:31], v115 offset:256
  v_fma_f32 v98, v98, s22, -v10
  v_mfma_f32_16x16x32_bf16 v[108:111], v[36:39], a[60:63], v[108:111]
  ds_read_b128 a[60:63], v115 offset:8448
  v_fma_f32 v99, v99, s22, -v10
  v_mfma_f32_16x16x32_bf16 v[84:87], v[36:39], a[92:95], v[84:87]
  v_exp_f32 v56, v96
  v_mfma_f32_16x16x32_bf16 v[92:95], v[36:39], a[124:127], v[92:95]
  ds_read_b64_tr_b16 v[36:37], v18 offset:40960
  ds_read_b64_tr_b16 v[38:39], v19 offset:40960
  s_waitcnt lgkmcnt(15)
  v_mfma_f32_32x32x16_bf16 v[128:143], v[40:43], v[72:75], v[128:143]
  v_exp_f32 v24, v97
  v_fma_f32 v100, v100, s22, -v10
  v_fma_f32 v101, v101, s22, -v10
  v_fma_f32 v102, v102, s22, -v10
  v_mfma_f32_32x32x16_bf16 a[128:143], v[40:43], v[64:67], a[128:143]
  ds_read_b64_tr_b16 v[40:41], v20 offset:32768
  ds_read_b64_tr_b16 v[42:43], v21 offset:32768
  v_exp_f32 v57, v98
  v_add_f32 v31, v56, v24
  s_waitcnt lgkmcnt(14)
  v_mfma_f32_32x32x16_bf16 v[128:143], v[44:47], v[76:79], v[128:143]
  v_exp_f32 v25, v99
  v_cvt_pk_bf16_f32 v56, v56, v24
  v_add_f32 v31, v31, v57
  v_fma_f32 v103, v103, s22, -v10
  v_mfma_f32_32x32x16_bf16 a[128:143], v[44:47], v[68:71], a[128:143]
  ds_read_b64_tr_b16 v[44:45], v20 offset:40960
  ds_read_b64_tr_b16 v[46:47], v21 offset:40960
  v_exp_f32 v60, v100
  v_add_f32 v31, v31, v25
  s_waitcnt lgkmcnt(14)
  v_mfma_f32_32x32x16_bf16 v[144:159], v[48:51], v[72:75], v[144:159]
  v_exp_f32 v24, v101
  v_cvt_pk_bf16_f32 v57, v57, v25
  v_add_f32 v31, v31, v60
  v_fma_f32 v104, v104, s22, -v11
  v_mfma_f32_32x32x16_bf16 a[144:159], v[48:51], v[64:67], a[144:159]
  ds_read_b64_tr_b16 v[48:49], v14 offset:33024
  ds_read_b64_tr_b16 v[50:51], v15 offset:33024
  v_exp_f32 v61, v102
  v_fma_f32 v105, v105, s22, -v11
  s_waitcnt lgkmcnt(12)
  v_mfma_f32_32x32x16_bf16 v[144:159], v[52:55], v[76:79], v[144:159]
  v_exp_f32 v25, v103
  v_add_f32 v31, v31, v24
  v_cvt_pk_bf16_f32 v60, v60, v24
  v_fma_f32 v106, v106, s22, -v11
  v_mfma_f32_32x32x16_bf16 a[144:159], v[52:55], v[68:71], a[144:159]
  ds_read_b64_tr_b16 v[52:53], v14 offset:41216
  ds_read_b64_tr_b16 v[54:55], v15 offset:41216
  v_exp_f32 v58, v104
  v_add_f32 v31, v31, v61
  s_waitcnt lgkmcnt(12)
  v_mfma_f32_32x32x16_bf16 v[160:175], v[32:35], v[72:75], v[160:175]
  v_exp_f32 v24, v105
  v_fma_f32 v107, v107, s22, -v11
  v_add_f32 v31, v31, v25
  v_cvt_pk_bf16_f32 v61, v61, v25
  v_mfma_f32_32x32x16_bf16 a[160:175], v[32:35], v[64:67], a[160:175]
  s_waitcnt lgkmcnt(10)
  s_barrier
  s_add_u32 m0, s21, 0
  s_nop 0
  buffer_load_dwordx4 v2, s[8:11], s33 offen offset:0 lds
  ds_read_b64_tr_b16 v[32:33], v16 offset:33024
  ds_read_b64_tr_b16 v[34:35], v17 offset:33024
  s_waitcnt lgkmcnt(10)
  v_mfma_f32_32x32x16_bf16 v[160:175], v[36:39], v[76:79], v[160:175]
  v_exp_f32 v59, v106
  s_waitcnt vmcnt(1)
  s_barrier
  v_fma_f32 v108, v108, s22, -v11
  v_add_f32 v0, v58, v24
  v_mfma_f32_32x32x16_bf16 a[160:175], v[36:39], v[68:71], a[160:175]
  buffer_load_dwordx4 v3, s[8:11], s33 offen offset:1024 lds
  ds_read_b64_tr_b16 v[36:37], v16 offset:41216
  ds_read_b64_tr_b16 v[38:39], v17 offset:41216
  v_exp_f32 v25, v107
  s_waitcnt lgkmcnt(10)
  v_mfma_f32_32x32x16_bf16 v[176:191], v[40:43], v[72:75], v[176:191]
  v_exp_f32 v62, v108
  v_fma_f32 v109, v109, s22, -v11
  v_cvt_pk_bf16_f32 v58, v58, v24
  v_add_f32 v0, v0, v59
  v_mfma_f32_32x32x16_bf16 a[176:191], v[40:43], v[64:67], a[176:191]
  buffer_load_dwordx4 v4, s[8:11], s33 offen offset:2048 lds
  ds_read_b64_tr_b16 v[40:41], v18 offset:33024
  ds_read_b64_tr_b16 v[42:43], v19 offset:33024
  v_exp_f32 v24, v109
  s_waitcnt lgkmcnt(10)
  v_mfma_f32_32x32x16_bf16 v[176:191], v[44:47], v[76:79], v[176:191]
  v_fma_f32 v110, v110, s22, -v11
  v_add_f32 v0, v0, v25
  v_exp_f32 v63, v110
  v_fma_f32 v111, v111, s22, -v11
  v_mfma_f32_32x32x16_bf16 a[176:191], v[44:47], v[68:71], a[176:191]
  buffer_load_dwordx4 v5, s[8:11], s33 offen offset:3072 lds
  ds_read_b64_tr_b16 v[44:45], v18 offset:41216
  ds_read_b64_tr_b16 v[46:47], v19 offset:41216
  v_cvt_pk_bf16_f32 v59, v59, v25
  s_waitcnt lgkmcnt(10)
  v_mfma_f32_32x32x16_bf16 v[192:207], v[48:51], v[72:75], v[192:207]
  v_add_f32 v0, v0, v62
  v_exp_f32 v25, v111
  v_add_f32 v0, v0, v24
  v_cvt_pk_bf16_f32 v62, v62, v24
  v_mfma_f32_32x32x16_bf16 a[192:207], v[48:51], v[64:67], a[192:207]
  ds_read_b64_tr_b16 v[48:49], v20 offset:33024
  ds_read_b64_tr_b16 v[50:51], v21 offset:33024
  v_add_f32 v0, v0, v63
  v_cvt_pk_bf16_f32 v63, v63, v25
  v_add_f32 v0, v0, v25
  s_waitcnt lgkmcnt(10)
  v_mfma_f32_32x32x16_bf16 v[192:207], v[52:55], v[76:79], v[192:207]
  s_add_u32 m0, s21, 147456
  s_nop 0
  buffer_load_dwordx4 v2, s[4:7], s99 offen offset:0 lds
  v_max_f32 v29, v31, v0
  v_permlane16_swap_b32 v56, v58
  v_permlane16_swap_b32 v57, v59
  v_mfma_f32_32x32x16_bf16 a[192:207], v[52:55], v[68:71], a[192:207]
  ds_read_b64_tr_b16 v[52:53], v20 offset:41216
  ds_read_b64_tr_b16 v[54:55], v21 offset:41216
  v_permlane16_swap_b32 v60, v62
  v_permlane16_swap_b32 v61, v63
  v_cmp_lt_f32 vcc, s23, v29
  s_waitcnt lgkmcnt(10)
  v_mfma_f32_32x32x16_bf16 v[208:223], v[32:35], v[72:75], v[208:223]
  buffer_load_dwordx4 v3, s[4:7], s99 offen offset:1024 lds
  s_cbranch_vccnz RARE17
RET17:
  s_cmp_lg_u32 s26, 0
  v_fma_f32 v80, v80, s22, -v12
  v_fma_f32 v81, v81, s22, -v12
  v_mfma_f32_32x32x16_bf16 a[208:223], v[32:35], v[64:67], a[208:223]
  ds_read_b64_tr_b16 v[32:33], v14 offset:0
  ds_read_b64_tr_b16 v[34:35], v15 offset:0
  v_fma_f32 v82, v82, s22, -v12
  v_fma_f32 v83, v83, s22, -v12
  v_fma_f32 v84, v84, s22, -v12
  s_waitcnt lgkmcnt(10)
  v_mfma_f32_32x32x16_bf16 v[208:223], v[36:39], v[76:79], v[208:223]
  buffer_load_dwordx4 v4, s[4:7], s99 offen offset:2048 lds
  v_add_f32 v26, v26, v31
  v_fma_f32 v85, v85, s22, -v12
  v_fma_f32 v86, v86, s22, -v12
  v_mfma_f32_32x32x16_bf16 a[208:223], v[36:39], v[68:71], a[208:223]
  ds_read_b64_tr_b16 v[36:37], v14 offset:8192
  ds_read_b64_tr_b16 v[38:39], v15 offset:8192
  v_fma_f32 v87, v87, s22, -v12
  v_fma_f32 v88, v88, s22, -v13
  v_fma_f32 v89, v89, s22, -v13
  s_waitcnt lgkmcnt(10)
  v_mfma_f32_32x32x16_bf16 v[224:239], v[40:43], v[72:75], v[224:239]
  buffer_load_dwordx4 v5, s[4:7], s99 offen offset:3072 lds
  v_fma_f32 v90, v90, s22, -v13
  v_fma_f32 v91, v91, s22, -v13
  v_fma_f32 v92, v92, s22, -v13
  v_mfma_f32_32x32x16_bf16 a[224:239], v[40:43], v[64:67], a[224:239]
  ds_read_b64_tr_b16 v[40:41], v16 offset:0
  ds_read_b64_tr_b16 v[42:43], v17 offset:0
  v_add_f32 v27, v27, v0
  v_fma_f32 v93, v93, s22, -v13
  v_fma_f32 v94, v94, s22, -v13
  s_waitcnt lgkmcnt(10)
  v_mfma_f32_32x32x16_bf16 v[224:239], v[44:47], v[76:79], v[224:239]
  v_fma_f32 v95, v95, s22, -v13
  v_permlane16_swap_b32 v26, v27
  ds_read_b128 a[64:67], v116 offset:0
  v_add_f32 v26, v26, v27
  ds_read_b128 a[96:99], v116 offset:8192
  v_mfma_f32_32x32x16_bf16 a[224:239], v[44:47], v[68:71], a[224:239]
  ds_read_b64_tr_b16 v[44:45], v16 offset:8192
  ds_read_b64_tr_b16 v[46:47], v17 offset:8192
  ds_read_b128 a[68:71], v117 offset:0
  ds_read_b128 a[100:103], v117 offset:8192
  ds_read_b128 a[72:75], v118 offset:0
  s_waitcnt lgkmcnt(15)
  v_mfma_f32_32x32x16_bf16 v[240:255], v[48:51], v[72:75], v[240:255]
  v_exp_f32 v72, v80
  ds_read_b128 a[104:107], v118 offset:8192
  ds_read_b128 a[76:79], v119 offset:0
  ds_read_b128 a[108:111], v119 offset:8192
  v_mfma_f32_32x32x16_bf16 a[240:255], v[48:51], v[64:67], a[240:255]
  ds_read_b64_tr_b16 v[48:49], v18 offset:0
  ds_read_b64_tr_b16 v[50:51], v19 offset:0
  v_exp_f32 v73, v82
  ds_read_b128 a[80:83], v116 offset:256
  s_waitcnt lgkmcnt(15)
  v_mfma_f32_32x32x16_bf16 v[240:255], v[52:55], v[76:79], v[240:255]
  v_exp_f32 v76, v84
  ds_read_b128 a[112:115], v116 offset:8448
  ds_read_b128 a[84:87], v117 offset:256
  ds_read_b128 a[116:119], v117 offset:8448
  v_mfma_f32_32x32x16_bf16 a[240:255], v[52:55], v[68:71], a[240:255]
  ds_read_b64_tr_b16 v[52:53], v18 offset:8192
  ds_read_b64_tr_b16 v[54:55], v19 offset:8192
  v_exp_f32 v77, v86
  s_cbranch_scc1 RARE18
RET18:
  v_mfma_f32_32x32x16_bf16 v[128:143], v[32:35], v[56:59], v[128:143]
  ds_read_b64_tr_b16 v[32:33], v20 offset:0
  ds_read_b64_tr_b16 v[34:35], v21 offset:0
  v_exp_f32 v24, v81
  ds_read_b128 a[88:91], v118 offset:256
  v_mfma_f32_32x32x16_bf16 v[128:143], v[36:39], v[60:63], v[128:143]
  ds_read_b64_tr_b16 v[36:37], v20 offset:8192
  ds_read_b64_tr_b16 v[38:39], v21 offset:8192
  v_exp_f32 v25, v83
  v_add_f32 v31, v72, v24
  s_waitcnt lgkmcnt(15)
  v_mfma_f32_32x32x16_bf16 v[144:159], v[40:43], v[56:59], v[144:159]
  ds_read_b64_tr_b16 v[40:41], v14 offset:256
  ds_read_b64_tr_b16 v[42:43], v15 offset:256
  v_cvt_pk_bf16_f32 v72, v72, v24
  v_add_f32 v31, v31, v73
  v_exp_f32 v24, v85
  v_mfma_f32_32x32x16_bf16 v[144:159], v[44:47], v[60:63], v[144:159]
  ds_read_b64_tr_b16 v[44:45], v14 offset:8448
  ds_read_b64_tr_b16 v[46:47], v15 offset:8448
  v_add_f32 v31, v31, v25
  v_cvt_pk_bf16_f32 v73, v73, v25
  v_add_f32 v31, v31, v76
  s_waitcnt lgkmcnt(15)
  v_mfma_f32_32x32x16_bf16 v[160:175], v[48:51], v[56:59], v[160:175]
  ds_read_b64_tr_b16 v[48:49], v16 offset:256
  ds_read_b64_tr_b16 v[50:51], v17 offset:256
  v_exp_f32 v25, v87
  v_add_f32 v31, v31, v24
  s_waitcnt lgkmcnt(11)
  v_mfma_f32_32x32x16_bf16 v[160:175], v[52:55], v[60:63], v[160:175]
  ds_read_b64_tr_b16 v[52:53], v16 offset:8448
  ds_read_b64_tr_b16 v[54:55], v17 offset:8448
  v_cvt_pk_bf16_f32 v76, v76, v24
  v_exp_f32 v74, v88
  s_waitcnt lgkmcnt(11)
  v_mfma_f32_32x32x16_bf16 v[176:191], v[32:35], v[56:59], v[176:191]
  ds_read_b64_tr_b16 v[32:33], v18 offset:256
  ds_read_b64_tr_b16 v[34:35], v19 offset:256
  v_exp_f32 v24, v89
  v_add_f32 v31, v31, v77
  s_waitcnt lgkmcnt(10)
  v_mfma_f32_32x32x16_bf16 v[176:191], v[36:39], v[60:63], v[176:191]
  ds_read_b64_tr_b16 v[36:37], v18 offset:8448
  ds_read_b64_tr_b16 v[38:39], v19 offset:8448
  v_exp_f32 v75, v90
  v_add_f32 v31, v31, v25
  s_waitcnt lgkmcnt(10)
  v_mfma_f32_32x32x16_bf16 v[192:207], v[40:43], v[56:59], v[192:207]
  ds_read_b64_tr_b16 v[40:41], v20 offset:256
  ds_read_b64_tr_b16 v[42:43], v21 offset:256
  v_cvt_pk_bf16_f32 v77, v77, v25
  v_exp_f32 v25, v91
  s_waitcnt lgkmcnt(10)
  v_mfma_f32_32x32x16_bf16 v[192:207], v[44:47], v[60:63], v[192:207]
  ds_read_b64_tr_b16 v[44:45], v20 offset:8448
  ds_read_b64_tr_b16 v[46:47], v21 offset:8448
  v_add_f32 v0, v74, v24
  v_exp_f32 v78, v92
  s_waitcnt lgkmcnt(10)
  v_mfma_f32_32x32x16_bf16 v[208:223], v[48:51], v[56:59], v[208:223]
  ds_read_b64_tr_b16 v[48:49], v14 offset:0
  ds_read_b64_tr_b16 v[50:51], v15 offset:0
  v_cvt_pk_bf16_f32 v74, v74, v24
  v_add_f32 v0, v0, v75
  v_exp_f32 v24, v93
  s_waitcnt lgkmcnt(10)
  v_mfma_f32_32x32x16_bf16 v[208:223], v[52:55], v[60:63], v[208:223]
  ds_read_b64_tr_b16 v[52:53], v14 offset:8192
  ds_read_b64_tr_b16 v[54:55], v15 offset:8192
  v_add_f32 v0, v0, v25
  v_exp_f32 v79, v94
  s_waitcnt lgkmcnt(10)
  v_mfma_f32_32x32x16_bf16 v[224:239], v[32:35], v[56:59], v[224:239]
  v_cvt_pk_bf16_f32 v75, v75, v25
  v_add_f32 v0, v0, v78
  v_exp_f32 v25, v95
  ds_read_b64_tr_b16 v[32:33], v16 offset:0
  s_waitcnt lgkmcnt(9)
  v_mfma_f32_32x32x16_bf16 v[224:239], v[36:39], v[60:63], v[224:239]
  ds_read_b64_tr_b16 v[34:35], v17 offset:0
  v_add_f32 v0, v0, v24
  ds_read_b64_tr_b16 v[36:37], v16 offset:8192
  v_add_f32 v0, v0, v79
  ds_read_b64_tr_b16 v[38:39], v17 offset:8192
  s_waitcnt lgkmcnt(10)
  v_mfma_f32_32x32x16_bf16 v[240:255], v[40:43], v[56:59], v[240:255]
  v_add_f32 v0, v0, v25
  v_cvt_pk_bf16_f32 v78, v78, v24
  v_cvt_pk_bf16_f32 v79, v79, v25
  v_max_f32 v29, v31, v0
  v_permlane16_swap_b32 v72, v74
  s_waitcnt lgkmcnt(8)
  v_mfma_f32_32x32x16_bf16 v[240:255], v[44:47], v[60:63], v[240:255]
  v_permlane16_swap_b32 v73, v75
  v_permlane16_swap_b32 v76, v78
  v_permlane16_swap_b32 v77, v79
  v_cmp_lt_f32 vcc, s23, v29
  ds_read_b64_tr_b16 v[40:41], v18 offset:0
  s_cbranch_vccnz RARE19
RET19:
  s_waitcnt lgkmcnt(7)
  v_mfma_f32_32x32x16_bf16 a[128:143], v[48:51], v[72:75], a[128:143]
  ds_read_b64_tr_b16 v[42:43], v19 offset:0
  ds_read_b64_tr_b16 v[44:45], v18 offset:8192
  ds_read_b64_tr_b16 v[46:47], v19 offset:8192
  ds_read_b64_tr_b16 v[48:49], v20 offset:0
  ds_read_b64_tr_b16 v[50:51], v21 offset:0
  s_waitcnt lgkmcnt(10)
  v_mfma_f32_32x32x16_bf16 a[128:143], v[52:55], v[76:79], a[128:143]
  ds_read_b64_tr_b16 v[52:53], v20 offset:8192
  ds_read_b64_tr_b16 v[54:55], v21 offset:8192
  v_add_f32 v22, v22, v31
  v_add_f32 v23, v23, v0
  v_mov_b32 v31, v26
  s_waitcnt lgkmcnt(10)
  v_mfma_f32_32x32x16_bf16 a[144:159], v[32:35], v[72:75], a[144:159]
  ds_read_b64_tr_b16 v[32:33], v14 offset:256
  ds_read_b64_tr_b16 v[34:35], v15 offset:256
  v_permlane16_swap_b32 v22, v23
  v_permlane32_swap_b32 v26, v31
  v_add_f32 v22, v22, v23
  s_waitcnt lgkmcnt(10)
  v_mfma_f32_32x32x16_bf16 a[144:159], v[36:39], v[76:79], a[144:159]
  ds_read_b64_tr_b16 v[36:37], v14 offset:8448
  ds_read_b64_tr_b16 v[38:39], v15 offset:8448
  v_mov_b32 v29, v22
  v_add_f32 v31, v31, v26
  s_nop 0
  v_permlane32_swap_b32 v22, v29
  s_waitcnt lgkmcnt(10)
  v_mfma_f32_32x32x16_bf16 a[160:175], v[40:43], v[72:75], a[160:175]
  ds_read_b64_tr_b16 v[40:41], v16 offset:256
  ds_read_b64_tr_b16 v[42:43], v17 offset:256
  v_add_f32 v29, v29, v22
  ds_read_b128 a[120:123], v118 offset:8448
  ds_read_b128 a[92:95], v119 offset:256
  s_waitcnt lgkmcnt(12)
  v_mfma_f32_32x32x16_bf16 a[160:175], v[44:47], v[76:79], a[160:175]
  ds_read_b64_tr_b16 v[44:45], v16 offset:8448
  ds_read_b64_tr_b16 v[46:47], v17 offset:8448
  ds_read_b128 a[124:127], v119 offset:8448
  v_rcp_f32 v28, v31
  s_waitcnt lgkmcnt(13)
  v_mfma_f32_32x32x16_bf16 a[176:191], v[48:51], v[72:75], a[176:191]
  ds_read_b64_tr_b16 v[48:49], v18 offset:256
  ds_read_b64_tr_b16 v[50:51], v19 offset:256
  v_rcp_f32 v30, v29
  s_waitcnt lgkmcnt(13)
  v_mfma_f32_32x32x16_bf16 a[176:191], v[52:55], v[76:79], a[176:191]
  ds_read_b64_tr_b16 v[52:53], v18 offset:8448
  ds_read_b64_tr_b16 v[54:55], v19 offset:8448
  s_waitcnt lgkmcnt(13)
  v_mfma_f32_32x32x16_bf16 a[192:207], v[32:35], v[72:75], a[192:207]
  ds_read_b64_tr_b16 v[32:33], v20 offset:256
  ds_read_b64_tr_b16 v[34:35], v21 offset:256
  s_waitcnt lgkmcnt(13)
  v_mfma_f32_32x32x16_bf16 a[192:207], v[36:39], v[76:79], a[192:207]
  ds_read_b64_tr_b16 v[36:37], v20 offset:8448
  ds_read_b64_tr_b16 v[38:39], v21 offset:8448
  s_waitcnt lgkmcnt(13)
  v_mfma_f32_32x32x16_bf16 a[208:223], v[40:43], v[72:75], a[208:223]
  s_waitcnt lgkmcnt(9)
  v_mfma_f32_32x32x16_bf16 a[208:223], v[44:47], v[76:79], a[208:223]
  s_waitcnt lgkmcnt(6)
  v_mfma_f32_32x32x16_bf16 a[224:239], v[48:51], v[72:75], a[224:239]
  s_waitcnt lgkmcnt(4)
  v_mfma_f32_32x32x16_bf16 a[224:239], v[52:55], v[76:79], a[224:239]
  s_waitcnt lgkmcnt(2)
  v_mfma_f32_32x32x16_bf16 a[240:255], v[32:35], v[72:75], a[240:255]
  s_waitcnt lgkmcnt(0)
  v_mfma_f32_32x32x16_bf16 a[240:255], v[36:39], v[76:79], a[240:255]
  s_cmp_lt_u32 s25, 3
  s_cbranch_scc1 MREG
  v_lshrrev_b32 v77, 9, v1
  v_bfe_u32 v76, v1, 4, 5
  v_lshlrev_b32 v77, 1, v77
  v_and_b32 v72, 7, v76
  v_lshrrev_b32 v78, 4, v1
  v_xor_b32 v72, v72, v77
  v_and_b32 v77, 7, v78
  v_lshlrev_b32 v72, 4, v72
  v_mul_f32 v128, v128, v28
  v_lshl_or_b32 v72, v76, 7, v72
  v_lshrrev_b32 v76, 3, v78
  v_mul_f32 v129, v129, v28
  v_mul_f32 v130, v130, v28
  v_mul_f32 v131, v131, v28
  v_mul_f32 v132, v132, v28
  v_mul_f32 v133, v133, v28
  v_mul_f32 v134, v134, v28
  v_mul_f32 v135, v135, v28
  v_add_u32 v72, s59, v72
  v_mul_f32 v136, v136, v28
  v_mul_f32 v137, v137, v28
  v_mul_f32 v138, v138, v28
  v_mul_f32 v139, v139, v28
  v_mul_f32 v140, v140, v28
  v_mul_f32 v141, v141, v28
  v_mul_f32 v142, v142, v28
  v_mul_f32 v143, v143, v28
  v_xor_b32 v77, v76, v77
  v_cvt_pk_bf16_f32 v64, v128, v129
  v_cvt_pk_bf16_f32 v65, v130, v131
  v_cvt_pk_bf16_f32 v66, v132, v133
  v_cvt_pk_bf16_f32 v67, v134, v135
  v_xor_b32 v73, 16, v72
  v_cvt_pk_bf16_f32 v68, v136, v137
  v_cvt_pk_bf16_f32 v69, v138, v139
  v_cvt_pk_bf16_f32 v70, v140, v141
  v_cvt_pk_bf16_f32 v71, v142, v143
  v_mul_f32 v144, v144, v28
  v_mul_f32 v145, v145, v28
  v_mul_f32 v146, v146, v28
  v_mul_f32 v147, v147, v28
  v_mul_f32 v148, v148, v28
  v_mul_f32 v149, v149, v28
  v_mul_f32 v150, v150, v28
  v_mul_f32 v151, v151, v28
  v_mul_f32 v152, v152, v28
  v_mul_f32 v153, v153, v28
  v_mul_f32 v154, v154, v28
  v_mul_f32 v155, v155, v28
  v_mul_f32 v156, v156, v28
  v_mul_f32 v157, v157, v28
  v_mul_f32 v158, v158, v28
  v_mul_f32 v159, v159, v28
  v_lshlrev_b32 v77, 4, v77
  ds_write_b128 v72, v[64:67]
  v_xor_b32 v74, 64, v72
  v_lshlrev_b32 v78, 4, v78
  ds_write_b128 v73, v[68:71]
  v_cvt_pk_bf16_f32 v64, v144, v145
  v_cvt_pk_bf16_f32 v65, v146, v147
  v_cvt_pk_bf16_f32 v66, v148, v149
  v_cvt_pk_bf16_f32 v67, v150, v151
  v_xor_b32 v75, 0x50, v72
  v_cvt_pk_bf16_f32 v68, v152, v153
  v_cvt_pk_bf16_f32 v69, v154, v155
  v_cvt_pk_bf16_f32 v70, v156, v157
  v_cvt_pk_bf16_f32 v71, v158, v159
  v_lshl_or_b32 v77, v76, 9, v77
  v_add_u32 v76, s59, v78
  ds_write_b128 v74, v[64:67]
  ds_write_b128 v75, v[68:71]
  ds_read_b128 v[48:51], v76 offset:0
  ds_read_b128 v[52:55], v76 offset:1024
  ds_read_b128 v[60:63], v76 offset:2048
  v_mul_f32 v160, v160, v28
  v_mul_f32 v161, v161, v28
  v_mul_f32 v162, v162, v28
  v_mul_f32 v163, v163, v28
  v_mul_f32 v164, v164, v28
  v_mul_f32 v165, v165, v28
  v_mul_f32 v166, v166, v28
  v_mul_f32 v167, v167, v28
  v_mul_f32 v168, v168, v28
  v_mul_f32 v169, v169, v28
  v_mul_f32 v170, v170, v28
  v_mul_f32 v171, v171, v28
  v_mul_f32 v172, v172, v28
  v_mul_f32 v173, v173, v28
  v_mul_f32 v174, v174, v28
  v_mul_f32 v175, v175, v28
  s_add_u32 s52, s41, 0
  v_cvt_pk_bf16_f32 v64, v160, v161
  v_cvt_pk_bf16_f32 v65, v162, v163
  v_cvt_pk_bf16_f32 v66, v164, v165
  v_cvt_pk_bf16_f32 v67, v166, v167
  v_cvt_pk_bf16_f32 v68, v168, v169
  v_cvt_pk_bf16_f32 v69, v170, v171
  v_cvt_pk_bf16_f32 v70, v172, v173
  v_cvt_pk_bf16_f32 v71, v174, v175
  v_mul_f32 v176, v176, v28
  v_mul_f32 v177, v177, v28
  v_mul_f32 v178, v178, v28
  v_mul_f32 v179, v179, v28
  v_mul_f32 v180, v180, v28
  s_waitcnt lgkmcnt(2)
  buffer_store_dwordx4 v[48:51], v77, s[16:19], s52 offen offset:0 sc0 sc1 nt
  v_mul_f32 v181, v181, v28
  v_mul_f32 v182, v182, v28
  v_mul_f32 v183, v183, v28
  ds_read_b128 v[48:51], v76 offset:3072
  v_mul_f32 v184, v184, v28
  v_mul_f32 v185, v185, v28
  v_mul_f32 v186, v186, v28
  v_mul_f32 v187, v187, v28
  v_mul_f32 v188, v188, v28
  v_mul_f32 v189, v189, v28
  v_mul_f32 v190, v190, v28
  v_mul_f32 v191, v191, v28
  ds_write_b128 v72, v[64:67]
  ds_write_b128 v73, v[68:71]
  s_nop 0
  v_cvt_pk_bf16_f32 v64, v176, v177
  v_cvt_pk_bf16_f32 v65, v178, v179
  v_cvt_pk_bf16_f32 v66, v180, v181
  v_cvt_pk_bf16_f32 v67, v182, v183
  v_cvt_pk_bf16_f32 v68, v184, v185
  v_cvt_pk_bf16_f32 v69, v186, v187
  v_cvt_pk_bf16_f32 v70, v188, v189
  v_cvt_pk_bf16_f32 v71, v190, v191
  s_add_u32 s53, s41, 4096
  ds_write_b128 v74, v[64:67]
  ds_write_b128 v75, v[68:71]
  s_waitcnt lgkmcnt(6)
  buffer_store_dwordx4 v[52:55], v77, s[16:19], s53 offen offset:0 sc0 sc1 nt
  s_nop 1
  ds_read_b128 v[52:55], v76 offset:0
  s_add_u32 s54, s41, 8192
  s_waitcnt lgkmcnt(6)
  buffer_store_dwordx4 v[60:63], v77, s[16:19], s54 offen offset:0 sc0 sc1 nt
  s_nop 1
  ds_read_b128 v[60:63], v76 offset:1024
  s_add_u32 s55, s41, 12288
  v_mul_f32 v192, v192, v28
  v_mul_f32 v193, v193, v28
  v_mul_f32 v194, v194, v28
  v_mul_f32 v195, v195, v28
  v_mul_f32 v196, v196, v28
  s_waitcnt lgkmcnt(6)
  buffer_store_dwordx4 v[48:51], v77, s[16:19], s55 offen offset:0 sc0 sc1 nt
  s_nop 1
  ds_read_b128 v[48:51], v76 offset:2048
  v_mul_f32 v197, v197, v28
  v_mul_f32 v198, v198, v28
  v_mul_f32 v199, v199, v28
  v_mul_f32 v200, v200, v28
  v_mul_f32 v201, v201, v28
  v_mul_f32 v202, v202, v28
  v_mul_f32 v203, v203, v28
  v_mul_f32 v204, v204, v28
  v_mul_f32 v205, v205, v28
  v_mul_f32 v206, v206, v28
  v_mul_f32 v207, v207, v28
  v_cvt_pk_bf16_f32 v64, v192, v193
  v_cvt_pk_bf16_f32 v65, v194, v195
  v_cvt_pk_bf16_f32 v66, v196, v197
  v_cvt_pk_bf16_f32 v67, v198, v199
  v_cvt_pk_bf16_f32 v68, v200, v201
  v_cvt_pk_bf16_f32 v69, v202, v203
  v_cvt_pk_bf16_f32 v70, v204, v205
  v_cvt_pk_bf16_f32 v71, v206, v207
  v_mul_f32 v208, v208, v28
  v_mul_f32 v209, v209, v28
  s_waitcnt lgkmcnt(2)
  buffer_store_dwordx4 v[52:55], v77, s[16:19], s52 offen offset:128 sc0 sc1 nt
  s_nop 1
  ds_read_b128 v[52:55], v76 offset:3072
  v_mul_f32 v210, v210, v28
  v_mul_f32 v211, v211, v28
  v_mul_f32 v212, v212, v28
  v_mul_f32 v213, v213, v28
  v_mul_f32 v214, v214, v28
  v_mul_f32 v215, v215, v28
  v_mul_f32 v216, v216, v28
  v_mul_f32 v217, v217, v28
  v_mul_f32 v218, v218, v28
  v_mul_f32 v219, v219, v28
  v_mul_f32 v220, v220, v28
  v_mul_f32 v221, v221, v28
  v_mul_f32 v222, v222, v28
  v_mul_f32 v223, v223, v28
  ds_write_b128 v72, v[64:67]
  ds_write_b128 v73, v[68:71]
  s_nop 0
  v_cvt_pk_bf16_f32 v64, v208, v209
  v_cvt_pk_bf16_f32 v65, v210, v211
  v_cvt_pk_bf16_f32 v66, v212, v213
  v_cvt_pk_bf16_f32 v67, v214, v215
  v_cvt_pk_bf16_f32 v68, v216, v217
  v_cvt_pk_bf16_f32 v69, v218, v219
  v_cvt_pk_bf16_f32 v70, v220, v221
  v_cvt_pk_bf16_f32 v71, v222, v223
  ds_write_b128 v74, v[64:67]
  ds_write_b128 v75, v[68:71]
  s_waitcnt lgkmcnt(6)
  buffer_store_dwordx4 v[60:63], v77, s[16:19], s53 offen offset:128 sc0 sc1 nt
  s_nop 1
  ds_read_b128 v[60:63], v76 offset:0
  s_waitcnt lgkmcnt(6)
  buffer_store_dwordx4 v[48:51], v77, s[16:19], s54 offen offset:128 sc0 sc1 nt
  s_nop 1
  ds_read_b128 v[48:51], v76 offset:1024
  v_mul_f32 v224, v224, v28
  v_mul_f32 v225, v225, v28
  s_waitcnt lgkmcnt(6)
  buffer_store_dwordx4 v[52:55], v77, s[16:19], s55 offen offset:128 sc0 sc1 nt
  s_nop 1
  ds_read_b128 v[52:55], v76 offset:2048
  v_mul_f32 v226, v226, v28
  v_mul_f32 v227, v227, v28
  v_mul_f32 v228, v228, v28
  v_mul_f32 v229, v229, v28
  v_mul_f32 v230, v230, v28
  v_mul_f32 v231, v231, v28
  v_mul_f32 v232, v232, v28
  v_mul_f32 v233, v233, v28
  v_mul_f32 v234, v234, v28
  v_mul_f32 v235, v235, v28
  v_mul_f32 v236, v236, v28
  v_mul_f32 v237, v237, v28
  v_mul_f32 v238, v238, v28
  v_mul_f32 v239, v239, v28
  v_cvt_pk_bf16_f32 v64, v224, v225
  v_cvt_pk_bf16_f32 v65, v226, v227
  v_cvt_pk_bf16_f32 v66, v228, v229
  v_cvt_pk_bf16_f32 v67, v230, v231
  v_cvt_pk_bf16_f32 v68, v232, v233
  v_cvt_pk_bf16_f32 v69, v234, v235
  v_cvt_pk_bf16_f32 v70, v236, v237
  v_cvt_pk_bf16_f32 v71, v238, v239
  v_mul_f32 v240, v240, v28
  v_mul_f32 v241, v241, v28
  v_mul_f32 v242, v242, v28
  v_mul_f32 v243, v243, v28
  s_waitcnt lgkmcnt(2)
  buffer_store_dwordx4 v[60:63], v77, s[16:19], s52 offen offset:256 sc0 sc1 nt
  v_mul_f32 v244, v244, v28
  v_mul_f32 v245, v245, v28
  v_mul_f32 v246, v246, v28
  v_mul_f32 v247, v247, v28
  ds_read_b128 v[60:63], v76 offset:3072
  v_mul_f32 v248, v248, v28
  v_mul_f32 v249, v249, v28
  v_mul_f32 v250, v250, v28
  v_mul_f32 v251, v251, v28
  v_mul_f32 v252, v252, v28
  v_mul_f32 v253, v253, v28
  v_mul_f32 v254, v254, v28
  v_mul_f32 v255, v255, v28
  ds_write_b128 v72, v[64:67]
  ds_write_b128 v73, v[68:71]
  s_nop 0
  v_cvt_pk_bf16_f32 v64, v240, v241
  v_cvt_pk_bf16_f32 v65, v242, v243
  v_cvt_pk_bf16_f32 v66, v244, v245
  v_cvt_pk_bf16_f32 v67, v246, v247
  v_cvt_pk_bf16_f32 v68, v248, v249
  v_cvt_pk_bf16_f32 v69, v250, v251
  v_cvt_pk_bf16_f32 v70, v252, v253
  v_cvt_pk_bf16_f32 v71, v254, v255
  ds_write_b128 v74, v[64:67]
  ds_write_b128 v75, v[68:71]
  s_waitcnt lgkmcnt(6)
  buffer_store_dwordx4 v[48:51], v77, s[16:19], s53 offen offset:256 sc0 sc1 nt
  s_nop 1
  ds_read_b128 v[48:51], v76 offset:0
  s_waitcnt lgkmcnt(6)
  buffer_store_dwordx4 v[52:55], v77, s[16:19], s54 offen offset:256 sc0 sc1 nt
  s_nop 1
  ds_read_b128 v[52:55], v76 offset:1024
  v_accvgpr_read_b32 v112, a128
  v_accvgpr_read_b32 v113, a129
  v_accvgpr_read_b32 v114, a130
  v_accvgpr_read_b32 v115, a131
  v_accvgpr_read_b32 v116, a132
  v_accvgpr_read_b32 v117, a133
  v_accvgpr_read_b32 v118, a134
  v_accvgpr_read_b32 v119, a135
  v_accvgpr_read_b32 v120, a136
  v_accvgpr_read_b32 v121, a137
  v_accvgpr_read_b32 v122, a138
  v_accvgpr_read_b32 v123, a139
  v_accvgpr_read_b32 v124, a140
  v_accvgpr_read_b32 v125, a141
  v_accvgpr_read_b32 v126, a142
  v_accvgpr_read_b32 v127, a143
  s_waitcnt lgkmcnt(6)
  buffer_store_dwordx4 v[60:63], v77, s[16:19], s55 offen offset:256 sc0 sc1 nt
  s_nop 1
  ds_read_b128 v[60:63], v76 offset:2048
  v_mul_f32 v112, v112, v30
  v_mul_f32 v113, v113, v30
  v_mul_f32 v114, v114, v30
  v_mul_f32 v115, v115, v30
  v_mul_f32 v116, v116, v30
  v_mul_f32 v117, v117, v30
  v_mul_f32 v118, v118, v30
  v_mul_f32 v119, v119, v30
  v_mul_f32 v120, v120, v30
  v_mul_f32 v121, v121, v30
  v_mul_f32 v122, v122, v30
  v_mul_f32 v123, v123, v30
  v_mul_f32 v124, v124, v30
  v_mul_f32 v125, v125, v30
  v_mul_f32 v126, v126, v30
  v_mul_f32 v127, v127, v30
  v_cvt_pk_bf16_f32 v64, v112, v113
  v_cvt_pk_bf16_f32 v65, v114, v115
  v_cvt_pk_bf16_f32 v66, v116, v117
  v_cvt_pk_bf16_f32 v67, v118, v119
  v_cvt_pk_bf16_f32 v68, v120, v121
  v_cvt_pk_bf16_f32 v69, v122, v123
  v_cvt_pk_bf16_f32 v70, v124, v125
  v_cvt_pk_bf16_f32 v71, v126, v127
  v_accvgpr_read_b32 v112, a144
  v_accvgpr_read_b32 v113, a145
  v_accvgpr_read_b32 v114, a146
  v_accvgpr_read_b32 v115, a147
  v_accvgpr_read_b32 v116, a148
  v_accvgpr_read_b32 v117, a149
  v_accvgpr_read_b32 v118, a150
  v_accvgpr_read_b32 v119, a151
  v_accvgpr_read_b32 v120, a152
  v_accvgpr_read_b32 v121, a153
  v_accvgpr_read_b32 v122, a154
  v_accvgpr_read_b32 v123, a155
  v_accvgpr_read_b32 v124, a156
  v_accvgpr_read_b32 v125, a157
  v_accvgpr_read_b32 v126, a158
  v_accvgpr_read_b32 v127, a159
  s_waitcnt lgkmcnt(2)
  buffer_store_dwordx4 v[48:51], v77, s[16:19], s52 offen offset:384 sc0 sc1 nt
  v_mul_f32 v112, v112, v30
  v_mul_f32 v113, v113, v30
  v_mul_f32 v114, v114, v30
  v_mul_f32 v115, v115, v30
  v_mul_f32 v116, v116, v30
  v_mul_f32 v117, v117, v30
  v_mul_f32 v118, v118, v30
  v_mul_f32 v119, v119, v30
  ds_read_b128 v[48:51], v76 offset:3072
  v_mul_f32 v120, v120, v30
  v_mul_f32 v121, v121, v30
  v_mul_f32 v122, v122, v30
  v_mul_f32 v123, v123, v30
  v_mul_f32 v124, v124, v30
  v_mul_f32 v125, v125, v30
  v_mul_f32 v126, v126, v30
  v_mul_f32 v127, v127, v30
  ds_write_b128 v72, v[64:67]
  ds_write_b128 v73, v[68:71]
  s_nop 0
  v_cvt_pk_bf16_f32 v64, v112, v113
  v_cvt_pk_bf16_f32 v65, v114, v115
  v_cvt_pk_bf16_f32 v66, v116, v117
  v_cvt_pk_bf16_f32 v67, v118, v119
  v_cvt_pk_bf16_f32 v68, v120, v121
  v_cvt_pk_bf16_f32 v69, v122, v123
  v_cvt_pk_bf16_f32 v70, v124, v125
  v_cvt_pk_bf16_f32 v71, v126, v127
  ds_write_b128 v74, v[64:67]
  ds_write_b128 v75, v[68:71]
  s_waitcnt lgkmcnt(6)
  buffer_store_dwordx4 v[52:55], v77, s[16:19], s53 offen offset:384 sc0 sc1 nt
  s_nop 1
  ds_read_b128 v[52:55], v76 offset:0
  s_waitcnt lgkmcnt(6)
  buffer_store_dwordx4 v[60:63], v77, s[16:19], s54 offen offset:384 sc0 sc1 nt
  s_nop 1
  ds_read_b128 v[60:63], v76 offset:1024
  s_add_u32 s52, s42, 0
  v_accvgpr_read_b32 v112, a160
  v_accvgpr_read_b32 v113, a161
  v_accvgpr_read_b32 v114, a162
  v_accvgpr_read_b32 v115, a163
  v_accvgpr_read_b32 v116, a164
  v_accvgpr_read_b32 v117, a165
  v_accvgpr_read_b32 v118, a166
  s_waitcnt lgkmcnt(6)
  buffer_store_dwordx4 v[48:51], v77, s[16:19], s55 offen offset:384 sc0 sc1 nt
  s_nop 1
  ds_read_b128 v[48:51], v76 offset:2048
  v_accvgpr_read_b32 v119, a167
  v_accvgpr_read_b32 v120, a168
  v_accvgpr_read_b32 v121, a169
  v_accvgpr_read_b32 v122, a170
  v_accvgpr_read_b32 v123, a171
  v_accvgpr_read_b32 v124, a172
  v_accvgpr_read_b32 v125, a173
  v_accvgpr_read_b32 v126, a174
  v_accvgpr_read_b32 v127, a175
  v_mul_f32 v112, v112, v30
  v_mul_f32 v113, v113, v30
  v_mul_f32 v114, v114, v30
  v_mul_f32 v115, v115, v30
  v_mul_f32 v116, v116, v30
  v_mul_f32 v117, v117, v30
  v_mul_f32 v118, v118, v30
  v_mul_f32 v119, v119, v30
  v_mul_f32 v120, v120, v30
  v_mul_f32 v121, v121, v30
  v_mul_f32 v122, v122, v30
  s_waitcnt lgkmcnt(2)
  buffer_store_dwordx4 v[52:55], v77, s[16:19], s52 offen offset:0 sc0 sc1 nt
  s_nop 1
  ds_read_b128 v[52:55], v76 offset:3072
  v_mul_f32 v123, v123, v30
  v_mul_f32 v124, v124, v30
  v_mul_f32 v125, v125, v30
  v_mul_f32 v126, v126, v30
  v_mul_f32 v127, v127, v30
  v_cvt_pk_bf16_f32 v64, v112, v113
  v_cvt_pk_bf16_f32 v65, v114, v115
  v_cvt_pk_bf16_f32 v66, v116, v117
  v_cvt_pk_bf16_f32 v67, v118, v119
  v_cvt_pk_bf16_f32 v68, v120, v121
  v_cvt_pk_bf16_f32 v69, v122, v123
  v_cvt_pk_bf16_f32 v70, v124, v125
  v_cvt_pk_bf16_f32 v71, v126, v127
  v_accvgpr_read_b32 v112, a176
  v_accvgpr_read_b32 v113, a177
  v_accvgpr_read_b32 v114, a178
  v_accvgpr_read_b32 v115, a179
  v_accvgpr_read_b32 v116, a180
  v_accvgpr_read_b32 v117, a181
  v_accvgpr_read_b32 v118, a182
  v_accvgpr_read_b32 v119, a183
  v_accvgpr_read_b32 v120, a184
  v_accvgpr_read_b32 v121, a185
  v_accvgpr_read_b32 v122, a186
  v_accvgpr_read_b32 v123, a187
  v_accvgpr_read_b32 v124, a188
  v_accvgpr_read_b32 v125, a189
  v_accvgpr_read_b32 v126, a190
  v_accvgpr_read_b32 v127, a191
  v_mul_f32 v112, v112, v30
  v_mul_f32 v113, v113, v30
  v_mul_f32 v114, v114, v30
  v_mul_f32 v115, v115, v30
  v_mul_f32 v116, v116, v30
  v_mul_f32 v117, v117, v30
  v_mul_f32 v118, v118, v30
  v_mul_f32 v119, v119, v30
  v_mul_f32 v120, v120, v30
  v_mul_f32 v121, v121, v30
  v_mul_f32 v122, v122, v30
  v_mul_f32 v123, v123, v30
  v_mul_f32 v124, v124, v30
  v_mul_f32 v125, v125, v30
  v_mul_f32 v126, v126, v30
  v_mul_f32 v127, v127, v30
  ds_write_b128 v72, v[64:67]
  ds_write_b128 v73, v[68:71]
  s_nop 0
  v_cvt_pk_bf16_f32 v64, v112, v113
  v_cvt_pk_bf16_f32 v65, v114, v115
  v_cvt_pk_bf16_f32 v66, v116, v117
  v_cvt_pk_bf16_f32 v67, v118, v119
  v_cvt_pk_bf16_f32 v68, v120, v121
  v_cvt_pk_bf16_f32 v69, v122, v123
  v_cvt_pk_bf16_f32 v70, v124, v125
  v_cvt_pk_bf16_f32 v71, v126, v127
  s_add_u32 s53, s42, 4096
  ds_write_b128 v74, v[64:67]
  ds_write_b128 v75, v[68:71]
  s_waitcnt lgkmcnt(6)
  buffer_store_dwordx4 v[60:63], v77, s[16:19], s53 offen offset:0 sc0 sc1 nt
  s_nop 1
  ds_read_b128 v[60:63], v76 offset:0
  s_add_u32 s54, s42, 8192
  s_waitcnt lgkmcnt(6)
  buffer_store_dwordx4 v[48:51], v77, s[16:19], s54 offen offset:0 sc0 sc1 nt
  s_nop 1
  ds_read_b128 v[48:51], v76 offset:1024
  s_add_u32 s55, s42, 12288
  s_waitcnt lgkmcnt(6)
  buffer_store_dwordx4 v[52:55], v77, s[16:19], s55 offen offset:0 sc0 sc1 nt
  s_nop 1
  ds_read_b128 v[52:55], v76 offset:2048
  v_accvgpr_read_b32 v112, a192
  v_accvgpr_read_b32 v113, a193
  v_accvgpr_read_b32 v114, a194
  v_accvgpr_read_b32 v115, a195
  v_accvgpr_read_b32 v116, a196
  v_accvgpr_read_b32 v117, a197
  v_accvgpr_read_b32 v118, a198
  v_accvgpr_read_b32 v119, a199
  v_accvgpr_read_b32 v120, a200
  v_accvgpr_read_b32 v121, a201
  v_accvgpr_read_b32 v122, a202
  v_accvgpr_read_b32 v123, a203
  v_accvgpr_read_b32 v124, a204
  v_accvgpr_read_b32 v125, a205
  v_accvgpr_read_b32 v126, a206
  v_accvgpr_read_b32 v127, a207
  v_mul_f32 v112, v112, v30
  v_mul_f32 v113, v113, v30
  v_mul_f32 v114, v114, v30
  v_mul_f32 v115, v115, v30
  v_mul_f32 v116, v116, v30
  v_mul_f32 v117, v117, v30
  v_mul_f32 v118, v118, v30
  v_mul_f32 v119, v119, v30
  v_mul_f32 v120, v120, v30
  v_mul_f32 v121, v121, v30
  v_mul_f32 v122, v122, v30
  v_mul_f32 v123, v123, v30
  v_mul_f32 v124, v124, v30
  v_mul_f32 v125, v125, v30
  v_mul_f32 v126, v126, v30
  v_mul_f32 v127, v127, v30
  v_cvt_pk_bf16_f32 v64, v112, v113
  v_cvt_pk_bf16_f32 v65, v114, v115
  v_cvt_pk_bf16_f32 v66, v116, v117
  v_cvt_pk_bf16_f32 v67, v118, v119
  v_cvt_pk_bf16_f32 v68, v120, v121
  v_cvt_pk_bf16_f32 v69, v122, v123
  v_cvt_pk_bf16_f32 v70, v124, v125
  v_cvt_pk_bf16_f32 v71, v126, v127
  v_accvgpr_read_b32 v112, a208
  v_accvgpr_read_b32 v113, a209
  v_accvgpr_read_b32 v114, a210
  v_accvgpr_read_b32 v115, a211
  v_accvgpr_read_b32 v116, a212
  v_accvgpr_read_b32 v117, a213
  v_accvgpr_read_b32 v118, a214
  v_accvgpr_read_b32 v119, a215
  v_accvgpr_read_b32 v120, a216
  v_accvgpr_read_b32 v121, a217
  v_accvgpr_read_b32 v122, a218
  v_accvgpr_read_b32 v123, a219
  v_accvgpr_read_b32 v124, a220
  v_accvgpr_read_b32 v125, a221
  v_accvgpr_read_b32 v126, a222
  v_accvgpr_read_b32 v127, a223
  s_waitcnt lgkmcnt(2)
  buffer_store_dwordx4 v[60:63], v77, s[16:19], s52 offen offset:128 sc0 sc1 nt
  v_mul_f32 v112, v112, v30
  v_mul_f32 v113, v113, v30
  v_mul_f32 v114, v114, v30
  v_mul_f32 v115, v115, v30
  v_mul_f32 v116, v116, v30
  v_mul_f32 v117, v117, v30
  v_mul_f32 v118, v118, v30
  v_mul_f32 v119, v119, v30
  ds_read_b128 v[60:63], v76 offset:3072
  v_mul_f32 v120, v120, v30
  v_mul_f32 v121, v121, v30
  v_mul_f32 v122, v122, v30
  v_mul_f32 v123, v123, v30
  v_mul_f32 v124, v124, v30
  v_mul_f32 v125, v125, v30
  v_mul_f32 v126, v126, v30
  v_mul_f32 v127, v127, v30
  ds_write_b128 v72, v[64:67]
  ds_write_b128 v73, v[68:71]
  s_nop 0
  v_cvt_pk_bf16_f32 v64, v112, v113
  v_cvt_pk_bf16_f32 v65, v114, v115
  v_cvt_pk_bf16_f32 v66, v116, v117
  v_cvt_pk_bf16_f32 v67, v118, v119
  v_cvt_pk_bf16_f32 v68, v120, v121
  v_cvt_pk_bf16_f32 v69, v122, v123
  v_cvt_pk_bf16_f32 v70, v124, v125
  v_cvt_pk_bf16_f32 v71, v126, v127
  ds_write_b128 v74, v[64:67]
  ds_write_b128 v75, v[68:71]
  s_waitcnt lgkmcnt(6)
  buffer_store_dwordx4 v[48:51], v77, s[16:19], s53 offen offset:128 sc0 sc1 nt
  s_nop 1
  ds_read_b128 v[48:51], v76 offset:0
  s_waitcnt lgkmcnt(6)
  buffer_store_dwordx4 v[52:55], v77, s[16:19], s54 offen offset:128 sc0 sc1 nt
  s_nop 1
  ds_read_b128 v[52:55], v76 offset:1024
  v_accvgpr_read_b32 v112, a224
  v_accvgpr_read_b32 v113, a225
  v_accvgpr_read_b32 v114, a226
  v_accvgpr_read_b32 v115, a227
  v_accvgpr_read_b32 v116, a228
  v_accvgpr_read_b32 v117, a229
  v_accvgpr_read_b32 v118, a230
  v_accvgpr_read_b32 v119, a231
  v_accvgpr_read_b32 v120, a232
  v_accvgpr_read_b32 v121, a233
  v_accvgpr_read_b32 v122, a234
  v_accvgpr_read_b32 v123, a235
  v_accvgpr_read_b32 v124, a236
  v_accvgpr_read_b32 v125, a237
  v_accvgpr_read_b32 v126, a238
  v_accvgpr_read_b32 v127, a239
  v_mul_f32 v112, v112, v30
  v_mul_f32 v113, v113, v30
  v_mul_f32 v114, v114, v30
  v_mul_f32 v115, v115, v30
  v_mul_f32 v116, v116, v30
  v_mul_f32 v117, v117, v30
  v_mul_f32 v118, v118, v30
  v_mul_f32 v119, v119, v30
  v_mul_f32 v120, v120, v30
  v_mul_f32 v121, v121, v30
  v_mul_f32 v122, v122, v30
  v_mul_f32 v123, v123, v30
  v_mul_f32 v124, v124, v30
  v_mul_f32 v125, v125, v30
  v_mul_f32 v126, v126, v30
  v_mul_f32 v127, v127, v30
  v_cvt_pk_bf16_f32 v64, v112, v113
  v_cvt_pk_bf16_f32 v65, v114, v115
  v_cvt_pk_bf16_f32 v66, v116, v117
  v_cvt_pk_bf16_f32 v67, v118, v119
  v_cvt_pk_bf16_f32 v68, v120, v121
  v_cvt_pk_bf16_f32 v69, v122, v123
  v_cvt_pk_bf16_f32 v70, v124, v125
  v_cvt_pk_bf16_f32 v71, v126, v127
  v_accvgpr_read_b32 v112, a240
  v_accvgpr_read_b32 v113, a241
  v_accvgpr_read_b32 v114, a242
  v_accvgpr_read_b32 v115, a243
  v_accvgpr_read_b32 v116, a244
  v_accvgpr_read_b32 v117, a245
  v_accvgpr_read_b32 v118, a246
  v_accvgpr_read_b32 v119, a247
  v_accvgpr_read_b32 v120, a248
  v_accvgpr_read_b32 v121, a249
  v_accvgpr_read_b32 v122, a250
  v_accvgpr_read_b32 v123, a251
  v_accvgpr_read_b32 v124, a252
  v_accvgpr_read_b32 v125, a253
  v_accvgpr_read_b32 v126, a254
  v_accvgpr_read_b32 v127, a255
  s_waitcnt lgkmcnt(6)
  buffer_store_dwordx4 v[60:63], v77, s[16:19], s55 offen offset:128 sc0 sc1 nt
  s_waitcnt lgkmcnt(1)
  buffer_store_dwordx4 v[48:51], v77, s[16:19], s52 offen offset:256 sc0 sc1 nt
  v_mul_f32 v112, v112, v30
  v_mul_f32 v113, v113, v30
  v_mul_f32 v114, v114, v30
  v_mul_f32 v115, v115, v30
  v_mul_f32 v116, v116, v30
  v_mul_f32 v117, v117, v30
  v_mul_f32 v118, v118, v30
  v_mul_f32 v119, v119, v30
  ds_read_b128 v[60:63], v76 offset:2048
  ds_read_b128 v[48:51], v76 offset:3072
  v_mul_f32 v120, v120, v30
  v_mul_f32 v121, v121, v30
  v_mul_f32 v122, v122, v30
  v_mul_f32 v123, v123, v30
  v_mul_f32 v124, v124, v30
  v_mul_f32 v125, v125, v30
  v_mul_f32 v126, v126, v30
  v_mul_f32 v127, v127, v30
  ds_write_b128 v72, v[64:67]
  ds_write_b128 v73, v[68:71]
  s_nop 0
  v_cvt_pk_bf16_f32 v64, v112, v113
  v_cvt_pk_bf16_f32 v65, v114, v115
  v_cvt_pk_bf16_f32 v66, v116, v117
  v_cvt_pk_bf16_f32 v67, v118, v119
  v_cvt_pk_bf16_f32 v68, v120, v121
  v_cvt_pk_bf16_f32 v69, v122, v123
  v_cvt_pk_bf16_f32 v70, v124, v125
  v_cvt_pk_bf16_f32 v71, v126, v127
  ds_write_b128 v74, v[64:67]
  ds_write_b128 v75, v[68:71]
  s_waitcnt lgkmcnt(6)
  buffer_store_dwordx4 v[52:55], v77, s[16:19], s53 offen offset:256 sc0 sc1 nt
  s_nop 1
  ds_read_b128 v[52:55], v76 offset:0
  v_mov_b32 v56, 0
  v_mov_b32 v57, 0
  v_mov_b32 v58, 0
  v_mov_b32 v59, 0
  s_waitcnt lgkmcnt(6)
  buffer_store_dwordx4 v[60:63], v77, s[16:19], s54 offen offset:256 sc0 sc1 nt
  s_nop 1
  ds_read_b128 v[60:63], v76 offset:1024
  s_waitcnt lgkmcnt(6)
  buffer_store_dwordx4 v[48:51], v77, s[16:19], s55 offen offset:256 sc0 sc1 nt
  s_nop 1
  ds_read_b128 v[48:51], v76 offset:2048
  s_waitcnt lgkmcnt(2)
  buffer_store_dwordx4 v[52:55], v77, s[16:19], s52 offen offset:384 sc0 sc1 nt
  s_nop 1
  ds_read_b128 v[52:55], v76 offset:3072
  s_waitcnt lgkmcnt(2)
  buffer_store_dwordx4 v[60:63], v77, s[16:19], s53 offen offset:384 sc0 sc1 nt
  s_waitcnt lgkmcnt(1)
  buffer_store_dwordx4 v[48:51], v77, s[16:19], s54 offen offset:384 sc0 sc1 nt
  s_waitcnt lgkmcnt(0)
  buffer_store_dwordx4 v[52:55], v77, s[16:19], s55 offen offset:384 sc0 sc1 nt
FIN:
  s_waitcnt vmcnt(0)
END:
  s_endpgm
RARE0:
  s_nop 7
  s_nop 7
  v_mul_f32 v128, v128, v28
  v_mul_f32 v129, v129, v28
  v_mul_f32 v130, v130, v28
  v_mul_f32 v131, v131, v28
  v_mul_f32 v132, v132, v28
  v_mul_f32 v133, v133, v28
  v_mul_f32 v134, v134, v28
  v_mul_f32 v135, v135, v28
  v_mul_f32 v136, v136, v28
  v_mul_f32 v137, v137, v28
  v_mul_f32 v138, v138, v28
  v_mul_f32 v139, v139, v28
  v_mul_f32 v140, v140, v28
  v_mul_f32 v141, v141, v28
  v_mul_f32 v142, v142, v28
  v_mul_f32 v143, v143, v28
  v_mul_f32 v144, v144, v28
  v_mul_f32 v145, v145, v28
  v_mul_f32 v146, v146, v28
  v_mul_f32 v147, v147, v28
  v_mul_f32 v148, v148, v28
  v_mul_f32 v149, v149, v28
  v_mul_f32 v150, v150, v28
  v_mul_f32 v151, v151, v28
  v_mul_f32 v152, v152, v28
  v_mul_f32 v153, v153, v28
  v_mul_f32 v154, v154, v28
  v_mul_f32 v155, v155, v28
  v_mul_f32 v156, v156, v28
  v_mul_f32 v157, v157, v28
  v_mul_f32 v158, v158, v28
  v_mul_f32 v159, v159, v28
  v_mul_f32 v160, v160, v28
  v_mul_f32 v161, v161, v28
  v_mul_f32 v162, v162, v28
  v_mul_f32 v163, v163, v28
  v_mul_f32 v164, v164, v28
  v_mul_f32 v165, v165, v28
  v_mul_f32 v166, v166, v28
  v_mul_f32 v167, v167, v28
  v_mul_f32 v168, v168, v28
  v_mul_f32 v169, v169, v28
  v_mul_f32 v170, v170, v28
  v_mul_f32 v171, v171, v28
  v_mul_f32 v172, v172, v28
  v_mul_f32 v173, v173, v28
  v_mul_f32 v174, v174, v28
  v_mul_f32 v175, v175, v28
  v_mul_f32 v176, v176, v28
  v_mul_f32 v177, v177, v28
  v_mul_f32 v178, v178, v28
  v_mul_f32 v179, v179, v28
  v_mul_f32 v180, v180, v28
  v_mul_f32 v181, v181, v28
  v_mul_f32 v182, v182, v28
  v_mul_f32 v183, v183, v28
  v_mul_f32 v184, v184, v28
  v_mul_f32 v185, v185, v28
  v_mul_f32 v186, v186, v28
  v_mul_f32 v187, v187, v28
  v_mul_f32 v188, v188, v28
  v_mul_f32 v189, v189, v28
  v_mul_f32 v190, v190, v28
  v_mul_f32 v191, v191, v28
  v_mul_f32 v192, v192, v28
  v_mul_f32 v193, v193, v28
  v_mul_f32 v194, v194, v28
  v_mul_f32 v195, v195, v28
  v_mul_f32 v196, v196, v28
  v_mul_f32 v197, v197, v28
  v_mul_f32 v198, v198, v28
  v_mul_f32 v199, v199, v28
  v_mul_f32 v200, v200, v28
  v_mul_f32 v201, v201, v28
  v_mul_f32 v202, v202, v28
  v_mul_f32 v203, v203, v28
  v_mul_f32 v204, v204, v28
  v_mul_f32 v205, v205, v28
  v_mul_f32 v206, v206, v28
  v_mul_f32 v207, v207, v28
  v_mul_f32 v208, v208, v28
  v_mul_f32 v209, v209, v28
  v_mul_f32 v210, v210, v28
  v_mul_f32 v211, v211, v28
  v_mul_f32 v212, v212, v28
  v_mul_f32 v213, v213, v28
  v_mul_f32 v214, v214, v28
  v_mul_f32 v215, v215, v28
  v_mul_f32 v216, v216, v28
  v_mul_f32 v217, v217, v28
  v_mul_f32 v218, v218, v28
  v_mul_f32 v219, v219, v28
  v_mul_f32 v220, v220, v28
  v_mul_f32 v221, v221, v28
  v_mul_f32 v222, v222, v28
  v_mul_f32 v223, v223, v28
  v_mul_f32 v224, v224, v28
  v_mul_f32 v225, v225, v28
  v_mul_f32 v226, v226, v28
  v_mul_f32 v227, v227, v28
  v_mul_f32 v228, v228, v28
  v_mul_f32 v229, v229, v28
  v_mul_f32 v230, v230, v28
  v_mul_f32 v231, v231, v28
  v_mul_f32 v232, v232, v28
  v_mul_f32 v233, v233, v28
  v_mul_f32 v234, v234, v28
  v_mul_f32 v235, v235, v28
  v_mul_f32 v236, v236, v28
  v_mul_f32 v237, v237, v28
  v_mul_f32 v238, v238, v28
  v_mul_f32 v239, v239, v28
  v_mul_f32 v240, v240, v28
  v_mul_f32 v241, v241, v28
  v_mul_f32 v242, v242, v28
  v_mul_f32 v243, v243, v28
  v_mul_f32 v244, v244, v28
  v_mul_f32 v245, v245, v28
  v_mul_f32 v246, v246, v28
  v_mul_f32 v247, v247, v28
  v_mul_f32 v248, v248, v28
  v_mul_f32 v249, v249, v28
  v_mul_f32 v250, v250, v28
  v_mul_f32 v251, v251, v28
  v_mul_f32 v252, v252, v28
  v_mul_f32 v253, v253, v28
  v_mul_f32 v254, v254, v28
  v_mul_f32 v255, v255, v28
  s_mov_b32 s26, 0
  s_nop 3
  s_branch RET0
RARE1:
  s_nop 7
  s_nop 7
  v_max3_f32 v29, v80, v81, 0
  v_max3_f32 v29, v29, v82, v83
  v_max3_f32 v29, v29, v84, v85
  v_max3_f32 v29, v29, v86, v87
  v_mov_b32 v30, v29
  s_nop 1
  v_permlane32_swap_b32 v29, v30
  s_nop 1
  v_max_f32 v29, v29, v30
  v_mov_b32 v30, v29
  s_nop 1
  v_permlane16_swap_b32 v29, v30
  s_nop 1
  v_max_f32 v29, v29, v30
  v_add_f32 v12, v12, v29
  v_sub_f32 v80, v80, v29
  v_sub_f32 v81, v81, v29
  v_sub_f32 v82, v82, v29
  v_sub_f32 v83, v83, v29
  v_sub_f32 v84, v84, v29
  v_sub_f32 v85, v85, v29
  v_sub_f32 v86, v86, v29
  v_sub_f32 v87, v87, v29
  v_sub_f32 v31, 0, v29
  v_exp_f32 v31, v31
  s_nop 1
  v_mul_f32 v22, v22, v31
  v_max3_f32 v29, v88, v89, 0
  v_max3_f32 v29, v29, v90, v91
  v_max3_f32 v29, v29, v92, v93
  v_max3_f32 v29, v29, v94, v95
  v_mov_b32 v30, v29
  s_nop 1
  v_permlane32_swap_b32 v29, v30
  s_nop 1
  v_max_f32 v29, v29, v30
  v_mov_b32 v30, v29
  s_nop 1
  v_permlane16_swap_b32 v29, v30
  s_nop 1
  v_max_f32 v29, v29, v30
  v_add_f32 v13, v13, v29
  v_sub_f32 v88, v88, v29
  v_sub_f32 v89, v89, v29
  v_sub_f32 v90, v90, v29
  v_sub_f32 v91, v91, v29
  v_sub_f32 v92, v92, v29
  v_sub_f32 v93, v93, v29
  v_sub_f32 v94, v94, v29
  v_sub_f32 v95, v95, v29
  v_sub_f32 v0, 0, v29
  v_exp_f32 v0, v0
  s_nop 1
  v_mul_f32 v23, v23, v0
  v_cndmask_b32 v29, v31, v0, s[96:97]
  s_nop 1
  v_accvgpr_read_b32 v24, a128
  v_accvgpr_read_b32 v25, a129
  v_mul_f32 v24, v24, v29
  v_mul_f32 v25, v25, v29
  v_accvgpr_write_b32 a128, v24
  v_accvgpr_write_b32 a129, v25
  v_accvgpr_read_b32 v24, a130
  v_accvgpr_read_b32 v25, a131
  v_mul_f32 v24, v24, v29
  v_mul_f32 v25, v25, v29
  v_accvgpr_write_b32 a130, v24
  v_accvgpr_write_b32 a131, v25
  v_accvgpr_read_b32 v24, a132
  v_accvgpr_read_b32 v25, a133
  v_mul_f32 v24, v24, v29
  v_mul_f32 v25, v25, v29
  v_accvgpr_write_b32 a132, v24
  v_accvgpr_write_b32 a133, v25
  v_accvgpr_read_b32 v24, a134
  v_accvgpr_read_b32 v25, a135
  v_mul_f32 v24, v24, v29
  v_mul_f32 v25, v25, v29
  v_accvgpr_write_b32 a134, v24
  v_accvgpr_write_b32 a135, v25
  v_accvgpr_read_b32 v24, a136
  v_accvgpr_read_b32 v25, a137
  v_mul_f32 v24, v24, v29
  v_mul_f32 v25, v25, v29
  v_accvgpr_write_b32 a136, v24
  v_accvgpr_write_b32 a137, v25
  v_accvgpr_read_b32 v24, a138
  v_accvgpr_read_b32 v25, a139
  v_mul_f32 v24, v24, v29
  v_mul_f32 v25, v25, v29
  v_accvgpr_write_b32 a138, v24
  v_accvgpr_write_b32 a139, v25
  v_accvgpr_read_b32 v24, a140
  v_accvgpr_read_b32 v25, a141
  v_mul_f32 v24, v24, v29
  v_mul_f32 v25, v25, v29
  v_accvgpr_write_b32 a140, v24
  v_accvgpr_write_b32 a141, v25
  v_accvgpr_read_b32 v24, a142
  v_accvgpr_read_b32 v25, a143
  v_mul_f32 v24, v24, v29
  v_mul_f32 v25, v25, v29
  v_accvgpr_write_b32 a142, v24
  v_accvgpr_write_b32 a143, v25
  v_accvgpr_read_b32 v24, a144
  v_accvgpr_read_b32 v25, a145
  v_mul_f32 v24, v24, v29
  v_mul_f32 v25, v25, v29
  v_accvgpr_write_b32 a144, v24
  v_accvgpr_write_b32 a145, v25
  v_accvgpr_read_b32 v24, a146
  v_accvgpr_read_b32 v25, a147
  v_mul_f32 v24, v24, v29
  v_mul_f32 v25, v25, v29
  v_accvgpr_write_b32 a146, v24
  v_accvgpr_write_b32 a147, v25
  v_accvgpr_read_b32 v24, a148
  v_accvgpr_read_b32 v25, a149
  v_mul_f32 v24, v24, v29
  v_mul_f32 v25, v25, v29
  v_accvgpr_write_b32 a148, v24
  v_accvgpr_write_b32 a149, v25
  v_accvgpr_read_b32 v24, a150
  v_accvgpr_read_b32 v25, a151
  v_mul_f32 v24, v24, v29
  v_mul_f32 v25, v25, v29
  v_accvgpr_write_b32 a150, v24
  v_accvgpr_write_b32 a151, v25
  v_accvgpr_read_b32 v24, a152
  v_accvgpr_read_b32 v25, a153
  v_mul_f32 v24, v24, v29
  v_mul_f32 v25, v25, v29
  v_accvgpr_write_b32 a152, v24
  v_accvgpr_write_b32 a153, v25
  v_accvgpr_read_b32 v24, a154
  v_accvgpr_read_b32 v25, a155
  v_mul_f32 v24, v24, v29
  v_mul_f32 v25, v25, v29
  v_accvgpr_write_b32 a154, v24
  v_accvgpr_write_b32 a155, v25
  v_accvgpr_read_b32 v24, a156
  v_accvgpr_read_b32 v25, a157
  v_mul_f32 v24, v24, v29
  v_mul_f32 v25, v25, v29
  v_accvgpr_write_b32 a156, v24
  v_accvgpr_write_b32 a157, v25
  v_accvgpr_read_b32 v24, a158
  v_accvgpr_read_b32 v25, a159
  v_mul_f32 v24, v24, v29
  v_mul_f32 v25, v25, v29
  v_accvgpr_write_b32 a158, v24
  v_accvgpr_write_b32 a159, v25
  v_accvgpr_read_b32 v24, a160
  v_accvgpr_read_b32 v25, a161
  v_mul_f32 v24, v24, v29
  v_mul_f32 v25, v25, v29
  v_accvgpr_write_b32 a160, v24
  v_accvgpr_write_b32 a161, v25
  v_accvgpr_read_b32 v24, a162
  v_accvgpr_read_b32 v25, a163
  v_mul_f32 v24, v24, v29
  v_mul_f32 v25, v25, v29
  v_accvgpr_write_b32 a162, v24
  v_accvgpr_write_b32 a163, v25
  v_accvgpr_read_b32 v24, a164
  v_accvgpr_read_b32 v25, a165
  v_mul_f32 v24, v24, v29
  v_mul_f32 v25, v25, v29
  v_accvgpr_write_b32 a164, v24
  v_accvgpr_write_b32 a165, v25
  v_accvgpr_read_b32 v24, a166
  v_accvgpr_read_b32 v25, a167
  v_mul_f32 v24, v24, v29
  v_mul_f32 v25, v25, v29
  v_accvgpr_write_b32 a166, v24
  v_accvgpr_write_b32 a167, v25
  v_accvgpr_read_b32 v24, a168
  v_accvgpr_read_b32 v25, a169
  v_mul_f32 v24, v24, v29
  v_mul_f32 v25, v25, v29
  v_accvgpr_write_b32 a168, v24
  v_accvgpr_write_b32 a169, v25
  v_accvgpr_read_b32 v24, a170
  v_accvgpr_read_b32 v25, a171
  v_mul_f32 v24, v24, v29
  v_mul_f32 v25, v25, v29
  v_accvgpr_write_b32 a170, v24
  v_accvgpr_write_b32 a171, v25
  v_accvgpr_read_b32 v24, a172
  v_accvgpr_read_b32 v25, a173
  v_mul_f32 v24, v24, v29
  v_mul_f32 v25, v25, v29
  v_accvgpr_write_b32 a172, v24
  v_accvgpr_write_b32 a173, v25
  v_accvgpr_read_b32 v24, a174
  v_accvgpr_read_b32 v25, a175
  v_mul_f32 v24, v24, v29
  v_mul_f32 v25, v25, v29
  v_accvgpr_write_b32 a174, v24
  v_accvgpr_write_b32 a175, v25
  v_accvgpr_read_b32 v24, a176
  v_accvgpr_read_b32 v25, a177
  v_mul_f32 v24, v24, v29
  v_mul_f32 v25, v25, v29
  v_accvgpr_write_b32 a176, v24
  v_accvgpr_write_b32 a177, v25
  v_accvgpr_read_b32 v24, a178
  v_accvgpr_read_b32 v25, a179
  v_mul_f32 v24, v24, v29
  v_mul_f32 v25, v25, v29
  v_accvgpr_write_b32 a178, v24
  v_accvgpr_write_b32 a179, v25
  v_accvgpr_read_b32 v24, a180
  v_accvgpr_read_b32 v25, a181
  v_mul_f32 v24, v24, v29
  v_mul_f32 v25, v25, v29
  v_accvgpr_write_b32 a180, v24
  v_accvgpr_write_b32 a181, v25
  v_accvgpr_read_b32 v24, a182
  v_accvgpr_read_b32 v25, a183
  v_mul_f32 v24, v24, v29
  v_mul_f32 v25, v25, v29
  v_accvgpr_write_b32 a182, v24
  v_accvgpr_write_b32 a183, v25
  v_accvgpr_read_b32 v24, a184
  v_accvgpr_read_b32 v25, a185
  v_mul_f32 v24, v24, v29
  v_mul_f32 v25, v25, v29
  v_accvgpr_write_b32 a184, v24
  v_accvgpr_write_b32 a185, v25
  v_accvgpr_read_b32 v24, a186
  v_accvgpr_read_b32 v25, a187
  v_mul_f32 v24, v24, v29
  v_mul_f32 v25, v25, v29
  v_accvgpr_write_b32 a186, v24
  v_accvgpr_write_b32 a187, v25
  v_accvgpr_read_b32 v24, a188
  v_accvgpr_read_b32 v25, a189
  v_mul_f32 v24, v24, v29
  v_mul_f32 v25, v25, v29
  v_accvgpr_write_b32 a188, v24
  v_accvgpr_write_b32 a189, v25
  v_accvgpr_read_b32 v24, a190
  v_accvgpr_read_b32 v25, a191
  v_mul_f32 v24, v24, v29
  v_mul_f32 v25, v25, v29
  v_accvgpr_write_b32 a190, v24
  v_accvgpr_write_b32 a191, v25
  v_accvgpr_read_b32 v24, a192
  v_accvgpr_read_b32 v25, a193
  v_mul_f32 v24, v24, v29
  v_mul_f32 v25, v25, v29
  v_accvgpr_write_b32 a192, v24
  v_accvgpr_write_b32 a193, v25
  v_accvgpr_read_b32 v24, a194
  v_accvgpr_read_b32 v25, a195
  v_mul_f32 v24, v24, v29
  v_mul_f32 v25, v25, v29
  v_accvgpr_write_b32 a194, v24
  v_accvgpr_write_b32 a195, v25
  v_accvgpr_read_b32 v24, a196
  v_accvgpr_read_b32 v25, a197
  v_mul_f32 v24, v24, v29
  v_mul_f32 v25, v25, v29
  v_accvgpr_write_b32 a196, v24
  v_accvgpr_write_b32 a197, v25
  v_accvgpr_read_b32 v24, a198
  v_accvgpr_read_b32 v25, a199
  v_mul_f32 v24, v24, v29
  v_mul_f32 v25, v25, v29
  v_accvgpr_write_b32 a198, v24
  v_accvgpr_write_b32 a199, v25
  v_accvgpr_read_b32 v24, a200
  v_accvgpr_read_b32 v25, a201
  v_mul_f32 v24, v24, v29
  v_mul_f32 v25, v25, v29
  v_accvgpr_write_b32 a200, v24
  v_accvgpr_write_b32 a201, v25
  v_accvgpr_read_b32 v24, a202
  v_accvgpr_read_b32 v25, a203
  v_mul_f32 v24, v24, v29
  v_mul_f32 v25, v25, v29
  v_accvgpr_write_b32 a202, v24
  v_accvgpr_write_b32 a203, v25
  v_accvgpr_read_b32 v24, a204
  v_accvgpr_read_b32 v25, a205
  v_mul_f32 v24, v24, v29
  v_mul_f32 v25, v25, v29
  v_accvgpr_write_b32 a204, v24
  v_accvgpr_write_b32 a205, v25
  v_accvgpr_read_b32 v24, a206
  v_accvgpr_read_b32 v25, a207
  v_mul_f32 v24, v24, v29
  v_mul_f32 v25, v25, v29
  v_accvgpr_write_b32 a206, v24
  v_accvgpr_write_b32 a207, v25
  v_accvgpr_read_b32 v24, a208
  v_accvgpr_read_b32 v25, a209
  v_mul_f32 v24, v24, v29
  v_mul_f32 v25, v25, v29
  v_accvgpr_write_b32 a208, v24
  v_accvgpr_write_b32 a209, v25
  v_accvgpr_read_b32 v24, a210
  v_accvgpr_read_b32 v25, a211
  v_mul_f32 v24, v24, v29
  v_mul_f32 v25, v25, v29
  v_accvgpr_write_b32 a210, v24
  v_accvgpr_write_b32 a211, v25
  v_accvgpr_read_b32 v24, a212
  v_accvgpr_read_b32 v25, a213
  v_mul_f32 v24, v24, v29
  v_mul_f32 v25, v25, v29
  v_accvgpr_write_b32 a212, v24
  v_accvgpr_write_b32 a213, v25
  v_accvgpr_read_b32 v24, a214
  v_accvgpr_read_b32 v25, a215
  v_mul_f32 v24, v24, v29
  v_mul_f32 v25, v25, v29
  v_accvgpr_write_b32 a214, v24
  v_accvgpr_write_b32 a215, v25
  v_accvgpr_read_b32 v24, a216
  v_accvgpr_read_b32 v25, a217
  v_mul_f32 v24, v24, v29
  v_mul_f32 v25, v25, v29
  v_accvgpr_write_b32 a216, v24
  v_accvgpr_write_b32 a217, v25
  v_accvgpr_read_b32 v24, a218
  v_accvgpr_read_b32 v25, a219
  v_mul_f32 v24, v24, v29
  v_mul_f32 v25, v25, v29
  v_accvgpr_write_b32 a218, v24
  v_accvgpr_write_b32 a219, v25
  v_accvgpr_read_b32 v24, a220
  v_accvgpr_read_b32 v25, a221
  v_mul_f32 v24, v24, v29
  v_mul_f32 v25, v25, v29
  v_accvgpr_write_b32 a220, v24
  v_accvgpr_write_b32 a221, v25
  v_accvgpr_read_b32 v24, a222
  v_accvgpr_read_b32 v25, a223
  v_mul_f32 v24, v24, v29
  v_mul_f32 v25, v25, v29
  v_accvgpr_write_b32 a222, v24
  v_accvgpr_write_b32 a223, v25
  v_accvgpr_read_b32 v24, a224
  v_accvgpr_read_b32 v25, a225
  v_mul_f32 v24, v24, v29
  v_mul_f32 v25, v25, v29
  v_accvgpr_write_b32 a224, v24
  v_accvgpr_write_b32 a225, v25
  v_accvgpr_read_b32 v24, a226
  v_accvgpr_read_b32 v25, a227
  v_mul_f32 v24, v24, v29
  v_mul_f32 v25, v25, v29
  v_accvgpr_write_b32 a226, v24
  v_accvgpr_write_b32 a227, v25
  v_accvgpr_read_b32 v24, a228
  v_accvgpr_read_b32 v25, a229
  v_mul_f32 v24, v24, v29
  v_mul_f32 v25, v25, v29
  v_accvgpr_write_b32 a228, v24
  v_accvgpr_write_b32 a229, v25
  v_accvgpr_read_b32 v24, a230
  v_accvgpr_read_b32 v25, a231
  v_mul_f32 v24, v24, v29
  v_mul_f32 v25, v25, v29
  v_accvgpr_write_b32 a230, v24
  v_accvgpr_write_b32 a231, v25
  v_accvgpr_read_b32 v24, a232
  v_accvgpr_read_b32 v25, a233
  v_mul_f32 v24, v24, v29
  v_mul_f32 v25, v25, v29
  v_accvgpr_write_b32 a232, v24
  v_accvgpr_write_b32 a233, v25
  v_accvgpr_read_b32 v24, a234
  v_accvgpr_read_b32 v25, a235
  v_mul_f32 v24, v24, v29
  v_mul_f32 v25, v25, v29
  v_accvgpr_write_b32 a234, v24
  v_accvgpr_write_b32 a235, v25
  v_accvgpr_read_b32 v24, a236
  v_accvgpr_read_b32 v25, a237
  v_mul_f32 v24, v24, v29
  v_mul_f32 v25, v25, v29
  v_accvgpr_write_b32 a236, v24
  v_accvgpr_write_b32 a237, v25
  v_accvgpr_read_b32 v24, a238
  v_accvgpr_read_b32 v25, a239
  v_mul_f32 v24, v24, v29
  v_mul_f32 v25, v25, v29
  v_accvgpr_write_b32 a238, v24
  v_accvgpr_write_b32 a239, v25
  v_accvgpr_read_b32 v24, a240
  v_accvgpr_read_b32 v25, a241
  v_mul_f32 v24, v24, v29
  v_mul_f32 v25, v25, v29
  v_accvgpr_write_b32 a240, v24
  v_accvgpr_write_b32 a241, v25
  v_accvgpr_read_b32 v24, a242
  v_accvgpr_read_b32 v25, a243
  v_mul_f32 v24, v24, v29
  v_mul_f32 v25, v25, v29
  v_accvgpr_write_b32 a242, v24
  v_accvgpr_write_b32 a243, v25
  v_accvgpr_read_b32 v24, a244
  v_accvgpr_read_b32 v25, a245
  v_mul_f32 v24, v24, v29
  v_mul_f32 v25, v25, v29
  v_accvgpr_write_b32 a244, v24
  v_accvgpr_write_b32 a245, v25
  v_accvgpr_read_b32 v24, a246
  v_accvgpr_read_b32 v25, a247
  v_mul_f32 v24, v24, v29
  v_mul_f32 v25, v25, v29
  v_accvgpr_write_b32 a246, v24
  v_accvgpr_write_b32 a247, v25
  v_accvgpr_read_b32 v24, a248
  v_accvgpr_read_b32 v25, a249
  v_mul_f32 v24, v24, v29
  v_mul_f32 v25, v25, v29
  v_accvgpr_write_b32 a248, v24
  v_accvgpr_write_b32 a249, v25
  v_accvgpr_read_b32 v24, a250
  v_accvgpr_read_b32 v25, a251
  v_mul_f32 v24, v24, v29
  v_mul_f32 v25, v25, v29
  v_accvgpr_write_b32 a250, v24
  v_accvgpr_write_b32 a251, v25
  v_accvgpr_read_b32 v24, a252
  v_accvgpr_read_b32 v25, a253
  v_mul_f32 v24, v24, v29
  v_mul_f32 v25, v25, v29
  v_accvgpr_write_b32 a252, v24
  v_accvgpr_write_b32 a253, v25
  v_accvgpr_read_b32 v24, a254
  v_accvgpr_read_b32 v25, a255
  v_mul_f32 v24, v24, v29
  v_mul_f32 v25, v25, v29
  v_accvgpr_write_b32 a254, v24
  v_accvgpr_write_b32 a255, v25
  s_nop 1
  v_exp_f32 v72, v80
  s_nop 1
  v_exp_f32 v24, v81
  s_nop 1
  v_add_f32 v31, v72, v24
  s_nop 1
  v_cvt_pk_bf16_f32 v72, v72, v24
  s_nop 1
  v_exp_f32 v73, v82
  s_nop 1
  v_add_f32 v31, v31, v73
  s_nop 1
  v_exp_f32 v25, v83
  s_nop 1
  v_add_f32 v31, v31, v25
  s_nop 1
  v_cvt_pk_bf16_f32 v73, v73, v25
  s_nop 1
  v_exp_f32 v76, v84
  s_nop 1
  v_add_f32 v31, v31, v76
  s_nop 1
  v_exp_f32 v24, v85
  s_nop 1
  v_add_f32 v31, v31, v24
  s_nop 1
  v_cvt_pk_bf16_f32 v76, v76, v24
  s_nop 1
  v_exp_f32 v77, v86
  s_nop 1
  v_add_f32 v31, v31, v77
  s_nop 1
  v_exp_f32 v25, v87
  s_nop 1
  v_add_f32 v31, v31, v25
  s_nop 1
  v_cvt_pk_bf16_f32 v77, v77, v25
  s_nop 1
  v_exp_f32 v74, v88
  s_nop 1
  v_exp_f32 v24, v89
  s_nop 1
  v_add_f32 v0, v74, v24
  s_nop 1
  v_cvt_pk_bf16_f32 v74, v74, v24
  s_nop 1
  v_permlane16_swap_b32 v72, v74
  s_nop 1
  v_exp_f32 v75, v90
  s_nop 1
  v_add_f32 v0, v0, v75
  s_nop 1
  v_exp_f32 v25, v91
  s_nop 1
  v_add_f32 v0, v0, v25
  s_nop 1
  v_cvt_pk_bf16_f32 v75, v75, v25
  s_nop 1
  v_permlane16_swap_b32 v73, v75
  s_nop 1
  v_exp_f32 v78, v92
  s_nop 1
  v_add_f32 v0, v0, v78
  s_nop 1
  v_exp_f32 v24, v93
  s_nop 1
  v_add_f32 v0, v0, v24
  s_nop 1
  v_cvt_pk_bf16_f32 v78, v78, v24
  s_nop 1
  v_permlane16_swap_b32 v76, v78
  s_nop 1
  v_exp_f32 v79, v94
  s_nop 1
  v_add_f32 v0, v0, v79
  s_nop 1
  v_exp_f32 v25, v95
  s_nop 1
  v_add_f32 v0, v0, v25
  s_nop 1
  v_cvt_pk_bf16_f32 v79, v79, v25
  s_nop 1
  v_permlane16_swap_b32 v77, v79
  s_nop 3
  s_branch RET1
RARE2:
  s_nop 7
  s_nop 7
  v_max3_f32 v29, v112, v113, 0
  v_max3_f32 v29, v29, v114, v115
  v_max3_f32 v29, v29, v116, v117
  v_max3_f32 v29, v29, v118, v119
  v_mov_b32 v30, v29
  s_nop 1
  v_permlane32_swap_b32 v29, v30
  s_nop 1
  v_max_f32 v29, v29, v30
  v_mov_b32 v30, v29
  s_nop 1
  v_permlane16_swap_b32 v29, v30
  s_nop 1
  v_max_f32 v29, v29, v30
  v_add_f32 v10, v10, v29
  v_sub_f32 v112, v112, v29
  v_sub_f32 v113, v113, v29
  v_sub_f32 v114, v114, v29
  v_sub_f32 v115, v115, v29
  v_sub_f32 v116, v116, v29
  v_sub_f32 v117, v117, v29
  v_sub_f32 v118, v118, v29
  v_sub_f32 v119, v119, v29
  v_sub_f32 v31, 0, v29
  v_exp_f32 v31, v31
  s_nop 1
  v_mul_f32 v26, v26, v31
  v_max3_f32 v29, v120, v121, 0
  v_max3_f32 v29, v29, v122, v123
  v_max3_f32 v29, v29, v124, v125
  v_max3_f32 v29, v29, v126, v127
  v_mov_b32 v30, v29
  s_nop 1
  v_permlane32_swap_b32 v29, v30
  s_nop 1
  v_max_f32 v29, v29, v30
  v_mov_b32 v30, v29
  s_nop 1
  v_permlane16_swap_b32 v29, v30
  s_nop 1
  v_max_f32 v29, v29, v30
  v_add_f32 v11, v11, v29
  v_sub_f32 v120, v120, v29
  v_sub_f32 v121, v121, v29
  v_sub_f32 v122, v122, v29
  v_sub_f32 v123, v123, v29
  v_sub_f32 v124, v124, v29
  v_sub_f32 v125, v125, v29
  v_sub_f32 v126, v126, v29
  v_sub_f32 v127, v127, v29
  v_sub_f32 v0, 0, v29
  v_exp_f32 v0, v0
  s_nop 1
  v_mul_f32 v27, v27, v0
  v_cndmask_b32 v29, v31, v0, s[96:97]
  s_nop 1
  v_mov_b32 v28, v29
  s_mov_b32 s26, 1
  s_nop 1
  v_exp_f32 v64, v112
  s_nop 1
  v_exp_f32 v24, v113
  s_nop 1
  v_add_f32 v31, v64, v24
  s_nop 1
  v_cvt_pk_bf16_f32 v64, v64, v24
  s_nop 1
  v_exp_f32 v65, v114
  s_nop 1
  v_add_f32 v31, v31, v65
  s_nop 1
  v_exp_f32 v25, v115
  s_nop 1
  v_add_f32 v31, v31, v25
  s_nop 1
  v_cvt_pk_bf16_f32 v65, v65, v25
  s_nop 1
  v_exp_f32 v68, v116
  s_nop 1
  v_add_f32 v31, v31, v68
  s_nop 1
  v_exp_f32 v24, v117
  s_nop 1
  v_add_f32 v31, v31, v24
  s_nop 1
  v_cvt_pk_bf16_f32 v68, v68, v24
  s_nop 1
  v_exp_f32 v69, v118
  s_nop 1
  v_add_f32 v31, v31, v69
  s_nop 1
  v_exp_f32 v25, v119
  s_nop 1
  v_add_f32 v31, v31, v25
  s_nop 1
  v_cvt_pk_bf16_f32 v69, v69, v25
  s_nop 1
  v_exp_f32 v66, v120
  s_nop 1
  v_exp_f32 v24, v121
  s_nop 1
  v_add_f32 v0, v66, v24
  s_nop 1
  v_cvt_pk_bf16_f32 v66, v66, v24
  s_nop 1
  v_permlane16_swap_b32 v64, v66
  s_nop 1
  v_exp_f32 v67, v122
  s_nop 1
  v_add_f32 v0, v0, v67
  s_nop 1
  v_exp_f32 v25, v123
  s_nop 1
  v_add_f32 v0, v0, v25
  s_nop 1
  v_cvt_pk_bf16_f32 v67, v67, v25
  s_nop 1
  v_permlane16_swap_b32 v65, v67
  s_nop 1
  v_exp_f32 v70, v124
  s_nop 1
  v_add_f32 v0, v0, v70
  s_nop 1
  v_exp_f32 v24, v125
  s_nop 1
  v_add_f32 v0, v0, v24
  s_nop 1
  v_cvt_pk_bf16_f32 v70, v70, v24
  s_nop 1
  v_permlane16_swap_b32 v68, v70
  s_nop 1
  v_exp_f32 v71, v126
  s_nop 1
  v_add_f32 v0, v0, v71
  s_nop 1
  v_exp_f32 v25, v127
  s_nop 1
  v_add_f32 v0, v0, v25
  s_nop 1
  v_cvt_pk_bf16_f32 v71, v71, v25
  s_nop 1
  v_permlane16_swap_b32 v69, v71
  s_nop 3
  s_branch RET2
RARE3:
  s_nop 7
  s_nop 7
  v_mul_f32 v128, v128, v28
  v_mul_f32 v129, v129, v28
  v_mul_f32 v130, v130, v28
  v_mul_f32 v131, v131, v28
  v_mul_f32 v132, v132, v28
  v_mul_f32 v133, v133, v28
  v_mul_f32 v134, v134, v28
  v_mul_f32 v135, v135, v28
  v_mul_f32 v136, v136, v28
  v_mul_f32 v137, v137, v28
  v_mul_f32 v138, v138, v28
  v_mul_f32 v139, v139, v28
  v_mul_f32 v140, v140, v28
  v_mul_f32 v141, v141, v28
  v_mul_f32 v142, v142, v28
  v_mul_f32 v143, v143, v28
  v_mul_f32 v144, v144, v28
  v_mul_f32 v145, v145, v28
  v_mul_f32 v146, v146, v28
  v_mul_f32 v147, v147, v28
  v_mul_f32 v148, v148, v28
  v_mul_f32 v149, v149, v28
  v_mul_f32 v150, v150, v28
  v_mul_f32 v151, v151, v28
  v_mul_f32 v152, v152, v28
  v_mul_f32 v153, v153, v28
  v_mul_f32 v154, v154, v28
  v_mul_f32 v155, v155, v28
  v_mul_f32 v156, v156, v28
  v_mul_f32 v157, v157, v28
  v_mul_f32 v158, v158, v28
  v_mul_f32 v159, v159, v28
  v_mul_f32 v160, v160, v28
  v_mul_f32 v161, v161, v28
  v_mul_f32 v162, v162, v28
  v_mul_f32 v163, v163, v28
  v_mul_f32 v164, v164, v28
  v_mul_f32 v165, v165, v28
  v_mul_f32 v166, v166, v28
  v_mul_f32 v167, v167, v28
  v_mul_f32 v168, v168, v28
  v_mul_f32 v169, v169, v28
  v_mul_f32 v170, v170, v28
  v_mul_f32 v171, v171, v28
  v_mul_f32 v172, v172, v28
  v_mul_f32 v173, v173, v28
  v_mul_f32 v174, v174, v28
  v_mul_f32 v175, v175, v28
  v_mul_f32 v176, v176, v28
  v_mul_f32 v177, v177, v28
  v_mul_f32 v178, v178, v28
  v_mul_f32 v179, v179, v28
  v_mul_f32 v180, v180, v28
  v_mul_f32 v181, v181, v28
  v_mul_f32 v182, v182, v28
  v_mul_f32 v183, v183, v28
  v_mul_f32 v184, v184, v28
  v_mul_f32 v185, v185, v28
  v_mul_f32 v186, v186, v28
  v_mul_f32 v187, v187, v28
  v_mul_f32 v188, v188, v28
  v_mul_f32 v189, v189, v28
  v_mul_f32 v190, v190, v28
  v_mul_f32 v191, v191, v28
  v_mul_f32 v192, v192, v28
  v_mul_f32 v193, v193, v28
  v_mul_f32 v194, v194, v28
  v_mul_f32 v195, v195, v28
  v_mul_f32 v196, v196, v28
  v_mul_f32 v197, v197, v28
  v_mul_f32 v198, v198, v28
  v_mul_f32 v199, v199, v28
  v_mul_f32 v200, v200, v28
  v_mul_f32 v201, v201, v28
  v_mul_f32 v202, v202, v28
  v_mul_f32 v203, v203, v28
  v_mul_f32 v204, v204, v28
  v_mul_f32 v205, v205, v28
  v_mul_f32 v206, v206, v28
  v_mul_f32 v207, v207, v28
  v_mul_f32 v208, v208, v28
  v_mul_f32 v209, v209, v28
  v_mul_f32 v210, v210, v28
  v_mul_f32 v211, v211, v28
  v_mul_f32 v212, v212, v28
  v_mul_f32 v213, v213, v28
  v_mul_f32 v214, v214, v28
  v_mul_f32 v215, v215, v28
  v_mul_f32 v216, v216, v28
  v_mul_f32 v217, v217, v28
  v_mul_f32 v218, v218, v28
  v_mul_f32 v219, v219, v28
  v_mul_f32 v220, v220, v28
  v_mul_f32 v221, v221, v28
  v_mul_f32 v222, v222, v28
  v_mul_f32 v223, v223, v28
  v_mul_f32 v224, v224, v28
  v_mul_f32 v225, v225, v28
  v_mul_f32 v226, v226, v28
  v_mul_f32 v227, v227, v28
  v_mul_f32 v228, v228, v28
  v_mul_f32 v229, v229, v28
  v_mul_f32 v230, v230, v28
  v_mul_f32 v231, v231, v28
  v_mul_f32 v232, v232, v28
  v_mul_f32 v233, v233, v28
  v_mul_f32 v234, v234, v28
  v_mul_f32 v235, v235, v28
  v_mul_f32 v236, v236, v28
  v_mul_f32 v237, v237, v28
  v_mul_f32 v238, v238, v28
  v_mul_f32 v239, v239, v28
  v_mul_f32 v240, v240, v28
  v_mul_f32 v241, v241, v28
  v_mul_f32 v242, v242, v28
  v_mul_f32 v243, v243, v28
  v_mul_f32 v244, v244, v28
  v_mul_f32 v245, v245, v28
  v_mul_f32 v246, v246, v28
  v_mul_f32 v247, v247, v28
  v_mul_f32 v248, v248, v28
  v_mul_f32 v249, v249, v28
  v_mul_f32 v250, v250, v28
  v_mul_f32 v251, v251, v28
  v_mul_f32 v252, v252, v28
  v_mul_f32 v253, v253, v28
  v_mul_f32 v254, v254, v28
  v_mul_f32 v255, v255, v28
  s_mov_b32 s26, 0
  s_nop 3
  s_branch RET3
RARE4:
  s_nop 7
  s_nop 7
  v_max3_f32 v29, v96, v97, 0
  v_max3_f32 v29, v29, v98, v99
  v_max3_f32 v29, v29, v100, v101
  v_max3_f32 v29, v29, v102, v103
  v_mov_b32 v30, v29
  s_nop 1
  v_permlane32_swap_b32 v29, v30
  s_nop 1
  v_max_f32 v29, v29, v30
  v_mov_b32 v30, v29
  s_nop 1
  v_permlane16_swap_b32 v29, v30
  s_nop 1
  v_max_f32 v29, v29, v30
  v_add_f32 v12, v12, v29
  v_sub_f32 v96, v96, v29
  v_sub_f32 v97, v97, v29
  v_sub_f32 v98, v98, v29
  v_sub_f32 v99, v99, v29
  v_sub_f32 v100, v100, v29
  v_sub_f32 v101, v101, v29
  v_sub_f32 v102, v102, v29
  v_sub_f32 v103, v103, v29
  v_sub_f32 v31, 0, v29
  v_exp_f32 v31, v31
  s_nop 1
  v_mul_f32 v22, v22, v31
  v_max3_f32 v29, v104, v105, 0
  v_max3_f32 v29, v29, v106, v107
  v_max3_f32 v29, v29, v108, v109
  v_max3_f32 v29, v29, v110, v111
  v_mov_b32 v30, v29
  s_nop 1
  v_permlane32_swap_b32 v29, v30
  s_nop 1
  v_max_f32 v29, v29, v30
  v_mov_b32 v30, v29
  s_nop 1
  v_permlane16_swap_b32 v29, v30
  s_nop 1
  v_max_f32 v29, v29, v30
  v_add_f32 v13, v13, v29
  v_sub_f32 v104, v104, v29
  v_sub_f32 v105, v105, v29
  v_sub_f32 v106, v106, v29
  v_sub_f32 v107, v107, v29
  v_sub_f32 v108, v108, v29
  v_sub_f32 v109, v109, v29
  v_sub_f32 v110, v110, v29
  v_sub_f32 v111, v111, v29
  v_sub_f32 v0, 0, v29
  v_exp_f32 v0, v0
  s_nop 1
  v_mul_f32 v23, v23, v0
  v_cndmask_b32 v29, v31, v0, s[96:97]
  s_nop 1
  v_accvgpr_read_b32 v24, a128
  v_accvgpr_read_b32 v25, a129
  v_mul_f32 v24, v24, v29
  v_mul_f32 v25, v25, v29
  v_accvgpr_write_b32 a128, v24
  v_accvgpr_write_b32 a129, v25
  v_accvgpr_read_b32 v24, a130
  v_accvgpr_read_b32 v25, a131
  v_mul_f32 v24, v24, v29
  v_mul_f32 v25, v25, v29
  v_accvgpr_write_b32 a130, v24
  v_accvgpr_write_b32 a131, v25
  v_accvgpr_read_b32 v24, a132
  v_accvgpr_read_b32 v25, a133
  v_mul_f32 v24, v24, v29
  v_mul_f32 v25, v25, v29
  v_accvgpr_write_b32 a132, v24
  v_accvgpr_write_b32 a133, v25
  v_accvgpr_read_b32 v24, a134
  v_accvgpr_read_b32 v25, a135
  v_mul_f32 v24, v24, v29
  v_mul_f32 v25, v25, v29
  v_accvgpr_write_b32 a134, v24
  v_accvgpr_write_b32 a135, v25
  v_accvgpr_read_b32 v24, a136
  v_accvgpr_read_b32 v25, a137
  v_mul_f32 v24, v24, v29
  v_mul_f32 v25, v25, v29
  v_accvgpr_write_b32 a136, v24
  v_accvgpr_write_b32 a137, v25
  v_accvgpr_read_b32 v24, a138
  v_accvgpr_read_b32 v25, a139
  v_mul_f32 v24, v24, v29
  v_mul_f32 v25, v25, v29
  v_accvgpr_write_b32 a138, v24
  v_accvgpr_write_b32 a139, v25
  v_accvgpr_read_b32 v24, a140
  v_accvgpr_read_b32 v25, a141
  v_mul_f32 v24, v24, v29
  v_mul_f32 v25, v25, v29
  v_accvgpr_write_b32 a140, v24
  v_accvgpr_write_b32 a141, v25
  v_accvgpr_read_b32 v24, a142
  v_accvgpr_read_b32 v25, a143
  v_mul_f32 v24, v24, v29
  v_mul_f32 v25, v25, v29
  v_accvgpr_write_b32 a142, v24
  v_accvgpr_write_b32 a143, v25
  v_accvgpr_read_b32 v24, a144
  v_accvgpr_read_b32 v25, a145
  v_mul_f32 v24, v24, v29
  v_mul_f32 v25, v25, v29
  v_accvgpr_write_b32 a144, v24
  v_accvgpr_write_b32 a145, v25
  v_accvgpr_read_b32 v24, a146
  v_accvgpr_read_b32 v25, a147
  v_mul_f32 v24, v24, v29
  v_mul_f32 v25, v25, v29
  v_accvgpr_write_b32 a146, v24
  v_accvgpr_write_b32 a147, v25
  v_accvgpr_read_b32 v24, a148
  v_accvgpr_read_b32 v25, a149
  v_mul_f32 v24, v24, v29
  v_mul_f32 v25, v25, v29
  v_accvgpr_write_b32 a148, v24
  v_accvgpr_write_b32 a149, v25
  v_accvgpr_read_b32 v24, a150
  v_accvgpr_read_b32 v25, a151
  v_mul_f32 v24, v24, v29
  v_mul_f32 v25, v25, v29
  v_accvgpr_write_b32 a150, v24
  v_accvgpr_write_b32 a151, v25
  v_accvgpr_read_b32 v24, a152
  v_accvgpr_read_b32 v25, a153
  v_mul_f32 v24, v24, v29
  v_mul_f32 v25, v25, v29
  v_accvgpr_write_b32 a152, v24
  v_accvgpr_write_b32 a153, v25
  v_accvgpr_read_b32 v24, a154
  v_accvgpr_read_b32 v25, a155
  v_mul_f32 v24, v24, v29
  v_mul_f32 v25, v25, v29
  v_accvgpr_write_b32 a154, v24
  v_accvgpr_write_b32 a155, v25
  v_accvgpr_read_b32 v24, a156
  v_accvgpr_read_b32 v25, a157
  v_mul_f32 v24, v24, v29
  v_mul_f32 v25, v25, v29
  v_accvgpr_write_b32 a156, v24
  v_accvgpr_write_b32 a157, v25
  v_accvgpr_read_b32 v24, a158
  v_accvgpr_read_b32 v25, a159
  v_mul_f32 v24, v24, v29
  v_mul_f32 v25, v25, v29
  v_accvgpr_write_b32 a158, v24
  v_accvgpr_write_b32 a159, v25
  v_accvgpr_read_b32 v24, a160
  v_accvgpr_read_b32 v25, a161
  v_mul_f32 v24, v24, v29
  v_mul_f32 v25, v25, v29
  v_accvgpr_write_b32 a160, v24
  v_accvgpr_write_b32 a161, v25
  v_accvgpr_read_b32 v24, a162
  v_accvgpr_read_b32 v25, a163
  v_mul_f32 v24, v24, v29
  v_mul_f32 v25, v25, v29
  v_accvgpr_write_b32 a162, v24
  v_accvgpr_write_b32 a163, v25
  v_accvgpr_read_b32 v24, a164
  v_accvgpr_read_b32 v25, a165
  v_mul_f32 v24, v24, v29
  v_mul_f32 v25, v25, v29
  v_accvgpr_write_b32 a164, v24
  v_accvgpr_write_b32 a165, v25
  v_accvgpr_read_b32 v24, a166
  v_accvgpr_read_b32 v25, a167
  v_mul_f32 v24, v24, v29
  v_mul_f32 v25, v25, v29
  v_accvgpr_write_b32 a166, v24
  v_accvgpr_write_b32 a167, v25
  v_accvgpr_read_b32 v24, a168
  v_accvgpr_read_b32 v25, a169
  v_mul_f32 v24, v24, v29
  v_mul_f32 v25, v25, v29
  v_accvgpr_write_b32 a168, v24
  v_accvgpr_write_b32 a169, v25
  v_accvgpr_read_b32 v24, a170
  v_accvgpr_read_b32 v25, a171
  v_mul_f32 v24, v24, v29
  v_mul_f32 v25, v25, v29
  v_accvgpr_write_b32 a170, v24
  v_accvgpr_write_b32 a171, v25
  v_accvgpr_read_b32 v24, a172
  v_accvgpr_read_b32 v25, a173
  v_mul_f32 v24, v24, v29
  v_mul_f32 v25, v25, v29
  v_accvgpr_write_b32 a172, v24
  v_accvgpr_write_b32 a173, v25
  v_accvgpr_read_b32 v24, a174
  v_accvgpr_read_b32 v25, a175
  v_mul_f32 v24, v24, v29
  v_mul_f32 v25, v25, v29
  v_accvgpr_write_b32 a174, v24
  v_accvgpr_write_b32 a175, v25
  v_accvgpr_read_b32 v24, a176
  v_accvgpr_read_b32 v25, a177
  v_mul_f32 v24, v24, v29
  v_mul_f32 v25, v25, v29
  v_accvgpr_write_b32 a176, v24
  v_accvgpr_write_b32 a177, v25
  v_accvgpr_read_b32 v24, a178
  v_accvgpr_read_b32 v25, a179
  v_mul_f32 v24, v24, v29
  v_mul_f32 v25, v25, v29
  v_accvgpr_write_b32 a178, v24
  v_accvgpr_write_b32 a179, v25
  v_accvgpr_read_b32 v24, a180
  v_accvgpr_read_b32 v25, a181
  v_mul_f32 v24, v24, v29
  v_mul_f32 v25, v25, v29
  v_accvgpr_write_b32 a180, v24
  v_accvgpr_write_b32 a181, v25
  v_accvgpr_read_b32 v24, a182
  v_accvgpr_read_b32 v25, a183
  v_mul_f32 v24, v24, v29
  v_mul_f32 v25, v25, v29
  v_accvgpr_write_b32 a182, v24
  v_accvgpr_write_b32 a183, v25
  v_accvgpr_read_b32 v24, a184
  v_accvgpr_read_b32 v25, a185
  v_mul_f32 v24, v24, v29
  v_mul_f32 v25, v25, v29
  v_accvgpr_write_b32 a184, v24
  v_accvgpr_write_b32 a185, v25
  v_accvgpr_read_b32 v24, a186
  v_accvgpr_read_b32 v25, a187
  v_mul_f32 v24, v24, v29
  v_mul_f32 v25, v25, v29
  v_accvgpr_write_b32 a186, v24
  v_accvgpr_write_b32 a187, v25
  v_accvgpr_read_b32 v24, a188
  v_accvgpr_read_b32 v25, a189
  v_mul_f32 v24, v24, v29
  v_mul_f32 v25, v25, v29
  v_accvgpr_write_b32 a188, v24
  v_accvgpr_write_b32 a189, v25
  v_accvgpr_read_b32 v24, a190
  v_accvgpr_read_b32 v25, a191
  v_mul_f32 v24, v24, v29
  v_mul_f32 v25, v25, v29
  v_accvgpr_write_b32 a190, v24
  v_accvgpr_write_b32 a191, v25
  v_accvgpr_read_b32 v24, a192
  v_accvgpr_read_b32 v25, a193
  v_mul_f32 v24, v24, v29
  v_mul_f32 v25, v25, v29
  v_accvgpr_write_b32 a192, v24
  v_accvgpr_write_b32 a193, v25
  v_accvgpr_read_b32 v24, a194
  v_accvgpr_read_b32 v25, a195
  v_mul_f32 v24, v24, v29
  v_mul_f32 v25, v25, v29
  v_accvgpr_write_b32 a194, v24
  v_accvgpr_write_b32 a195, v25
  v_accvgpr_read_b32 v24, a196
  v_accvgpr_read_b32 v25, a197
  v_mul_f32 v24, v24, v29
  v_mul_f32 v25, v25, v29
  v_accvgpr_write_b32 a196, v24
  v_accvgpr_write_b32 a197, v25
  v_accvgpr_read_b32 v24, a198
  v_accvgpr_read_b32 v25, a199
  v_mul_f32 v24, v24, v29
  v_mul_f32 v25, v25, v29
  v_accvgpr_write_b32 a198, v24
  v_accvgpr_write_b32 a199, v25
  v_accvgpr_read_b32 v24, a200
  v_accvgpr_read_b32 v25, a201
  v_mul_f32 v24, v24, v29
  v_mul_f32 v25, v25, v29
  v_accvgpr_write_b32 a200, v24
  v_accvgpr_write_b32 a201, v25
  v_accvgpr_read_b32 v24, a202
  v_accvgpr_read_b32 v25, a203
  v_mul_f32 v24, v24, v29
  v_mul_f32 v25, v25, v29
  v_accvgpr_write_b32 a202, v24
  v_accvgpr_write_b32 a203, v25
  v_accvgpr_read_b32 v24, a204
  v_accvgpr_read_b32 v25, a205
  v_mul_f32 v24, v24, v29
  v_mul_f32 v25, v25, v29
  v_accvgpr_write_b32 a204, v24
  v_accvgpr_write_b32 a205, v25
  v_accvgpr_read_b32 v24, a206
  v_accvgpr_read_b32 v25, a207
  v_mul_f32 v24, v24, v29
  v_mul_f32 v25, v25, v29
  v_accvgpr_write_b32 a206, v24
  v_accvgpr_write_b32 a207, v25
  v_accvgpr_read_b32 v24, a208
  v_accvgpr_read_b32 v25, a209
  v_mul_f32 v24, v24, v29
  v_mul_f32 v25, v25, v29
  v_accvgpr_write_b32 a208, v24
  v_accvgpr_write_b32 a209, v25
  v_accvgpr_read_b32 v24, a210
  v_accvgpr_read_b32 v25, a211
  v_mul_f32 v24, v24, v29
  v_mul_f32 v25, v25, v29
  v_accvgpr_write_b32 a210, v24
  v_accvgpr_write_b32 a211, v25
  v_accvgpr_read_b32 v24, a212
  v_accvgpr_read_b32 v25, a213
  v_mul_f32 v24, v24, v29
  v_mul_f32 v25, v25, v29
  v_accvgpr_write_b32 a212, v24
  v_accvgpr_write_b32 a213, v25
  v_accvgpr_read_b32 v24, a214
  v_accvgpr_read_b32 v25, a215
  v_mul_f32 v24, v24, v29
  v_mul_f32 v25, v25, v29
  v_accvgpr_write_b32 a214, v24
  v_accvgpr_write_b32 a215, v25
  v_accvgpr_read_b32 v24, a216
  v_accvgpr_read_b32 v25, a217
  v_mul_f32 v24, v24, v29
  v_mul_f32 v25, v25, v29
  v_accvgpr_write_b32 a216, v24
  v_accvgpr_write_b32 a217, v25
  v_accvgpr_read_b32 v24, a218
  v_accvgpr_read_b32 v25, a219
  v_mul_f32 v24, v24, v29
  v_mul_f32 v25, v25, v29
  v_accvgpr_write_b32 a218, v24
  v_accvgpr_write_b32 a219, v25
  v_accvgpr_read_b32 v24, a220
  v_accvgpr_read_b32 v25, a221
  v_mul_f32 v24, v24, v29
  v_mul_f32 v25, v25, v29
  v_accvgpr_write_b32 a220, v24
  v_accvgpr_write_b32 a221, v25
  v_accvgpr_read_b32 v24, a222
  v_accvgpr_read_b32 v25, a223
  v_mul_f32 v24, v24, v29
  v_mul_f32 v25, v25, v29
  v_accvgpr_write_b32 a222, v24
  v_accvgpr_write_b32 a223, v25
  v_accvgpr_read_b32 v24, a224
  v_accvgpr_read_b32 v25, a225
  v_mul_f32 v24, v24, v29
  v_mul_f32 v25, v25, v29
  v_accvgpr_write_b32 a224, v24
  v_accvgpr_write_b32 a225, v25
  v_accvgpr_read_b32 v24, a226
  v_accvgpr_read_b32 v25, a227
  v_mul_f32 v24, v24, v29
  v_mul_f32 v25, v25, v29
  v_accvgpr_write_b32 a226, v24
  v_accvgpr_write_b32 a227, v25
  v_accvgpr_read_b32 v24, a228
  v_accvgpr_read_b32 v25, a229
  v_mul_f32 v24, v24, v29
  v_mul_f32 v25, v25, v29
  v_accvgpr_write_b32 a228, v24
  v_accvgpr_write_b32 a229, v25
  v_accvgpr_read_b32 v24, a230
  v_accvgpr_read_b32 v25, a231
  v_mul_f32 v24, v24, v29
  v_mul_f32 v25, v25, v29
  v_accvgpr_write_b32 a230, v24
  v_accvgpr_write_b32 a231, v25
  v_accvgpr_read_b32 v24, a232
  v_accvgpr_read_b32 v25, a233
  v_mul_f32 v24, v24, v29
  v_mul_f32 v25, v25, v29
  v_accvgpr_write_b32 a232, v24
  v_accvgpr_write_b32 a233, v25
  v_accvgpr_read_b32 v24, a234
  v_accvgpr_read_b32 v25, a235
  v_mul_f32 v24, v24, v29
  v_mul_f32 v25, v25, v29
  v_accvgpr_write_b32 a234, v24
  v_accvgpr_write_b32 a235, v25
  v_accvgpr_read_b32 v24, a236
  v_accvgpr_read_b32 v25, a237
  v_mul_f32 v24, v24, v29
  v_mul_f32 v25, v25, v29
  v_accvgpr_write_b32 a236, v24
  v_accvgpr_write_b32 a237, v25
  v_accvgpr_read_b32 v24, a238
  v_accvgpr_read_b32 v25, a239
  v_mul_f32 v24, v24, v29
  v_mul_f32 v25, v25, v29
  v_accvgpr_write_b32 a238, v24
  v_accvgpr_write_b32 a239, v25
  v_accvgpr_read_b32 v24, a240
  v_accvgpr_read_b32 v25, a241
  v_mul_f32 v24, v24, v29
  v_mul_f32 v25, v25, v29
  v_accvgpr_write_b32 a240, v24
  v_accvgpr_write_b32 a241, v25
  v_accvgpr_read_b32 v24, a242
  v_accvgpr_read_b32 v25, a243
  v_mul_f32 v24, v24, v29
  v_mul_f32 v25, v25, v29
  v_accvgpr_write_b32 a242, v24
  v_accvgpr_write_b32 a243, v25
  v_accvgpr_read_b32 v24, a244
  v_accvgpr_read_b32 v25, a245
  v_mul_f32 v24, v24, v29
  v_mul_f32 v25, v25, v29
  v_accvgpr_write_b32 a244, v24
  v_accvgpr_write_b32 a245, v25
  v_accvgpr_read_b32 v24, a246
  v_accvgpr_read_b32 v25, a247
  v_mul_f32 v24, v24, v29
  v_mul_f32 v25, v25, v29
  v_accvgpr_write_b32 a246, v24
  v_accvgpr_write_b32 a247, v25
  v_accvgpr_read_b32 v24, a248
  v_accvgpr_read_b32 v25, a249
  v_mul_f32 v24, v24, v29
  v_mul_f32 v25, v25, v29
  v_accvgpr_write_b32 a248, v24
  v_accvgpr_write_b32 a249, v25
  v_accvgpr_read_b32 v24, a250
  v_accvgpr_read_b32 v25, a251
  v_mul_f32 v24, v24, v29
  v_mul_f32 v25, v25, v29
  v_accvgpr_write_b32 a250, v24
  v_accvgpr_write_b32 a251, v25
  v_accvgpr_read_b32 v24, a252
  v_accvgpr_read_b32 v25, a253
  v_mul_f32 v24, v24, v29
  v_mul_f32 v25, v25, v29
  v_accvgpr_write_b32 a252, v24
  v_accvgpr_write_b32 a253, v25
  v_accvgpr_read_b32 v24, a254
  v_accvgpr_read_b32 v25, a255
  v_mul_f32 v24, v24, v29
  v_mul_f32 v25, v25, v29
  v_accvgpr_write_b32 a254, v24
  v_accvgpr_write_b32 a255, v25
  s_nop 1
  v_exp_f32 v56, v96
  s_nop 1
  v_exp_f32 v24, v97
  s_nop 1
  v_add_f32 v31, v56, v24
  s_nop 1
  v_cvt_pk_bf16_f32 v56, v56, v24
  s_nop 1
  v_exp_f32 v57, v98
  s_nop 1
  v_add_f32 v31, v31, v57
  s_nop 1
  v_exp_f32 v25, v99
  s_nop 1
  v_add_f32 v31, v31, v25
  s_nop 1
  v_cvt_pk_bf16_f32 v57, v57, v25
  s_nop 1
  v_exp_f32 v60, v100
  s_nop 1
  v_add_f32 v31, v31, v60
  s_nop 1
  v_exp_f32 v24, v101
  s_nop 1
  v_add_f32 v31, v31, v24
  s_nop 1
  v_cvt_pk_bf16_f32 v60, v60, v24
  s_nop 1
  v_exp_f32 v61, v102
  s_nop 1
  v_add_f32 v31, v31, v61
  s_nop 1
  v_exp_f32 v25, v103
  s_nop 1
  v_add_f32 v31, v31, v25
  s_nop 1
  v_cvt_pk_bf16_f32 v61, v61, v25
  s_nop 1
  v_exp_f32 v58, v104
  s_nop 1
  v_exp_f32 v24, v105
  s_nop 1
  v_add_f32 v0, v58, v24
  s_nop 1
  v_cvt_pk_bf16_f32 v58, v58, v24
  s_nop 1
  v_permlane16_swap_b32 v56, v58
  s_nop 1
  v_exp_f32 v59, v106
  s_nop 1
  v_add_f32 v0, v0, v59
  s_nop 1
  v_exp_f32 v25, v107
  s_nop 1
  v_add_f32 v0, v0, v25
  s_nop 1
  v_cvt_pk_bf16_f32 v59, v59, v25
  s_nop 1
  v_permlane16_swap_b32 v57, v59
  s_nop 1
  v_exp_f32 v62, v108
  s_nop 1
  v_add_f32 v0, v0, v62
  s_nop 1
  v_exp_f32 v24, v109
  s_nop 1
  v_add_f32 v0, v0, v24
  s_nop 1
  v_cvt_pk_bf16_f32 v62, v62, v24
  s_nop 1
  v_permlane16_swap_b32 v60, v62
  s_nop 1
  v_exp_f32 v63, v110
  s_nop 1
  v_add_f32 v0, v0, v63
  s_nop 1
  v_exp_f32 v25, v111
  s_nop 1
  v_add_f32 v0, v0, v25
  s_nop 1
  v_cvt_pk_bf16_f32 v63, v63, v25
  s_nop 1
  v_permlane16_swap_b32 v61, v63
  s_nop 3
  s_branch RET4
RARE5:
  s_nop 7
  s_nop 7
  v_max3_f32 v29, v80, v81, 0
  v_max3_f32 v29, v29, v82, v83
  v_max3_f32 v29, v29, v84, v85
  v_max3_f32 v29, v29, v86, v87
  v_mov_b32 v30, v29
  s_nop 1
  v_permlane32_swap_b32 v29, v30
  s_nop 1
  v_max_f32 v29, v29, v30
  v_mov_b32 v30, v29
  s_nop 1
  v_permlane16_swap_b32 v29, v30
  s_nop 1
  v_max_f32 v29, v29, v30
  v_add_f32 v10, v10, v29
  v_sub_f32 v80, v80, v29
  v_sub_f32 v81, v81, v29
  v_sub_f32 v82, v82, v29
  v_sub_f32 v83, v83, v29
  v_sub_f32 v84, v84, v29
  v_sub_f32 v85, v85, v29
  v_sub_f32 v86, v86, v29
  v_sub_f32 v87, v87, v29
  v_sub_f32 v31, 0, v29
  v_exp_f32 v31, v31
  s_nop 1
  v_mul_f32 v26, v26, v31
  v_max3_f32 v29, v88, v89, 0
  v_max3_f32 v29, v29, v90, v91
  v_max3_f32 v29, v29, v92, v93
  v_max3_f32 v29, v29, v94, v95
  v_mov_b32 v30, v29
  s_nop 1
  v_permlane32_swap_b32 v29, v30
  s_nop 1
  v_max_f32 v29, v29, v30
  v_mov_b32 v30, v29
  s_nop 1
  v_permlane16_swap_b32 v29, v30
  s_nop 1
  v_max_f32 v29, v29, v30
  v_add_f32 v11, v11, v29
  v_sub_f32 v88, v88, v29
  v_sub_f32 v89, v89, v29
  v_sub_f32 v90, v90, v29
  v_sub_f32 v91, v91, v29
  v_sub_f32 v92, v92, v29
  v_sub_f32 v93, v93, v29
  v_sub_f32 v94, v94, v29
  v_sub_f32 v95, v95, v29
  v_sub_f32 v0, 0, v29
  v_exp_f32 v0, v0
  s_nop 1
  v_mul_f32 v27, v27, v0
  v_cndmask_b32 v29, v31, v0, s[96:97]
  s_nop 1
  v_mov_b32 v28, v29
  s_mov_b32 s26, 1
  s_nop 1
  v_exp_f32 v72, v80
  s_nop 1
  v_exp_f32 v24, v81
  s_nop 1
  v_add_f32 v31, v72, v24
  s_nop 1
  v_cvt_pk_bf16_f32 v72, v72, v24
  s_nop 1
  v_exp_f32 v73, v82
  s_nop 1
  v_add_f32 v31, v31, v73
  s_nop 1
  v_exp_f32 v25, v83
  s_nop 1
  v_add_f32 v31, v31, v25
  s_nop 1
  v_cvt_pk_bf16_f32 v73, v73, v25
  s_nop 1
  v_exp_f32 v76, v84
  s_nop 1
  v_add_f32 v31, v31, v76
  s_nop 1
  v_exp_f32 v24, v85
  s_nop 1
  v_add_f32 v31, v31, v24
  s_nop 1
  v_cvt_pk_bf16_f32 v76, v76, v24
  s_nop 1
  v_exp_f32 v77, v86
  s_nop 1
  v_add_f32 v31, v31, v77
  s_nop 1
  v_exp_f32 v25, v87
  s_nop 1
  v_add_f32 v31, v31, v25
  s_nop 1
  v_cvt_pk_bf16_f32 v77, v77, v25
  s_nop 1
  v_exp_f32 v74, v88
  s_nop 1
  v_exp_f32 v24, v89
  s_nop 1
  v_add_f32 v0, v74, v24
  s_nop 1
  v_cvt_pk_bf16_f32 v74, v74, v24
  s_nop 1
  v_permlane16_swap_b32 v72, v74
  s_nop 1
  v_exp_f32 v75, v90
  s_nop 1
  v_add_f32 v0, v0, v75
  s_nop 1
  v_exp_f32 v25, v91
  s_nop 1
  v_add_f32 v0, v0, v25
  s_nop 1
  v_cvt_pk_bf16_f32 v75, v75, v25
  s_nop 1
  v_permlane16_swap_b32 v73, v75
  s_nop 1
  v_exp_f32 v78, v92
  s_nop 1
  v_add_f32 v0, v0, v78
  s_nop 1
  v_exp_f32 v24, v93
  s_nop 1
  v_add_f32 v0, v0, v24
  s_nop 1
  v_cvt_pk_bf16_f32 v78, v78, v24
  s_nop 1
  v_permlane16_swap_b32 v76, v78
  s_nop 1
  v_exp_f32 v79, v94
  s_nop 1
  v_add_f32 v0, v0, v79
  s_nop 1
  v_exp_f32 v25, v95
  s_nop 1
  v_add_f32 v0, v0, v25
  s_nop 1
  v_cvt_pk_bf16_f32 v79, v79, v25
  s_nop 1
  v_permlane16_swap_b32 v77, v79
  s_nop 3
  s_branch RET5
RARE6:
  s_nop 7
  s_nop 7
  v_mul_f32 v128, v128, v28
  v_mul_f32 v129, v129, v28
  v_mul_f32 v130, v130, v28
  v_mul_f32 v131, v131, v28
  v_mul_f32 v132, v132, v28
  v_mul_f32 v133, v133, v28
  v_mul_f32 v134, v134, v28
  v_mul_f32 v135, v135, v28
  v_mul_f32 v136, v136, v28
  v_mul_f32 v137, v137, v28
  v_mul_f32 v138, v138, v28
  v_mul_f32 v139, v139, v28
  v_mul_f32 v140, v140, v28
  v_mul_f32 v141, v141, v28
  v_mul_f32 v142, v142, v28
  v_mul_f32 v143, v143, v28
  v_mul_f32 v144, v144, v28
  v_mul_f32 v145, v145, v28
  v_mul_f32 v146, v146, v28
  v_mul_f32 v147, v147, v28
  v_mul_f32 v148, v148, v28
  v_mul_f32 v149, v149, v28
  v_mul_f32 v150, v150, v28
  v_mul_f32 v151, v151, v28
  v_mul_f32 v152, v152, v28
  v_mul_f32 v153, v153, v28
  v_mul_f32 v154, v154, v28
  v_mul_f32 v155, v155, v28
  v_mul_f32 v156, v156, v28
  v_mul_f32 v157, v157, v28
  v_mul_f32 v158, v158, v28
  v_mul_f32 v159, v159, v28
  v_mul_f32 v160, v160, v28
  v_mul_f32 v161, v161, v28
  v_mul_f32 v162, v162, v28
  v_mul_f32 v163, v163, v28
  v_mul_f32 v164, v164, v28
  v_mul_f32 v165, v165, v28
  v_mul_f32 v166, v166, v28
  v_mul_f32 v167, v167, v28
  v_mul_f32 v168, v168, v28
  v_mul_f32 v169, v169, v28
  v_mul_f32 v170, v170, v28
  v_mul_f32 v171, v171, v28
  v_mul_f32 v172, v172, v28
  v_mul_f32 v173, v173, v28
  v_mul_f32 v174, v174, v28
  v_mul_f32 v175, v175, v28
  v_mul_f32 v176, v176, v28
  v_mul_f32 v177, v177, v28
  v_mul_f32 v178, v178, v28
  v_mul_f32 v179, v179, v28
  v_mul_f32 v180, v180, v28
  v_mul_f32 v181, v181, v28
  v_mul_f32 v182, v182, v28
  v_mul_f32 v183, v183, v28
  v_mul_f32 v184, v184, v28
  v_mul_f32 v185, v185, v28
  v_mul_f32 v186, v186, v28
  v_mul_f32 v187, v187, v28
  v_mul_f32 v188, v188, v28
  v_mul_f32 v189, v189, v28
  v_mul_f32 v190, v190, v28
  v_mul_f32 v191, v191, v28
  v_mul_f32 v192, v192, v28
  v_mul_f32 v193, v193, v28
  v_mul_f32 v194, v194, v28
  v_mul_f32 v195, v195, v28
  v_mul_f32 v196, v196, v28
  v_mul_f32 v197, v197, v28
  v_mul_f32 v198, v198, v28
  v_mul_f32 v199, v199, v28
  v_mul_f32 v200, v200, v28
  v_mul_f32 v201, v201, v28
  v_mul_f32 v202, v202, v28
  v_mul_f32 v203, v203, v28
  v_mul_f32 v204, v204, v28
  v_mul_f32 v205, v205, v28
  v_mul_f32 v206, v206, v28
  v_mul_f32 v207, v207, v28
  v_mul_f32 v208, v208, v28
  v_mul_f32 v209, v209, v28
  v_mul_f32 v210, v210, v28
  v_mul_f32 v211, v211, v28
  v_mul_f32 v212, v212, v28
  v_mul_f32 v213, v213, v28
  v_mul_f32 v214, v214, v28
  v_mul_f32 v215, v215, v28
  v_mul_f32 v216, v216, v28
  v_mul_f32 v217, v217, v28
  v_mul_f32 v218, v218, v28
  v_mul_f32 v219, v219, v28
  v_mul_f32 v220, v220, v28
  v_mul_f32 v221, v221, v28
  v_mul_f32 v222, v222, v28
  v_mul_f32 v223, v223, v28
  v_mul_f32 v224, v224, v28
  v_mul_f32 v225, v225, v28
  v_mul_f32 v226, v226, v28
  v_mul_f32 v227, v227, v28
  v_mul_f32 v228, v228, v28
  v_mul_f32 v229, v229, v28
  v_mul_f32 v230, v230, v28
  v_mul_f32 v231, v231, v28
  v_mul_f32 v232, v232, v28
  v_mul_f32 v233, v233, v28
  v_mul_f32 v234, v234, v28
  v_mul_f32 v235, v235, v28
  v_mul_f32 v236, v236, v28
  v_mul_f32 v237, v237, v28
  v_mul_f32 v238, v238, v28
  v_mul_f32 v239, v239, v28
  v_mul_f32 v240, v240, v28
  v_mul_f32 v241, v241, v28
  v_mul_f32 v242, v242, v28
  v_mul_f32 v243, v243, v28
  v_mul_f32 v244, v244, v28
  v_mul_f32 v245, v245, v28
  v_mul_f32 v246, v246, v28
  v_mul_f32 v247, v247, v28
  v_mul_f32 v248, v248, v28
  v_mul_f32 v249, v249, v28
  v_mul_f32 v250, v250, v28
  v_mul_f32 v251, v251, v28
  v_mul_f32 v252, v252, v28
  v_mul_f32 v253, v253, v28
  v_mul_f32 v254, v254, v28
  v_mul_f32 v255, v255, v28
  s_mov_b32 s26, 0
  s_nop 3
  s_branch RET6
RARE7:
  s_nop 7
  s_nop 7
  v_max3_f32 v29, v112, v113, 0
  v_max3_f32 v29, v29, v114, v115
  v_max3_f32 v29, v29, v116, v117
  v_max3_f32 v29, v29, v118, v119
  v_mov_b32 v30, v29
  s_nop 1
  v_permlane32_swap_b32 v29, v30
  s_nop 1
  v_max_f32 v29, v29, v30
  v_mov_b32 v30, v29
  s_nop 1
  v_permlane16_swap_b32 v29, v30
  s_nop 1
  v_max_f32 v29, v29, v30
  v_add_f32 v12, v12, v29
  v_sub_f32 v112, v112, v29
  v_sub_f32 v113, v113, v29
  v_sub_f32 v114, v114, v29
  v_sub_f32 v115, v115, v29
  v_sub_f32 v116, v116, v29
  v_sub_f32 v117, v117, v29
  v_sub_f32 v118, v118, v29
  v_sub_f32 v119, v119, v29
  v_sub_f32 v31, 0, v29
  v_exp_f32 v31, v31
  s_nop 1
  v_mul_f32 v22, v22, v31
  v_max3_f32 v29, v120, v121, 0
  v_max3_f32 v29, v29, v122, v123
  v_max3_f32 v29, v29, v124, v125
  v_max3_f32 v29, v29, v126, v127
  v_mov_b32 v30, v29
  s_nop 1
  v_permlane32_swap_b32 v29, v30
  s_nop 1
  v_max_f32 v29, v29, v30
  v_mov_b32 v30, v29
  s_nop 1
  v_permlane16_swap_b32 v29, v30
  s_nop 1
  v_max_f32 v29, v29, v30
  v_add_f32 v13, v13, v29
  v_sub_f32 v120, v120, v29
  v_sub_f32 v121, v121, v29
  v_sub_f32 v122, v122, v29
  v_sub_f32 v123, v123, v29
  v_sub_f32 v124, v124, v29
  v_sub_f32 v125, v125, v29
  v_sub_f32 v126, v126, v29
  v_sub_f32 v127, v127, v29
  v_sub_f32 v0, 0, v29
  v_exp_f32 v0, v0
  s_nop 1
  v_mul_f32 v23, v23, v0
  v_cndmask_b32 v29, v31, v0, s[96:97]
  s_nop 1
  v_accvgpr_read_b32 v24, a128
  v_accvgpr_read_b32 v25, a129
  v_mul_f32 v24, v24, v29
  v_mul_f32 v25, v25, v29
  v_accvgpr_write_b32 a128, v24
  v_accvgpr_write_b32 a129, v25
  v_accvgpr_read_b32 v24, a130
  v_accvgpr_read_b32 v25, a131
  v_mul_f32 v24, v24, v29
  v_mul_f32 v25, v25, v29
  v_accvgpr_write_b32 a130, v24
  v_accvgpr_write_b32 a131, v25
  v_accvgpr_read_b32 v24, a132
  v_accvgpr_read_b32 v25, a133
  v_mul_f32 v24, v24, v29
  v_mul_f32 v25, v25, v29
  v_accvgpr_write_b32 a132, v24
  v_accvgpr_write_b32 a133, v25
  v_accvgpr_read_b32 v24, a134
  v_accvgpr_read_b32 v25, a135
  v_mul_f32 v24, v24, v29
  v_mul_f32 v25, v25, v29
  v_accvgpr_write_b32 a134, v24
  v_accvgpr_write_b32 a135, v25
  v_accvgpr_read_b32 v24, a136
  v_accvgpr_read_b32 v25, a137
  v_mul_f32 v24, v24, v29
  v_mul_f32 v25, v25, v29
  v_accvgpr_write_b32 a136, v24
  v_accvgpr_write_b32 a137, v25
  v_accvgpr_read_b32 v24, a138
  v_accvgpr_read_b32 v25, a139
  v_mul_f32 v24, v24, v29
  v_mul_f32 v25, v25, v29
  v_accvgpr_write_b32 a138, v24
  v_accvgpr_write_b32 a139, v25
  v_accvgpr_read_b32 v24, a140
  v_accvgpr_read_b32 v25, a141
  v_mul_f32 v24, v24, v29
  v_mul_f32 v25, v25, v29
  v_accvgpr_write_b32 a140, v24
  v_accvgpr_write_b32 a141, v25
  v_accvgpr_read_b32 v24, a142
  v_accvgpr_read_b32 v25, a143
  v_mul_f32 v24, v24, v29
  v_mul_f32 v25, v25, v29
  v_accvgpr_write_b32 a142, v24
  v_accvgpr_write_b32 a143, v25
  v_accvgpr_read_b32 v24, a144
  v_accvgpr_read_b32 v25, a145
  v_mul_f32 v24, v24, v29
  v_mul_f32 v25, v25, v29
  v_accvgpr_write_b32 a144, v24
  v_accvgpr_write_b32 a145, v25
  v_accvgpr_read_b32 v24, a146
  v_accvgpr_read_b32 v25, a147
  v_mul_f32 v24, v24, v29
  v_mul_f32 v25, v25, v29
  v_accvgpr_write_b32 a146, v24
  v_accvgpr_write_b32 a147, v25
  v_accvgpr_read_b32 v24, a148
  v_accvgpr_read_b32 v25, a149
  v_mul_f32 v24, v24, v29
  v_mul_f32 v25, v25, v29
  v_accvgpr_write_b32 a148, v24
  v_accvgpr_write_b32 a149, v25
  v_accvgpr_read_b32 v24, a150
  v_accvgpr_read_b32 v25, a151
  v_mul_f32 v24, v24, v29
  v_mul_f32 v25, v25, v29
  v_accvgpr_write_b32 a150, v24
  v_accvgpr_write_b32 a151, v25
  v_accvgpr_read_b32 v24, a152
  v_accvgpr_read_b32 v25, a153
  v_mul_f32 v24, v24, v29
  v_mul_f32 v25, v25, v29
  v_accvgpr_write_b32 a152, v24
  v_accvgpr_write_b32 a153, v25
  v_accvgpr_read_b32 v24, a154
  v_accvgpr_read_b32 v25, a155
  v_mul_f32 v24, v24, v29
  v_mul_f32 v25, v25, v29
  v_accvgpr_write_b32 a154, v24
  v_accvgpr_write_b32 a155, v25
  v_accvgpr_read_b32 v24, a156
  v_accvgpr_read_b32 v25, a157
  v_mul_f32 v24, v24, v29
  v_mul_f32 v25, v25, v29
  v_accvgpr_write_b32 a156, v24
  v_accvgpr_write_b32 a157, v25
  v_accvgpr_read_b32 v24, a158
  v_accvgpr_read_b32 v25, a159
  v_mul_f32 v24, v24, v29
  v_mul_f32 v25, v25, v29
  v_accvgpr_write_b32 a158, v24
  v_accvgpr_write_b32 a159, v25
  v_accvgpr_read_b32 v24, a160
  v_accvgpr_read_b32 v25, a161
  v_mul_f32 v24, v24, v29
  v_mul_f32 v25, v25, v29
  v_accvgpr_write_b32 a160, v24
  v_accvgpr_write_b32 a161, v25
  v_accvgpr_read_b32 v24, a162
  v_accvgpr_read_b32 v25, a163
  v_mul_f32 v24, v24, v29
  v_mul_f32 v25, v25, v29
  v_accvgpr_write_b32 a162, v24
  v_accvgpr_write_b32 a163, v25
  v_accvgpr_read_b32 v24, a164
  v_accvgpr_read_b32 v25, a165
  v_mul_f32 v24, v24, v29
  v_mul_f32 v25, v25, v29
  v_accvgpr_write_b32 a164, v24
  v_accvgpr_write_b32 a165, v25
  v_accvgpr_read_b32 v24, a166
  v_accvgpr_read_b32 v25, a167
  v_mul_f32 v24, v24, v29
  v_mul_f32 v25, v25, v29
  v_accvgpr_write_b32 a166, v24
  v_accvgpr_write_b32 a167, v25
  v_accvgpr_read_b32 v24, a168
  v_accvgpr_read_b32 v25, a169
  v_mul_f32 v24, v24, v29
  v_mul_f32 v25, v25, v29
  v_accvgpr_write_b32 a168, v24
  v_accvgpr_write_b32 a169, v25
  v_accvgpr_read_b32 v24, a170
  v_accvgpr_read_b32 v25, a171
  v_mul_f32 v24, v24, v29
  v_mul_f32 v25, v25, v29
  v_accvgpr_write_b32 a170, v24
  v_accvgpr_write_b32 a171, v25
  v_accvgpr_read_b32 v24, a172
  v_accvgpr_read_b32 v25, a173
  v_mul_f32 v24, v24, v29
  v_mul_f32 v25, v25, v29
  v_accvgpr_write_b32 a172, v24
  v_accvgpr_write_b32 a173, v25
  v_accvgpr_read_b32 v24, a174
  v_accvgpr_read_b32 v25, a175
  v_mul_f32 v24, v24, v29
  v_mul_f32 v25, v25, v29
  v_accvgpr_write_b32 a174, v24
  v_accvgpr_write_b32 a175, v25
  v_accvgpr_read_b32 v24, a176
  v_accvgpr_read_b32 v25, a177
  v_mul_f32 v24, v24, v29
  v_mul_f32 v25, v25, v29
  v_accvgpr_write_b32 a176, v24
  v_accvgpr_write_b32 a177, v25
  v_accvgpr_read_b32 v24, a178
  v_accvgpr_read_b32 v25, a179
  v_mul_f32 v24, v24, v29
  v_mul_f32 v25, v25, v29
  v_accvgpr_write_b32 a178, v24
  v_accvgpr_write_b32 a179, v25
  v_accvgpr_read_b32 v24, a180
  v_accvgpr_read_b32 v25, a181
  v_mul_f32 v24, v24, v29
  v_mul_f32 v25, v25, v29
  v_accvgpr_write_b32 a180, v24
  v_accvgpr_write_b32 a181, v25
  v_accvgpr_read_b32 v24, a182
  v_accvgpr_read_b32 v25, a183
  v_mul_f32 v24, v24, v29
  v_mul_f32 v25, v25, v29
  v_accvgpr_write_b32 a182, v24
  v_accvgpr_write_b32 a183, v25
  v_accvgpr_read_b32 v24, a184
  v_accvgpr_read_b32 v25, a185
  v_mul_f32 v24, v24, v29
  v_mul_f32 v25, v25, v29
  v_accvgpr_write_b32 a184, v24
  v_accvgpr_write_b32 a185, v25
  v_accvgpr_read_b32 v24, a186
  v_accvgpr_read_b32 v25, a187
  v_mul_f32 v24, v24, v29
  v_mul_f32 v25, v25, v29
  v_accvgpr_write_b32 a186, v24
  v_accvgpr_write_b32 a187, v25
  v_accvgpr_read_b32 v24, a188
  v_accvgpr_read_b32 v25, a189
  v_mul_f32 v24, v24, v29
  v_mul_f32 v25, v25, v29
  v_accvgpr_write_b32 a188, v24
  v_accvgpr_write_b32 a189, v25
  v_accvgpr_read_b32 v24, a190
  v_accvgpr_read_b32 v25, a191
  v_mul_f32 v24, v24, v29
  v_mul_f32 v25, v25, v29
  v_accvgpr_write_b32 a190, v24
  v_accvgpr_write_b32 a191, v25
  v_accvgpr_read_b32 v24, a192
  v_accvgpr_read_b32 v25, a193
  v_mul_f32 v24, v24, v29
  v_mul_f32 v25, v25, v29
  v_accvgpr_write_b32 a192, v24
  v_accvgpr_write_b32 a193, v25
  v_accvgpr_read_b32 v24, a194
  v_accvgpr_read_b32 v25, a195
  v_mul_f32 v24, v24, v29
  v_mul_f32 v25, v25, v29
  v_accvgpr_write_b32 a194, v24
  v_accvgpr_write_b32 a195, v25
  v_accvgpr_read_b32 v24, a196
  v_accvgpr_read_b32 v25, a197
  v_mul_f32 v24, v24, v29
  v_mul_f32 v25, v25, v29
  v_accvgpr_write_b32 a196, v24
  v_accvgpr_write_b32 a197, v25
  v_accvgpr_read_b32 v24, a198
  v_accvgpr_read_b32 v25, a199
  v_mul_f32 v24, v24, v29
  v_mul_f32 v25, v25, v29
  v_accvgpr_write_b32 a198, v24
  v_accvgpr_write_b32 a199, v25
  v_accvgpr_read_b32 v24, a200
  v_accvgpr_read_b32 v25, a201
  v_mul_f32 v24, v24, v29
  v_mul_f32 v25, v25, v29
  v_accvgpr_write_b32 a200, v24
  v_accvgpr_write_b32 a201, v25
  v_accvgpr_read_b32 v24, a202
  v_accvgpr_read_b32 v25, a203
  v_mul_f32 v24, v24, v29
  v_mul_f32 v25, v25, v29
  v_accvgpr_write_b32 a202, v24
  v_accvgpr_write_b32 a203, v25
  v_accvgpr_read_b32 v24, a204
  v_accvgpr_read_b32 v25, a205
  v_mul_f32 v24, v24, v29
  v_mul_f32 v25, v25, v29
  v_accvgpr_write_b32 a204, v24
  v_accvgpr_write_b32 a205, v25
  v_accvgpr_read_b32 v24, a206
  v_accvgpr_read_b32 v25, a207
  v_mul_f32 v24, v24, v29
  v_mul_f32 v25, v25, v29
  v_accvgpr_write_b32 a206, v24
  v_accvgpr_write_b32 a207, v25
  v_accvgpr_read_b32 v24, a208
  v_accvgpr_read_b32 v25, a209
  v_mul_f32 v24, v24, v29
  v_mul_f32 v25, v25, v29
  v_accvgpr_write_b32 a208, v24
  v_accvgpr_write_b32 a209, v25
  v_accvgpr_read_b32 v24, a210
  v_accvgpr_read_b32 v25, a211
  v_mul_f32 v24, v24, v29
  v_mul_f32 v25, v25, v29
  v_accvgpr_write_b32 a210, v24
  v_accvgpr_write_b32 a211, v25
  v_accvgpr_read_b32 v24, a212
  v_accvgpr_read_b32 v25, a213
  v_mul_f32 v24, v24, v29
  v_mul_f32 v25, v25, v29
  v_accvgpr_write_b32 a212, v24
  v_accvgpr_write_b32 a213, v25
  v_accvgpr_read_b32 v24, a214
  v_accvgpr_read_b32 v25, a215
  v_mul_f32 v24, v24, v29
  v_mul_f32 v25, v25, v29
  v_accvgpr_write_b32 a214, v24
  v_accvgpr_write_b32 a215, v25
  v_accvgpr_read_b32 v24, a216
  v_accvgpr_read_b32 v25, a217
  v_mul_f32 v24, v24, v29
  v_mul_f32 v25, v25, v29
  v_accvgpr_write_b32 a216, v24
  v_accvgpr_write_b32 a217, v25
  v_accvgpr_read_b32 v24, a218
  v_accvgpr_read_b32 v25, a219
  v_mul_f32 v24, v24, v29
  v_mul_f32 v25, v25, v29
  v_accvgpr_write_b32 a218, v24
  v_accvgpr_write_b32 a219, v25
  v_accvgpr_read_b32 v24, a220
  v_accvgpr_read_b32 v25, a221
  v_mul_f32 v24, v24, v29
  v_mul_f32 v25, v25, v29
  v_accvgpr_write_b32 a220, v24
  v_accvgpr_write_b32 a221, v25
  v_accvgpr_read_b32 v24, a222
  v_accvgpr_read_b32 v25, a223
  v_mul_f32 v24, v24, v29
  v_mul_f32 v25, v25, v29
  v_accvgpr_write_b32 a222, v24
  v_accvgpr_write_b32 a223, v25
  v_accvgpr_read_b32 v24, a224
  v_accvgpr_read_b32 v25, a225
  v_mul_f32 v24, v24, v29
  v_mul_f32 v25, v25, v29
  v_accvgpr_write_b32 a224, v24
  v_accvgpr_write_b32 a225, v25
  v_accvgpr_read_b32 v24, a226
  v_accvgpr_read_b32 v25, a227
  v_mul_f32 v24, v24, v29
  v_mul_f32 v25, v25, v29
  v_accvgpr_write_b32 a226, v24
  v_accvgpr_write_b32 a227, v25
  v_accvgpr_read_b32 v24, a228
  v_accvgpr_read_b32 v25, a229
  v_mul_f32 v24, v24, v29
  v_mul_f32 v25, v25, v29
  v_accvgpr_write_b32 a228, v24
  v_accvgpr_write_b32 a229, v25
  v_accvgpr_read_b32 v24, a230
  v_accvgpr_read_b32 v25, a231
  v_mul_f32 v24, v24, v29
  v_mul_f32 v25, v25, v29
  v_accvgpr_write_b32 a230, v24
  v_accvgpr_write_b32 a231, v25
  v_accvgpr_read_b32 v24, a232
  v_accvgpr_read_b32 v25, a233
  v_mul_f32 v24, v24, v29
  v_mul_f32 v25, v25, v29
  v_accvgpr_write_b32 a232, v24
  v_accvgpr_write_b32 a233, v25
  v_accvgpr_read_b32 v24, a234
  v_accvgpr_read_b32 v25, a235
  v_mul_f32 v24, v24, v29
  v_mul_f32 v25, v25, v29
  v_accvgpr_write_b32 a234, v24
  v_accvgpr_write_b32 a235, v25
  v_accvgpr_read_b32 v24, a236
  v_accvgpr_read_b32 v25, a237
  v_mul_f32 v24, v24, v29
  v_mul_f32 v25, v25, v29
  v_accvgpr_write_b32 a236, v24
  v_accvgpr_write_b32 a237, v25
  v_accvgpr_read_b32 v24, a238
  v_accvgpr_read_b32 v25, a239
  v_mul_f32 v24, v24, v29
  v_mul_f32 v25, v25, v29
  v_accvgpr_write_b32 a238, v24
  v_accvgpr_write_b32 a239, v25
  v_accvgpr_read_b32 v24, a240
  v_accvgpr_read_b32 v25, a241
  v_mul_f32 v24, v24, v29
  v_mul_f32 v25, v25, v29
  v_accvgpr_write_b32 a240, v24
  v_accvgpr_write_b32 a241, v25
  v_accvgpr_read_b32 v24, a242
  v_accvgpr_read_b32 v25, a243
  v_mul_f32 v24, v24, v29
  v_mul_f32 v25, v25, v29
  v_accvgpr_write_b32 a242, v24
  v_accvgpr_write_b32 a243, v25
  v_accvgpr_read_b32 v24, a244
  v_accvgpr_read_b32 v25, a245
  v_mul_f32 v24, v24, v29
  v_mul_f32 v25, v25, v29
  v_accvgpr_write_b32 a244, v24
  v_accvgpr_write_b32 a245, v25
  v_accvgpr_read_b32 v24, a246
  v_accvgpr_read_b32 v25, a247
  v_mul_f32 v24, v24, v29
  v_mul_f32 v25, v25, v29
  v_accvgpr_write_b32 a246, v24
  v_accvgpr_write_b32 a247, v25
  v_accvgpr_read_b32 v24, a248
  v_accvgpr_read_b32 v25, a249
  v_mul_f32 v24, v24, v29
  v_mul_f32 v25, v25, v29
  v_accvgpr_write_b32 a248, v24
  v_accvgpr_write_b32 a249, v25
  v_accvgpr_read_b32 v24, a250
  v_accvgpr_read_b32 v25, a251
  v_mul_f32 v24, v24, v29
  v_mul_f32 v25, v25, v29
  v_accvgpr_write_b32 a250, v24
  v_accvgpr_write_b32 a251, v25
  v_accvgpr_read_b32 v24, a252
  v_accvgpr_read_b32 v25, a253
  v_mul_f32 v24, v24, v29
  v_mul_f32 v25, v25, v29
  v_accvgpr_write_b32 a252, v24
  v_accvgpr_write_b32 a253, v25
  v_accvgpr_read_b32 v24, a254
  v_accvgpr_read_b32 v25, a255
  v_mul_f32 v24, v24, v29
  v_mul_f32 v25, v25, v29
  v_accvgpr_write_b32 a254, v24
  v_accvgpr_write_b32 a255, v25
  s_nop 1
  v_exp_f32 v64, v112
  s_nop 1
  v_exp_f32 v24, v113
  s_nop 1
  v_add_f32 v31, v64, v24
  s_nop 1
  v_cvt_pk_bf16_f32 v64, v64, v24
  s_nop 1
  v_exp_f32 v65, v114
  s_nop 1
  v_add_f32 v31, v31, v65
  s_nop 1
  v_exp_f32 v25, v115
  s_nop 1
  v_add_f32 v31, v31, v25
  s_nop 1
  v_cvt_pk_bf16_f32 v65, v65, v25
  s_nop 1
  v_exp_f32 v68, v116
  s_nop 1
  v_add_f32 v31, v31, v68
  s_nop 1
  v_exp_f32 v24, v117
  s_nop 1
  v_add_f32 v31, v31, v24
  s_nop 1
  v_cvt_pk_bf16_f32 v68, v68, v24
  s_nop 1
  v_exp_f32 v69, v118
  s_nop 1
  v_add_f32 v31, v31, v69
  s_nop 1
  v_exp_f32 v25, v119
  s_nop 1
  v_add_f32 v31, v31, v25
  s_nop 1
  v_cvt_pk_bf16_f32 v69, v69, v25
  s_nop 1
  v_exp_f32 v66, v120
  s_nop 1
  v_exp_f32 v24, v121
  s_nop 1
  v_add_f32 v0, v66, v24
  s_nop 1
  v_cvt_pk_bf16_f32 v66, v66, v24
  s_nop 1
  v_permlane16_swap_b32 v64, v66
  s_nop 1
  v_exp_f32 v67, v122
  s_nop 1
  v_add_f32 v0, v0, v67
  s_nop 1
  v_exp_f32 v25, v123
  s_nop 1
  v_add_f32 v0, v0, v25
  s_nop 1
  v_cvt_pk_bf16_f32 v67, v67, v25
  s_nop 1
  v_permlane16_swap_b32 v65, v67
  s_nop 1
  v_exp_f32 v70, v124
  s_nop 1
  v_add_f32 v0, v0, v70
  s_nop 1
  v_exp_f32 v24, v125
  s_nop 1
  v_add_f32 v0, v0, v24
  s_nop 1
  v_cvt_pk_bf16_f32 v70, v70, v24
  s_nop 1
  v_permlane16_swap_b32 v68, v70
  s_nop 1
  v_exp_f32 v71, v126
  s_nop 1
  v_add_f32 v0, v0, v71
  s_nop 1
  v_exp_f32 v25, v127
  s_nop 1
  v_add_f32 v0, v0, v25
  s_nop 1
  v_cvt_pk_bf16_f32 v71, v71, v25
  s_nop 1
  v_permlane16_swap_b32 v69, v71
  s_nop 3
  s_branch RET7
RARE8:
  s_nop 7
  s_nop 7
  v_max3_f32 v29, v96, v97, 0
  v_max3_f32 v29, v29, v98, v99
  v_max3_f32 v29, v29, v100, v101
  v_max3_f32 v29, v29, v102, v103
  v_mov_b32 v30, v29
  s_nop 1
  v_permlane32_swap_b32 v29, v30
  s_nop 1
  v_max_f32 v29, v29, v30
  v_mov_b32 v30, v29
  s_nop 1
  v_permlane16_swap_b32 v29, v30
  s_nop 1
  v_max_f32 v29, v29, v30
  v_add_f32 v10, v10, v29
  v_sub_f32 v96, v96, v29
  v_sub_f32 v97, v97, v29
  v_sub_f32 v98, v98, v29
  v_sub_f32 v99, v99, v29
  v_sub_f32 v100, v100, v29
  v_sub_f32 v101, v101, v29
  v_sub_f32 v102, v102, v29
  v_sub_f32 v103, v103, v29
  v_sub_f32 v31, 0, v29
  v_exp_f32 v31, v31
  s_nop 1
  v_mul_f32 v26, v26, v31
  v_max3_f32 v29, v104, v105, 0
  v_max3_f32 v29, v29, v106, v107
  v_max3_f32 v29, v29, v108, v109
  v_max3_f32 v29, v29, v110, v111
  v_mov_b32 v30, v29
  s_nop 1
  v_permlane32_swap_b32 v29, v30
  s_nop 1
  v_max_f32 v29, v29, v30
  v_mov_b32 v30, v29
  s_nop 1
  v_permlane16_swap_b32 v29, v30
  s_nop 1
  v_max_f32 v29, v29, v30
  v_add_f32 v11, v11, v29
  v_sub_f32 v104, v104, v29
  v_sub_f32 v105, v105, v29
  v_sub_f32 v106, v106, v29
  v_sub_f32 v107, v107, v29
  v_sub_f32 v108, v108, v29
  v_sub_f32 v109, v109, v29
  v_sub_f32 v110, v110, v29
  v_sub_f32 v111, v111, v29
  v_sub_f32 v0, 0, v29
  v_exp_f32 v0, v0
  s_nop 1
  v_mul_f32 v27, v27, v0
  v_cndmask_b32 v29, v31, v0, s[96:97]
  s_nop 1
  v_mov_b32 v28, v29
  s_mov_b32 s26, 1
  s_nop 1
  v_exp_f32 v56, v96
  s_nop 1
  v_exp_f32 v24, v97
  s_nop 1
  v_add_f32 v31, v56, v24
  s_nop 1
  v_cvt_pk_bf16_f32 v56, v56, v24
  s_nop 1
  v_exp_f32 v57, v98
  s_nop 1
  v_add_f32 v31, v31, v57
  s_nop 1
  v_exp_f32 v25, v99
  s_nop 1
  v_add_f32 v31, v31, v25
  s_nop 1
  v_cvt_pk_bf16_f32 v57, v57, v25
  s_nop 1
  v_exp_f32 v60, v100
  s_nop 1
  v_add_f32 v31, v31, v60
  s_nop 1
  v_exp_f32 v24, v101
  s_nop 1
  v_add_f32 v31, v31, v24
  s_nop 1
  v_cvt_pk_bf16_f32 v60, v60, v24
  s_nop 1
  v_exp_f32 v61, v102
  s_nop 1
  v_add_f32 v31, v31, v61
  s_nop 1
  v_exp_f32 v25, v103
  s_nop 1
  v_add_f32 v31, v31, v25
  s_nop 1
  v_cvt_pk_bf16_f32 v61, v61, v25
  s_nop 1
  v_exp_f32 v58, v104
  s_nop 1
  v_exp_f32 v24, v105
  s_nop 1
  v_add_f32 v0, v58, v24
  s_nop 1
  v_cvt_pk_bf16_f32 v58, v58, v24
  s_nop 1
  v_permlane16_swap_b32 v56, v58
  s_nop 1
  v_exp_f32 v59, v106
  s_nop 1
  v_add_f32 v0, v0, v59
  s_nop 1
  v_exp_f32 v25, v107
  s_nop 1
  v_add_f32 v0, v0, v25
  s_nop 1
  v_cvt_pk_bf16_f32 v59, v59, v25
  s_nop 1
  v_permlane16_swap_b32 v57, v59
  s_nop 1
  v_exp_f32 v62, v108
  s_nop 1
  v_add_f32 v0, v0, v62
  s_nop 1
  v_exp_f32 v24, v109
  s_nop 1
  v_add_f32 v0, v0, v24
  s_nop 1
  v_cvt_pk_bf16_f32 v62, v62, v24
  s_nop 1
  v_permlane16_swap_b32 v60, v62
  s_nop 1
  v_exp_f32 v63, v110
  s_nop 1
  v_add_f32 v0, v0, v63
  s_nop 1
  v_exp_f32 v25, v111
  s_nop 1
  v_add_f32 v0, v0, v25
  s_nop 1
  v_cvt_pk_bf16_f32 v63, v63, v25
  s_nop 1
  v_permlane16_swap_b32 v61, v63
  s_nop 3
  s_branch RET8
RARE9:
  s_nop 7
  s_nop 7
  v_mul_f32 v128, v128, v28
  v_mul_f32 v129, v129, v28
  v_mul_f32 v130, v130, v28
  v_mul_f32 v131, v131, v28
  v_mul_f32 v132, v132, v28
  v_mul_f32 v133, v133, v28
  v_mul_f32 v134, v134, v28
  v_mul_f32 v135, v135, v28
  v_mul_f32 v136, v136, v28
  v_mul_f32 v137, v137, v28
  v_mul_f32 v138, v138, v28
  v_mul_f32 v139, v139, v28
  v_mul_f32 v140, v140, v28
  v_mul_f32 v141, v141, v28
  v_mul_f32 v142, v142, v28
  v_mul_f32 v143, v143, v28
  v_mul_f32 v144, v144, v28
  v_mul_f32 v145, v145, v28
  v_mul_f32 v146, v146, v28
  v_mul_f32 v147, v147, v28
  v_mul_f32 v148, v148, v28
  v_mul_f32 v149, v149, v28
  v_mul_f32 v150, v150, v28
  v_mul_f32 v151, v151, v28
  v_mul_f32 v152, v152, v28
  v_mul_f32 v153, v153, v28
  v_mul_f32 v154, v154, v28
  v_mul_f32 v155, v155, v28
  v_mul_f32 v156, v156, v28
  v_mul_f32 v157, v157, v28
  v_mul_f32 v158, v158, v28
  v_mul_f32 v159, v159, v28
  v_mul_f32 v160, v160, v28
  v_mul_f32 v161, v161, v28
  v_mul_f32 v162, v162, v28
  v_mul_f32 v163, v163, v28
  v_mul_f32 v164, v164, v28
  v_mul_f32 v165, v165, v28
  v_mul_f32 v166, v166, v28
  v_mul_f32 v167, v167, v28
  v_mul_f32 v168, v168, v28
  v_mul_f32 v169, v169, v28
  v_mul_f32 v170, v170, v28
  v_mul_f32 v171, v171, v28
  v_mul_f32 v172, v172, v28
  v_mul_f32 v173, v173, v28
  v_mul_f32 v174, v174, v28
  v_mul_f32 v175, v175, v28
  v_mul_f32 v176, v176, v28
  v_mul_f32 v177, v177, v28
  v_mul_f32 v178, v178, v28
  v_mul_f32 v179, v179, v28
  v_mul_f32 v180, v180, v28
  v_mul_f32 v181, v181, v28
  v_mul_f32 v182, v182, v28
  v_mul_f32 v183, v183, v28
  v_mul_f32 v184, v184, v28
  v_mul_f32 v185, v185, v28
  v_mul_f32 v186, v186, v28
  v_mul_f32 v187, v187, v28
  v_mul_f32 v188, v188, v28
  v_mul_f32 v189, v189, v28
  v_mul_f32 v190, v190, v28
  v_mul_f32 v191, v191, v28
  v_mul_f32 v192, v192, v28
  v_mul_f32 v193, v193, v28
  v_mul_f32 v194, v194, v28
  v_mul_f32 v195, v195, v28
  v_mul_f32 v196, v196, v28
  v_mul_f32 v197, v197, v28
  v_mul_f32 v198, v198, v28
  v_mul_f32 v199, v199, v28
  v_mul_f32 v200, v200, v28
  v_mul_f32 v201, v201, v28
  v_mul_f32 v202, v202, v28
  v_mul_f32 v203, v203, v28
  v_mul_f32 v204, v204, v28
  v_mul_f32 v205, v205, v28
  v_mul_f32 v206, v206, v28
  v_mul_f32 v207, v207, v28
  v_mul_f32 v208, v208, v28
  v_mul_f32 v209, v209, v28
  v_mul_f32 v210, v210, v28
  v_mul_f32 v211, v211, v28
  v_mul_f32 v212, v212, v28
  v_mul_f32 v213, v213, v28
  v_mul_f32 v214, v214, v28
  v_mul_f32 v215, v215, v28
  v_mul_f32 v216, v216, v28
  v_mul_f32 v217, v217, v28
  v_mul_f32 v218, v218, v28
  v_mul_f32 v219, v219, v28
  v_mul_f32 v220, v220, v28
  v_mul_f32 v221, v221, v28
  v_mul_f32 v222, v222, v28
  v_mul_f32 v223, v223, v28
  v_mul_f32 v224, v224, v28
  v_mul_f32 v225, v225, v28
  v_mul_f32 v226, v226, v28
  v_mul_f32 v227, v227, v28
  v_mul_f32 v228, v228, v28
  v_mul_f32 v229, v229, v28
  v_mul_f32 v230, v230, v28
  v_mul_f32 v231, v231, v28
  v_mul_f32 v232, v232, v28
  v_mul_f32 v233, v233, v28
  v_mul_f32 v234, v234, v28
  v_mul_f32 v235, v235, v28
  v_mul_f32 v236, v236, v28
  v_mul_f32 v237, v237, v28
  v_mul_f32 v238, v238, v28
  v_mul_f32 v239, v239, v28
  v_mul_f32 v240, v240, v28
  v_mul_f32 v241, v241, v28
  v_mul_f32 v242, v242, v28
  v_mul_f32 v243, v243, v28
  v_mul_f32 v244, v244, v28
  v_mul_f32 v245, v245, v28
  v_mul_f32 v246, v246, v28
  v_mul_f32 v247, v247, v28
  v_mul_f32 v248, v248, v28
  v_mul_f32 v249, v249, v28
  v_mul_f32 v250, v250, v28
  v_mul_f32 v251, v251, v28
  v_mul_f32 v252, v252, v28
  v_mul_f32 v253, v253, v28
  v_mul_f32 v254, v254, v28
  v_mul_f32 v255, v255, v28
  s_mov_b32 s26, 0
  s_nop 3
  s_branch RET9
RARE10:
  s_nop 7
  s_nop 7
  v_max3_f32 v29, v80, v81, 0
  v_max3_f32 v29, v29, v82, v83
  v_max3_f32 v29, v29, v84, v85
  v_max3_f32 v29, v29, v86, v87
  v_mov_b32 v30, v29
  s_nop 1
  v_permlane32_swap_b32 v29, v30
  s_nop 1
  v_max_f32 v29, v29, v30
  v_mov_b32 v30, v29
  s_nop 1
  v_permlane16_swap_b32 v29, v30
  s_nop 1
  v_max_f32 v29, v29, v30
  v_add_f32 v12, v12, v29
  v_sub_f32 v80, v80, v29
  v_sub_f32 v81, v81, v29
  v_sub_f32 v82, v82, v29
  v_sub_f32 v83, v83, v29
  v_sub_f32 v84, v84, v29
  v_sub_f32 v85, v85, v29
  v_sub_f32 v86, v86, v29
  v_sub_f32 v87, v87, v29
  v_sub_f32 v31, 0, v29
  v_exp_f32 v31, v31
  s_nop 1
  v_mul_f32 v22, v22, v31
  v_max3_f32 v29, v88, v89, 0
  v_max3_f32 v29, v29, v90, v91
  v_max3_f32 v29, v29, v92, v93
  v_max3_f32 v29, v29, v94, v95
  v_mov_b32 v30, v29
  s_nop 1
  v_permlane32_swap_b32 v29, v30
  s_nop 1
  v_max_f32 v29, v29, v30
  v_mov_b32 v30, v29
  s_nop 1
  v_permlane16_swap_b32 v29, v30
  s_nop 1
  v_max_f32 v29, v29, v30
  v_add_f32 v13, v13, v29
  v_sub_f32 v88, v88, v29
  v_sub_f32 v89, v89, v29
  v_sub_f32 v90, v90, v29
  v_sub_f32 v91, v91, v29
  v_sub_f32 v92, v92, v29
  v_sub_f32 v93, v93, v29
  v_sub_f32 v94, v94, v29
  v_sub_f32 v95, v95, v29
  v_sub_f32 v0, 0, v29
  v_exp_f32 v0, v0
  s_nop 1
  v_mul_f32 v23, v23, v0
  v_cndmask_b32 v29, v31, v0, s[96:97]
  s_nop 1
  v_accvgpr_read_b32 v24, a128
  v_accvgpr_read_b32 v25, a129
  v_mul_f32 v24, v24, v29
  v_mul_f32 v25, v25, v29
  v_accvgpr_write_b32 a128, v24
  v_accvgpr_write_b32 a129, v25
  v_accvgpr_read_b32 v24, a130
  v_accvgpr_read_b32 v25, a131
  v_mul_f32 v24, v24, v29
  v_mul_f32 v25, v25, v29
  v_accvgpr_write_b32 a130, v24
  v_accvgpr_write_b32 a131, v25
  v_accvgpr_read_b32 v24, a132
  v_accvgpr_read_b32 v25, a133
  v_mul_f32 v24, v24, v29
  v_mul_f32 v25, v25, v29
  v_accvgpr_write_b32 a132, v24
  v_accvgpr_write_b32 a133, v25
  v_accvgpr_read_b32 v24, a134
  v_accvgpr_read_b32 v25, a135
  v_mul_f32 v24, v24, v29
  v_mul_f32 v25, v25, v29
  v_accvgpr_write_b32 a134, v24
  v_accvgpr_write_b32 a135, v25
  v_accvgpr_read_b32 v24, a136
  v_accvgpr_read_b32 v25, a137
  v_mul_f32 v24, v24, v29
  v_mul_f32 v25, v25, v29
  v_accvgpr_write_b32 a136, v24
  v_accvgpr_write_b32 a137, v25
  v_accvgpr_read_b32 v24, a138
  v_accvgpr_read_b32 v25, a139
  v_mul_f32 v24, v24, v29
  v_mul_f32 v25, v25, v29
  v_accvgpr_write_b32 a138, v24
  v_accvgpr_write_b32 a139, v25
  v_accvgpr_read_b32 v24, a140
  v_accvgpr_read_b32 v25, a141
  v_mul_f32 v24, v24, v29
  v_mul_f32 v25, v25, v29
  v_accvgpr_write_b32 a140, v24
  v_accvgpr_write_b32 a141, v25
  v_accvgpr_read_b32 v24, a142
  v_accvgpr_read_b32 v25, a143
  v_mul_f32 v24, v24, v29
  v_mul_f32 v25, v25, v29
  v_accvgpr_write_b32 a142, v24
  v_accvgpr_write_b32 a143, v25
  v_accvgpr_read_b32 v24, a144
  v_accvgpr_read_b32 v25, a145
  v_mul_f32 v24, v24, v29
  v_mul_f32 v25, v25, v29
  v_accvgpr_write_b32 a144, v24
  v_accvgpr_write_b32 a145, v25
  v_accvgpr_read_b32 v24, a146
  v_accvgpr_read_b32 v25, a147
  v_mul_f32 v24, v24, v29
  v_mul_f32 v25, v25, v29
  v_accvgpr_write_b32 a146, v24
  v_accvgpr_write_b32 a147, v25
  v_accvgpr_read_b32 v24, a148
  v_accvgpr_read_b32 v25, a149
  v_mul_f32 v24, v24, v29
  v_mul_f32 v25, v25, v29
  v_accvgpr_write_b32 a148, v24
  v_accvgpr_write_b32 a149, v25
  v_accvgpr_read_b32 v24, a150
  v_accvgpr_read_b32 v25, a151
  v_mul_f32 v24, v24, v29
  v_mul_f32 v25, v25, v29
  v_accvgpr_write_b32 a150, v24
  v_accvgpr_write_b32 a151, v25
  v_accvgpr_read_b32 v24, a152
  v_accvgpr_read_b32 v25, a153
  v_mul_f32 v24, v24, v29
  v_mul_f32 v25, v25, v29
  v_accvgpr_write_b32 a152, v24
  v_accvgpr_write_b32 a153, v25
  v_accvgpr_read_b32 v24, a154
  v_accvgpr_read_b32 v25, a155
  v_mul_f32 v24, v24, v29
  v_mul_f32 v25, v25, v29
  v_accvgpr_write_b32 a154, v24
  v_accvgpr_write_b32 a155, v25
  v_accvgpr_read_b32 v24, a156
  v_accvgpr_read_b32 v25, a157
  v_mul_f32 v24, v24, v29
  v_mul_f32 v25, v25, v29
  v_accvgpr_write_b32 a156, v24
  v_accvgpr_write_b32 a157, v25
  v_accvgpr_read_b32 v24, a158
  v_accvgpr_read_b32 v25, a159
  v_mul_f32 v24, v24, v29
  v_mul_f32 v25, v25, v29
  v_accvgpr_write_b32 a158, v24
  v_accvgpr_write_b32 a159, v25
  v_accvgpr_read_b32 v24, a160
  v_accvgpr_read_b32 v25, a161
  v_mul_f32 v24, v24, v29
  v_mul_f32 v25, v25, v29
  v_accvgpr_write_b32 a160, v24
  v_accvgpr_write_b32 a161, v25
  v_accvgpr_read_b32 v24, a162
  v_accvgpr_read_b32 v25, a163
  v_mul_f32 v24, v24, v29
  v_mul_f32 v25, v25, v29
  v_accvgpr_write_b32 a162, v24
  v_accvgpr_write_b32 a163, v25
  v_accvgpr_read_b32 v24, a164
  v_accvgpr_read_b32 v25, a165
  v_mul_f32 v24, v24, v29
  v_mul_f32 v25, v25, v29
  v_accvgpr_write_b32 a164, v24
  v_accvgpr_write_b32 a165, v25
  v_accvgpr_read_b32 v24, a166
  v_accvgpr_read_b32 v25, a167
  v_mul_f32 v24, v24, v29
  v_mul_f32 v25, v25, v29
  v_accvgpr_write_b32 a166, v24
  v_accvgpr_write_b32 a167, v25
  v_accvgpr_read_b32 v24, a168
  v_accvgpr_read_b32 v25, a169
  v_mul_f32 v24, v24, v29
  v_mul_f32 v25, v25, v29
  v_accvgpr_write_b32 a168, v24
  v_accvgpr_write_b32 a169, v25
  v_accvgpr_read_b32 v24, a170
  v_accvgpr_read_b32 v25, a171
  v_mul_f32 v24, v24, v29
  v_mul_f32 v25, v25, v29
  v_accvgpr_write_b32 a170, v24
  v_accvgpr_write_b32 a171, v25
  v_accvgpr_read_b32 v24, a172
  v_accvgpr_read_b32 v25, a173
  v_mul_f32 v24, v24, v29
  v_mul_f32 v25, v25, v29
  v_accvgpr_write_b32 a172, v24
  v_accvgpr_write_b32 a173, v25
  v_accvgpr_read_b32 v24, a174
  v_accvgpr_read_b32 v25, a175
  v_mul_f32 v24, v24, v29
  v_mul_f32 v25, v25, v29
  v_accvgpr_write_b32 a174, v24
  v_accvgpr_write_b32 a175, v25
  v_accvgpr_read_b32 v24, a176
  v_accvgpr_read_b32 v25, a177
  v_mul_f32 v24, v24, v29
  v_mul_f32 v25, v25, v29
  v_accvgpr_write_b32 a176, v24
  v_accvgpr_write_b32 a177, v25
  v_accvgpr_read_b32 v24, a178
  v_accvgpr_read_b32 v25, a179
  v_mul_f32 v24, v24, v29
  v_mul_f32 v25, v25, v29
  v_accvgpr_write_b32 a178, v24
  v_accvgpr_write_b32 a179, v25
  v_accvgpr_read_b32 v24, a180
  v_accvgpr_read_b32 v25, a181
  v_mul_f32 v24, v24, v29
  v_mul_f32 v25, v25, v29
  v_accvgpr_write_b32 a180, v24
  v_accvgpr_write_b32 a181, v25
  v_accvgpr_read_b32 v24, a182
  v_accvgpr_read_b32 v25, a183
  v_mul_f32 v24, v24, v29
  v_mul_f32 v25, v25, v29
  v_accvgpr_write_b32 a182, v24
  v_accvgpr_write_b32 a183, v25
  v_accvgpr_read_b32 v24, a184
  v_accvgpr_read_b32 v25, a185
  v_mul_f32 v24, v24, v29
  v_mul_f32 v25, v25, v29
  v_accvgpr_write_b32 a184, v24
  v_accvgpr_write_b32 a185, v25
  v_accvgpr_read_b32 v24, a186
  v_accvgpr_read_b32 v25, a187
  v_mul_f32 v24, v24, v29
  v_mul_f32 v25, v25, v29
  v_accvgpr_write_b32 a186, v24
  v_accvgpr_write_b32 a187, v25
  v_accvgpr_read_b32 v24, a188
  v_accvgpr_read_b32 v25, a189
  v_mul_f32 v24, v24, v29
  v_mul_f32 v25, v25, v29
  v_accvgpr_write_b32 a188, v24
  v_accvgpr_write_b32 a189, v25
  v_accvgpr_read_b32 v24, a190
  v_accvgpr_read_b32 v25, a191
  v_mul_f32 v24, v24, v29
  v_mul_f32 v25, v25, v29
  v_accvgpr_write_b32 a190, v24
  v_accvgpr_write_b32 a191, v25
  v_accvgpr_read_b32 v24, a192
  v_accvgpr_read_b32 v25, a193
  v_mul_f32 v24, v24, v29
  v_mul_f32 v25, v25, v29
  v_accvgpr_write_b32 a192, v24
  v_accvgpr_write_b32 a193, v25
  v_accvgpr_read_b32 v24, a194
  v_accvgpr_read_b32 v25, a195
  v_mul_f32 v24, v24, v29
  v_mul_f32 v25, v25, v29
  v_accvgpr_write_b32 a194, v24
  v_accvgpr_write_b32 a195, v25
  v_accvgpr_read_b32 v24, a196
  v_accvgpr_read_b32 v25, a197
  v_mul_f32 v24, v24, v29
  v_mul_f32 v25, v25, v29
  v_accvgpr_write_b32 a196, v24
  v_accvgpr_write_b32 a197, v25
  v_accvgpr_read_b32 v24, a198
  v_accvgpr_read_b32 v25, a199
  v_mul_f32 v24, v24, v29
  v_mul_f32 v25, v25, v29
  v_accvgpr_write_b32 a198, v24
  v_accvgpr_write_b32 a199, v25
  v_accvgpr_read_b32 v24, a200
  v_accvgpr_read_b32 v25, a201
  v_mul_f32 v24, v24, v29
  v_mul_f32 v25, v25, v29
  v_accvgpr_write_b32 a200, v24
  v_accvgpr_write_b32 a201, v25
  v_accvgpr_read_b32 v24, a202
  v_accvgpr_read_b32 v25, a203
  v_mul_f32 v24, v24, v29
  v_mul_f32 v25, v25, v29
  v_accvgpr_write_b32 a202, v24
  v_accvgpr_write_b32 a203, v25
  v_accvgpr_read_b32 v24, a204
  v_accvgpr_read_b32 v25, a205
  v_mul_f32 v24, v24, v29
  v_mul_f32 v25, v25, v29
  v_accvgpr_write_b32 a204, v24
  v_accvgpr_write_b32 a205, v25
  v_accvgpr_read_b32 v24, a206
  v_accvgpr_read_b32 v25, a207
  v_mul_f32 v24, v24, v29
  v_mul_f32 v25, v25, v29
  v_accvgpr_write_b32 a206, v24
  v_accvgpr_write_b32 a207, v25
  v_accvgpr_read_b32 v24, a208
  v_accvgpr_read_b32 v25, a209
  v_mul_f32 v24, v24, v29
  v_mul_f32 v25, v25, v29
  v_accvgpr_write_b32 a208, v24
  v_accvgpr_write_b32 a209, v25
  v_accvgpr_read_b32 v24, a210
  v_accvgpr_read_b32 v25, a211
  v_mul_f32 v24, v24, v29
  v_mul_f32 v25, v25, v29
  v_accvgpr_write_b32 a210, v24
  v_accvgpr_write_b32 a211, v25
  v_accvgpr_read_b32 v24, a212
  v_accvgpr_read_b32 v25, a213
  v_mul_f32 v24, v24, v29
  v_mul_f32 v25, v25, v29
  v_accvgpr_write_b32 a212, v24
  v_accvgpr_write_b32 a213, v25
  v_accvgpr_read_b32 v24, a214
  v_accvgpr_read_b32 v25, a215
  v_mul_f32 v24, v24, v29
  v_mul_f32 v25, v25, v29
  v_accvgpr_write_b32 a214, v24
  v_accvgpr_write_b32 a215, v25
  v_accvgpr_read_b32 v24, a216
  v_accvgpr_read_b32 v25, a217
  v_mul_f32 v24, v24, v29
  v_mul_f32 v25, v25, v29
  v_accvgpr_write_b32 a216, v24
  v_accvgpr_write_b32 a217, v25
  v_accvgpr_read_b32 v24, a218
  v_accvgpr_read_b32 v25, a219
  v_mul_f32 v24, v24, v29
  v_mul_f32 v25, v25, v29
  v_accvgpr_write_b32 a218, v24
  v_accvgpr_write_b32 a219, v25
  v_accvgpr_read_b32 v24, a220
  v_accvgpr_read_b32 v25, a221
  v_mul_f32 v24, v24, v29
  v_mul_f32 v25, v25, v29
  v_accvgpr_write_b32 a220, v24
  v_accvgpr_write_b32 a221, v25
  v_accvgpr_read_b32 v24, a222
  v_accvgpr_read_b32 v25, a223
  v_mul_f32 v24, v24, v29
  v_mul_f32 v25, v25, v29
  v_accvgpr_write_b32 a222, v24
  v_accvgpr_write_b32 a223, v25
  v_accvgpr_read_b32 v24, a224
  v_accvgpr_read_b32 v25, a225
  v_mul_f32 v24, v24, v29
  v_mul_f32 v25, v25, v29
  v_accvgpr_write_b32 a224, v24
  v_accvgpr_write_b32 a225, v25
  v_accvgpr_read_b32 v24, a226
  v_accvgpr_read_b32 v25, a227
  v_mul_f32 v24, v24, v29
  v_mul_f32 v25, v25, v29
  v_accvgpr_write_b32 a226, v24
  v_accvgpr_write_b32 a227, v25
  v_accvgpr_read_b32 v24, a228
  v_accvgpr_read_b32 v25, a229
  v_mul_f32 v24, v24, v29
  v_mul_f32 v25, v25, v29
  v_accvgpr_write_b32 a228, v24
  v_accvgpr_write_b32 a229, v25
  v_accvgpr_read_b32 v24, a230
  v_accvgpr_read_b32 v25, a231
  v_mul_f32 v24, v24, v29
  v_mul_f32 v25, v25, v29
  v_accvgpr_write_b32 a230, v24
  v_accvgpr_write_b32 a231, v25
  v_accvgpr_read_b32 v24, a232
  v_accvgpr_read_b32 v25, a233
  v_mul_f32 v24, v24, v29
  v_mul_f32 v25, v25, v29
  v_accvgpr_write_b32 a232, v24
  v_accvgpr_write_b32 a233, v25
  v_accvgpr_read_b32 v24, a234
  v_accvgpr_read_b32 v25, a235
  v_mul_f32 v24, v24, v29
  v_mul_f32 v25, v25, v29
  v_accvgpr_write_b32 a234, v24
  v_accvgpr_write_b32 a235, v25
  v_accvgpr_read_b32 v24, a236
  v_accvgpr_read_b32 v25, a237
  v_mul_f32 v24, v24, v29
  v_mul_f32 v25, v25, v29
  v_accvgpr_write_b32 a236, v24
  v_accvgpr_write_b32 a237, v25
  v_accvgpr_read_b32 v24, a238
  v_accvgpr_read_b32 v25, a239
  v_mul_f32 v24, v24, v29
  v_mul_f32 v25, v25, v29
  v_accvgpr_write_b32 a238, v24
  v_accvgpr_write_b32 a239, v25
  v_accvgpr_read_b32 v24, a240
  v_accvgpr_read_b32 v25, a241
  v_mul_f32 v24, v24, v29
  v_mul_f32 v25, v25, v29
  v_accvgpr_write_b32 a240, v24
  v_accvgpr_write_b32 a241, v25
  v_accvgpr_read_b32 v24, a242
  v_accvgpr_read_b32 v25, a243
  v_mul_f32 v24, v24, v29
  v_mul_f32 v25, v25, v29
  v_accvgpr_write_b32 a242, v24
  v_accvgpr_write_b32 a243, v25
  v_accvgpr_read_b32 v24, a244
  v_accvgpr_read_b32 v25, a245
  v_mul_f32 v24, v24, v29
  v_mul_f32 v25, v25, v29
  v_accvgpr_write_b32 a244, v24
  v_accvgpr_write_b32 a245, v25
  v_accvgpr_read_b32 v24, a246
  v_accvgpr_read_b32 v25, a247
  v_mul_f32 v24, v24, v29
  v_mul_f32 v25, v25, v29
  v_accvgpr_write_b32 a246, v24
  v_accvgpr_write_b32 a247, v25
  v_accvgpr_read_b32 v24, a248
  v_accvgpr_read_b32 v25, a249
  v_mul_f32 v24, v24, v29
  v_mul_f32 v25, v25, v29
  v_accvgpr_write_b32 a248, v24
  v_accvgpr_write_b32 a249, v25
  v_accvgpr_read_b32 v24, a250
  v_accvgpr_read_b32 v25, a251
  v_mul_f32 v24, v24, v29
  v_mul_f32 v25, v25, v29
  v_accvgpr_write_b32 a250, v24
  v_accvgpr_write_b32 a251, v25
  v_accvgpr_read_b32 v24, a252
  v_accvgpr_read_b32 v25, a253
  v_mul_f32 v24, v24, v29
  v_mul_f32 v25, v25, v29
  v_accvgpr_write_b32 a252, v24
  v_accvgpr_write_b32 a253, v25
  v_accvgpr_read_b32 v24, a254
  v_accvgpr_read_b32 v25, a255
  v_mul_f32 v24, v24, v29
  v_mul_f32 v25, v25, v29
  v_accvgpr_write_b32 a254, v24
  v_accvgpr_write_b32 a255, v25
  s_nop 1
  v_exp_f32 v72, v80
  s_nop 1
  v_exp_f32 v24, v81
  s_nop 1
  v_add_f32 v31, v72, v24
  s_nop 1
  v_cvt_pk_bf16_f32 v72, v72, v24
  s_nop 1
  v_exp_f32 v73, v82
  s_nop 1
  v_add_f32 v31, v31, v73
  s_nop 1
  v_exp_f32 v25, v83
  s_nop 1
  v_add_f32 v31, v31, v25
  s_nop 1
  v_cvt_pk_bf16_f32 v73, v73, v25
  s_nop 1
  v_exp_f32 v76, v84
  s_nop 1
  v_add_f32 v31, v31, v76
  s_nop 1
  v_exp_f32 v24, v85
  s_nop 1
  v_add_f32 v31, v31, v24
  s_nop 1
  v_cvt_pk_bf16_f32 v76, v76, v24
  s_nop 1
  v_exp_f32 v77, v86
  s_nop 1
  v_add_f32 v31, v31, v77
  s_nop 1
  v_exp_f32 v25, v87
  s_nop 1
  v_add_f32 v31, v31, v25
  s_nop 1
  v_cvt_pk_bf16_f32 v77, v77, v25
  s_nop 1
  v_exp_f32 v74, v88
  s_nop 1
  v_exp_f32 v24, v89
  s_nop 1
  v_add_f32 v0, v74, v24
  s_nop 1
  v_cvt_pk_bf16_f32 v74, v74, v24
  s_nop 1
  v_permlane16_swap_b32 v72, v74
  s_nop 1
  v_exp_f32 v75, v90
  s_nop 1
  v_add_f32 v0, v0, v75
  s_nop 1
  v_exp_f32 v25, v91
  s_nop 1
  v_add_f32 v0, v0, v25
  s_nop 1
  v_cvt_pk_bf16_f32 v75, v75, v25
  s_nop 1
  v_permlane16_swap_b32 v73, v75
  s_nop 1
  v_exp_f32 v78, v92
  s_nop 1
  v_add_f32 v0, v0, v78
  s_nop 1
  v_exp_f32 v24, v93
  s_nop 1
  v_add_f32 v0, v0, v24
  s_nop 1
  v_cvt_pk_bf16_f32 v78, v78, v24
  s_nop 1
  v_permlane16_swap_b32 v76, v78
  s_nop 1
  v_exp_f32 v79, v94
  s_nop 1
  v_add_f32 v0, v0, v79
  s_nop 1
  v_exp_f32 v25, v95
  s_nop 1
  v_add_f32 v0, v0, v25
  s_nop 1
  v_cvt_pk_bf16_f32 v79, v79, v25
  s_nop 1
  v_permlane16_swap_b32 v77, v79
  s_nop 3
  s_branch RET10
RARE11:
  s_nop 7
  s_nop 7
  v_max3_f32 v29, v112, v113, 0
  v_max3_f32 v29, v29, v114, v115
  v_max3_f32 v29, v29, v116, v117
  v_max3_f32 v29, v29, v118, v119
  v_mov_b32 v30, v29
  s_nop 1
  v_permlane32_swap_b32 v29, v30
  s_nop 1
  v_max_f32 v29, v29, v30
  v_mov_b32 v30, v29
  s_nop 1
  v_permlane16_swap_b32 v29, v30
  s_nop 1
  v_max_f32 v29, v29, v30
  v_add_f32 v10, v10, v29
  v_sub_f32 v112, v112, v29
  v_sub_f32 v113, v113, v29
  v_sub_f32 v114, v114, v29
  v_sub_f32 v115, v115, v29
  v_sub_f32 v116, v116, v29
  v_sub_f32 v117, v117, v29
  v_sub_f32 v118, v118, v29
  v_sub_f32 v119, v119, v29
  v_sub_f32 v31, 0, v29
  v_exp_f32 v31, v31
  s_nop 1
  v_mul_f32 v26, v26, v31
  v_max3_f32 v29, v120, v121, 0
  v_max3_f32 v29, v29, v122, v123
  v_max3_f32 v29, v29, v124, v125
  v_max3_f32 v29, v29, v126, v127
  v_mov_b32 v30, v29
  s_nop 1
  v_permlane32_swap_b32 v29, v30
  s_nop 1
  v_max_f32 v29, v29, v30
  v_mov_b32 v30, v29
  s_nop 1
  v_permlane16_swap_b32 v29, v30
  s_nop 1
  v_max_f32 v29, v29, v30
  v_add_f32 v11, v11, v29
  v_sub_f32 v120, v120, v29
  v_sub_f32 v121, v121, v29
  v_sub_f32 v122, v122, v29
  v_sub_f32 v123, v123, v29
  v_sub_f32 v124, v124, v29
  v_sub_f32 v125, v125, v29
  v_sub_f32 v126, v126, v29
  v_sub_f32 v127, v127, v29
  v_sub_f32 v0, 0, v29
  v_exp_f32 v0, v0
  s_nop 1
  v_mul_f32 v27, v27, v0
  v_cndmask_b32 v29, v31, v0, s[96:97]
  s_nop 1
  v_mov_b32 v28, v29
  s_mov_b32 s26, 1
  s_nop 1
  v_exp_f32 v64, v112
  s_nop 1
  v_exp_f32 v24, v113
  s_nop 1
  v_add_f32 v31, v64, v24
  s_nop 1
  v_cvt_pk_bf16_f32 v64, v64, v24
  s_nop 1
  v_exp_f32 v65, v114
  s_nop 1
  v_add_f32 v31, v31, v65
  s_nop 1
  v_exp_f32 v25, v115
  s_nop 1
  v_add_f32 v31, v31, v25
  s_nop 1
  v_cvt_pk_bf16_f32 v65, v65, v25
  s_nop 1
  v_exp_f32 v68, v116
  s_nop 1
  v_add_f32 v31, v31, v68
  s_nop 1
  v_exp_f32 v24, v117
  s_nop 1
  v_add_f32 v31, v31, v24
  s_nop 1
  v_cvt_pk_bf16_f32 v68, v68, v24
  s_nop 1
  v_exp_f32 v69, v118
  s_nop 1
  v_add_f32 v31, v31, v69
  s_nop 1
  v_exp_f32 v25, v119
  s_nop 1
  v_add_f32 v31, v31, v25
  s_nop 1
  v_cvt_pk_bf16_f32 v69, v69, v25
  s_nop 1
  v_exp_f32 v66, v120
  s_nop 1
  v_exp_f32 v24, v121
  s_nop 1
  v_add_f32 v0, v66, v24
  s_nop 1
  v_cvt_pk_bf16_f32 v66, v66, v24
  s_nop 1
  v_permlane16_swap_b32 v64, v66
  s_nop 1
  v_exp_f32 v67, v122
  s_nop 1
  v_add_f32 v0, v0, v67
  s_nop 1
  v_exp_f32 v25, v123
  s_nop 1
  v_add_f32 v0, v0, v25
  s_nop 1
  v_cvt_pk_bf16_f32 v67, v67, v25
  s_nop 1
  v_permlane16_swap_b32 v65, v67
  s_nop 1
  v_exp_f32 v70, v124
  s_nop 1
  v_add_f32 v0, v0, v70
  s_nop 1
  v_exp_f32 v24, v125
  s_nop 1
  v_add_f32 v0, v0, v24
  s_nop 1
  v_cvt_pk_bf16_f32 v70, v70, v24
  s_nop 1
  v_permlane16_swap_b32 v68, v70
  s_nop 1
  v_exp_f32 v71, v126
  s_nop 1
  v_add_f32 v0, v0, v71
  s_nop 1
  v_exp_f32 v25, v127
  s_nop 1
  v_add_f32 v0, v0, v25
  s_nop 1
  v_cvt_pk_bf16_f32 v71, v71, v25
  s_nop 1
  v_permlane16_swap_b32 v69, v71
  s_nop 3
  s_branch RET11
RARE12:
  s_nop 7
  s_nop 7
  v_mul_f32 v128, v128, v28
  v_mul_f32 v129, v129, v28
  v_mul_f32 v130, v130, v28
  v_mul_f32 v131, v131, v28
  v_mul_f32 v132, v132, v28
  v_mul_f32 v133, v133, v28
  v_mul_f32 v134, v134, v28
  v_mul_f32 v135, v135, v28
  v_mul_f32 v136, v136, v28
  v_mul_f32 v137, v137, v28
  v_mul_f32 v138, v138, v28
  v_mul_f32 v139, v139, v28
  v_mul_f32 v140, v140, v28
  v_mul_f32 v141, v141, v28
  v_mul_f32 v142, v142, v28
  v_mul_f32 v143, v143, v28
  v_mul_f32 v144, v144, v28
  v_mul_f32 v145, v145, v28
  v_mul_f32 v146, v146, v28
  v_mul_f32 v147, v147, v28
  v_mul_f32 v148, v148, v28
  v_mul_f32 v149, v149, v28
  v_mul_f32 v150, v150, v28
  v_mul_f32 v151, v151, v28
  v_mul_f32 v152, v152, v28
  v_mul_f32 v153, v153, v28
  v_mul_f32 v154, v154, v28
  v_mul_f32 v155, v155, v28
  v_mul_f32 v156, v156, v28
  v_mul_f32 v157, v157, v28
  v_mul_f32 v158, v158, v28
  v_mul_f32 v159, v159, v28
  v_mul_f32 v160, v160, v28
  v_mul_f32 v161, v161, v28
  v_mul_f32 v162, v162, v28
  v_mul_f32 v163, v163, v28
  v_mul_f32 v164, v164, v28
  v_mul_f32 v165, v165, v28
  v_mul_f32 v166, v166, v28
  v_mul_f32 v167, v167, v28
  v_mul_f32 v168, v168, v28
  v_mul_f32 v169, v169, v28
  v_mul_f32 v170, v170, v28
  v_mul_f32 v171, v171, v28
  v_mul_f32 v172, v172, v28
  v_mul_f32 v173, v173, v28
  v_mul_f32 v174, v174, v28
  v_mul_f32 v175, v175, v28
  v_mul_f32 v176, v176, v28
  v_mul_f32 v177, v177, v28
  v_mul_f32 v178, v178, v28
  v_mul_f32 v179, v179, v28
  v_mul_f32 v180, v180, v28
  v_mul_f32 v181, v181, v28
  v_mul_f32 v182, v182, v28
  v_mul_f32 v183, v183, v28
  v_mul_f32 v184, v184, v28
  v_mul_f32 v185, v185, v28
  v_mul_f32 v186, v186, v28
  v_mul_f32 v187, v187, v28
  v_mul_f32 v188, v188, v28
  v_mul_f32 v189, v189, v28
  v_mul_f32 v190, v190, v28
  v_mul_f32 v191, v191, v28
  v_mul_f32 v192, v192, v28
  v_mul_f32 v193, v193, v28
  v_mul_f32 v194, v194, v28
  v_mul_f32 v195, v195, v28
  v_mul_f32 v196, v196, v28
  v_mul_f32 v197, v197, v28
  v_mul_f32 v198, v198, v28
  v_mul_f32 v199, v199, v28
  v_mul_f32 v200, v200, v28
  v_mul_f32 v201, v201, v28
  v_mul_f32 v202, v202, v28
  v_mul_f32 v203, v203, v28
  v_mul_f32 v204, v204, v28
  v_mul_f32 v205, v205, v28
  v_mul_f32 v206, v206, v28
  v_mul_f32 v207, v207, v28
  v_mul_f32 v208, v208, v28
  v_mul_f32 v209, v209, v28
  v_mul_f32 v210, v210, v28
  v_mul_f32 v211, v211, v28
  v_mul_f32 v212, v212, v28
  v_mul_f32 v213, v213, v28
  v_mul_f32 v214, v214, v28
  v_mul_f32 v215, v215, v28
  v_mul_f32 v216, v216, v28
  v_mul_f32 v217, v217, v28
  v_mul_f32 v218, v218, v28
  v_mul_f32 v219, v219, v28
  v_mul_f32 v220, v220, v28
  v_mul_f32 v221, v221, v28
  v_mul_f32 v222, v222, v28
  v_mul_f32 v223, v223, v28
  v_mul_f32 v224, v224, v28
  v_mul_f32 v225, v225, v28
  v_mul_f32 v226, v226, v28
  v_mul_f32 v227, v227, v28
  v_mul_f32 v228, v228, v28
  v_mul_f32 v229, v229, v28
  v_mul_f32 v230, v230, v28
  v_mul_f32 v231, v231, v28
  v_mul_f32 v232, v232, v28
  v_mul_f32 v233, v233, v28
  v_mul_f32 v234, v234, v28
  v_mul_f32 v235, v235, v28
  v_mul_f32 v236, v236, v28
  v_mul_f32 v237, v237, v28
  v_mul_f32 v238, v238, v28
  v_mul_f32 v239, v239, v28
  v_mul_f32 v240, v240, v28
  v_mul_f32 v241, v241, v28
  v_mul_f32 v242, v242, v28
  v_mul_f32 v243, v243, v28
  v_mul_f32 v244, v244, v28
  v_mul_f32 v245, v245, v28
  v_mul_f32 v246, v246, v28
  v_mul_f32 v247, v247, v28
  v_mul_f32 v248, v248, v28
  v_mul_f32 v249, v249, v28
  v_mul_f32 v250, v250, v28
  v_mul_f32 v251, v251, v28
  v_mul_f32 v252, v252, v28
  v_mul_f32 v253, v253, v28
  v_mul_f32 v254, v254, v28
  v_mul_f32 v255, v255, v28
  s_mov_b32 s26, 0
  s_nop 3
  s_branch RET12
RARE13:
  s_nop 7
  s_nop 7
  v_max3_f32 v29, v96, v97, 0
  v_max3_f32 v29, v29, v98, v99
  v_max3_f32 v29, v29, v100, v101
  v_max3_f32 v29, v29, v102, v103
  v_mov_b32 v30, v29
  s_nop 1
  v_permlane32_swap_b32 v29, v30
  s_nop 1
  v_max_f32 v29, v29, v30
  v_mov_b32 v30, v29
  s_nop 1
  v_permlane16_swap_b32 v29, v30
  s_nop 1
  v_max_f32 v29, v29, v30
  v_add_f32 v12, v12, v29
  v_sub_f32 v96, v96, v29
  v_sub_f32 v97, v97, v29
  v_sub_f32 v98, v98, v29
  v_sub_f32 v99, v99, v29
  v_sub_f32 v100, v100, v29
  v_sub_f32 v101, v101, v29
  v_sub_f32 v102, v102, v29
  v_sub_f32 v103, v103, v29
  v_sub_f32 v31, 0, v29
  v_exp_f32 v31, v31
  s_nop 1
  v_mul_f32 v22, v22, v31
  v_max3_f32 v29, v104, v105, 0
  v_max3_f32 v29, v29, v106, v107
  v_max3_f32 v29, v29, v108, v109
  v_max3_f32 v29, v29, v110, v111
  v_mov_b32 v30, v29
  s_nop 1
  v_permlane32_swap_b32 v29, v30
  s_nop 1
  v_max_f32 v29, v29, v30
  v_mov_b32 v30, v29
  s_nop 1
  v_permlane16_swap_b32 v29, v30
  s_nop 1
  v_max_f32 v29, v29, v30
  v_add_f32 v13, v13, v29
  v_sub_f32 v104, v104, v29
  v_sub_f32 v105, v105, v29
  v_sub_f32 v106, v106, v29
  v_sub_f32 v107, v107, v29
  v_sub_f32 v108, v108, v29
  v_sub_f32 v109, v109, v29
  v_sub_f32 v110, v110, v29
  v_sub_f32 v111, v111, v29
  v_sub_f32 v0, 0, v29
  v_exp_f32 v0, v0
  s_nop 1
  v_mul_f32 v23, v23, v0
  v_cndmask_b32 v29, v31, v0, s[96:97]
  s_nop 1
  v_accvgpr_read_b32 v24, a128
  v_accvgpr_read_b32 v25, a129
  v_mul_f32 v24, v24, v29
  v_mul_f32 v25, v25, v29
  v_accvgpr_write_b32 a128, v24
  v_accvgpr_write_b32 a129, v25
  v_accvgpr_read_b32 v24, a130
  v_accvgpr_read_b32 v25, a131
  v_mul_f32 v24, v24, v29
  v_mul_f32 v25, v25, v29
  v_accvgpr_write_b32 a130, v24
  v_accvgpr_write_b32 a131, v25
  v_accvgpr_read_b32 v24, a132
  v_accvgpr_read_b32 v25, a133
  v_mul_f32 v24, v24, v29
  v_mul_f32 v25, v25, v29
  v_accvgpr_write_b32 a132, v24
  v_accvgpr_write_b32 a133, v25
  v_accvgpr_read_b32 v24, a134
  v_accvgpr_read_b32 v25, a135
  v_mul_f32 v24, v24, v29
  v_mul_f32 v25, v25, v29
  v_accvgpr_write_b32 a134, v24
  v_accvgpr_write_b32 a135, v25
  v_accvgpr_read_b32 v24, a136
  v_accvgpr_read_b32 v25, a137
  v_mul_f32 v24, v24, v29
  v_mul_f32 v25, v25, v29
  v_accvgpr_write_b32 a136, v24
  v_accvgpr_write_b32 a137, v25
  v_accvgpr_read_b32 v24, a138
  v_accvgpr_read_b32 v25, a139
  v_mul_f32 v24, v24, v29
  v_mul_f32 v25, v25, v29
  v_accvgpr_write_b32 a138, v24
  v_accvgpr_write_b32 a139, v25
  v_accvgpr_read_b32 v24, a140
  v_accvgpr_read_b32 v25, a141
  v_mul_f32 v24, v24, v29
  v_mul_f32 v25, v25, v29
  v_accvgpr_write_b32 a140, v24
  v_accvgpr_write_b32 a141, v25
  v_accvgpr_read_b32 v24, a142
  v_accvgpr_read_b32 v25, a143
  v_mul_f32 v24, v24, v29
  v_mul_f32 v25, v25, v29
  v_accvgpr_write_b32 a142, v24
  v_accvgpr_write_b32 a143, v25
  v_accvgpr_read_b32 v24, a144
  v_accvgpr_read_b32 v25, a145
  v_mul_f32 v24, v24, v29
  v_mul_f32 v25, v25, v29
  v_accvgpr_write_b32 a144, v24
  v_accvgpr_write_b32 a145, v25
  v_accvgpr_read_b32 v24, a146
  v_accvgpr_read_b32 v25, a147
  v_mul_f32 v24, v24, v29
  v_mul_f32 v25, v25, v29
  v_accvgpr_write_b32 a146, v24
  v_accvgpr_write_b32 a147, v25
  v_accvgpr_read_b32 v24, a148
  v_accvgpr_read_b32 v25, a149
  v_mul_f32 v24, v24, v29
  v_mul_f32 v25, v25, v29
  v_accvgpr_write_b32 a148, v24
  v_accvgpr_write_b32 a149, v25
  v_accvgpr_read_b32 v24, a150
  v_accvgpr_read_b32 v25, a151
  v_mul_f32 v24, v24, v29
  v_mul_f32 v25, v25, v29
  v_accvgpr_write_b32 a150, v24
  v_accvgpr_write_b32 a151, v25
  v_accvgpr_read_b32 v24, a152
  v_accvgpr_read_b32 v25, a153
  v_mul_f32 v24, v24, v29
  v_mul_f32 v25, v25, v29
  v_accvgpr_write_b32 a152, v24
  v_accvgpr_write_b32 a153, v25
  v_accvgpr_read_b32 v24, a154
  v_accvgpr_read_b32 v25, a155
  v_mul_f32 v24, v24, v29
  v_mul_f32 v25, v25, v29
  v_accvgpr_write_b32 a154, v24
  v_accvgpr_write_b32 a155, v25
  v_accvgpr_read_b32 v24, a156
  v_accvgpr_read_b32 v25, a157
  v_mul_f32 v24, v24, v29
  v_mul_f32 v25, v25, v29
  v_accvgpr_write_b32 a156, v24
  v_accvgpr_write_b32 a157, v25
  v_accvgpr_read_b32 v24, a158
  v_accvgpr_read_b32 v25, a159
  v_mul_f32 v24, v24, v29
  v_mul_f32 v25, v25, v29
  v_accvgpr_write_b32 a158, v24
  v_accvgpr_write_b32 a159, v25
  v_accvgpr_read_b32 v24, a160
  v_accvgpr_read_b32 v25, a161
  v_mul_f32 v24, v24, v29
  v_mul_f32 v25, v25, v29
  v_accvgpr_write_b32 a160, v24
  v_accvgpr_write_b32 a161, v25
  v_accvgpr_read_b32 v24, a162
  v_accvgpr_read_b32 v25, a163
  v_mul_f32 v24, v24, v29
  v_mul_f32 v25, v25, v29
  v_accvgpr_write_b32 a162, v24
  v_accvgpr_write_b32 a163, v25
  v_accvgpr_read_b32 v24, a164
  v_accvgpr_read_b32 v25, a165
  v_mul_f32 v24, v24, v29
  v_mul_f32 v25, v25, v29
  v_accvgpr_write_b32 a164, v24
  v_accvgpr_write_b32 a165, v25
  v_accvgpr_read_b32 v24, a166
  v_accvgpr_read_b32 v25, a167
  v_mul_f32 v24, v24, v29
  v_mul_f32 v25, v25, v29
  v_accvgpr_write_b32 a166, v24
  v_accvgpr_write_b32 a167, v25
  v_accvgpr_read_b32 v24, a168
  v_accvgpr_read_b32 v25, a169
  v_mul_f32 v24, v24, v29
  v_mul_f32 v25, v25, v29
  v_accvgpr_write_b32 a168, v24
  v_accvgpr_write_b32 a169, v25
  v_accvgpr_read_b32 v24, a170
  v_accvgpr_read_b32 v25, a171
  v_mul_f32 v24, v24, v29
  v_mul_f32 v25, v25, v29
  v_accvgpr_write_b32 a170, v24
  v_accvgpr_write_b32 a171, v25
  v_accvgpr_read_b32 v24, a172
  v_accvgpr_read_b32 v25, a173
  v_mul_f32 v24, v24, v29
  v_mul_f32 v25, v25, v29
  v_accvgpr_write_b32 a172, v24
  v_accvgpr_write_b32 a173, v25
  v_accvgpr_read_b32 v24, a174
  v_accvgpr_read_b32 v25, a175
  v_mul_f32 v24, v24, v29
  v_mul_f32 v25, v25, v29
  v_accvgpr_write_b32 a174, v24
  v_accvgpr_write_b32 a175, v25
  v_accvgpr_read_b32 v24, a176
  v_accvgpr_read_b32 v25, a177
  v_mul_f32 v24, v24, v29
  v_mul_f32 v25, v25, v29
  v_accvgpr_write_b32 a176, v24
  v_accvgpr_write_b32 a177, v25
  v_accvgpr_read_b32 v24, a178
  v_accvgpr_read_b32 v25, a179
  v_mul_f32 v24, v24, v29
  v_mul_f32 v25, v25, v29
  v_accvgpr_write_b32 a178, v24
  v_accvgpr_write_b32 a179, v25
  v_accvgpr_read_b32 v24, a180
  v_accvgpr_read_b32 v25, a181
  v_mul_f32 v24, v24, v29
  v_mul_f32 v25, v25, v29
  v_accvgpr_write_b32 a180, v24
  v_accvgpr_write_b32 a181, v25
  v_accvgpr_read_b32 v24, a182
  v_accvgpr_read_b32 v25, a183
  v_mul_f32 v24, v24, v29
  v_mul_f32 v25, v25, v29
  v_accvgpr_write_b32 a182, v24
  v_accvgpr_write_b32 a183, v25
  v_accvgpr_read_b32 v24, a184
  v_accvgpr_read_b32 v25, a185
  v_mul_f32 v24, v24, v29
  v_mul_f32 v25, v25, v29
  v_accvgpr_write_b32 a184, v24
  v_accvgpr_write_b32 a185, v25
  v_accvgpr_read_b32 v24, a186
  v_accvgpr_read_b32 v25, a187
  v_mul_f32 v24, v24, v29
  v_mul_f32 v25, v25, v29
  v_accvgpr_write_b32 a186, v24
  v_accvgpr_write_b32 a187, v25
  v_accvgpr_read_b32 v24, a188
  v_accvgpr_read_b32 v25, a189
  v_mul_f32 v24, v24, v29
  v_mul_f32 v25, v25, v29
  v_accvgpr_write_b32 a188, v24
  v_accvgpr_write_b32 a189, v25
  v_accvgpr_read_b32 v24, a190
  v_accvgpr_read_b32 v25, a191
  v_mul_f32 v24, v24, v29
  v_mul_f32 v25, v25, v29
  v_accvgpr_write_b32 a190, v24
  v_accvgpr_write_b32 a191, v25
  v_accvgpr_read_b32 v24, a192
  v_accvgpr_read_b32 v25, a193
  v_mul_f32 v24, v24, v29
  v_mul_f32 v25, v25, v29
  v_accvgpr_write_b32 a192, v24
  v_accvgpr_write_b32 a193, v25
  v_accvgpr_read_b32 v24, a194
  v_accvgpr_read_b32 v25, a195
  v_mul_f32 v24, v24, v29
  v_mul_f32 v25, v25, v29
  v_accvgpr_write_b32 a194, v24
  v_accvgpr_write_b32 a195, v25
  v_accvgpr_read_b32 v24, a196
  v_accvgpr_read_b32 v25, a197
  v_mul_f32 v24, v24, v29
  v_mul_f32 v25, v25, v29
  v_accvgpr_write_b32 a196, v24
  v_accvgpr_write_b32 a197, v25
  v_accvgpr_read_b32 v24, a198
  v_accvgpr_read_b32 v25, a199
  v_mul_f32 v24, v24, v29
  v_mul_f32 v25, v25, v29
  v_accvgpr_write_b32 a198, v24
  v_accvgpr_write_b32 a199, v25
  v_accvgpr_read_b32 v24, a200
  v_accvgpr_read_b32 v25, a201
  v_mul_f32 v24, v24, v29
  v_mul_f32 v25, v25, v29
  v_accvgpr_write_b32 a200, v24
  v_accvgpr_write_b32 a201, v25
  v_accvgpr_read_b32 v24, a202
  v_accvgpr_read_b32 v25, a203
  v_mul_f32 v24, v24, v29
  v_mul_f32 v25, v25, v29
  v_accvgpr_write_b32 a202, v24
  v_accvgpr_write_b32 a203, v25
  v_accvgpr_read_b32 v24, a204
  v_accvgpr_read_b32 v25, a205
  v_mul_f32 v24, v24, v29
  v_mul_f32 v25, v25, v29
  v_accvgpr_write_b32 a204, v24
  v_accvgpr_write_b32 a205, v25
  v_accvgpr_read_b32 v24, a206
  v_accvgpr_read_b32 v25, a207
  v_mul_f32 v24, v24, v29
  v_mul_f32 v25, v25, v29
  v_accvgpr_write_b32 a206, v24
  v_accvgpr_write_b32 a207, v25
  v_accvgpr_read_b32 v24, a208
  v_accvgpr_read_b32 v25, a209
  v_mul_f32 v24, v24, v29
  v_mul_f32 v25, v25, v29
  v_accvgpr_write_b32 a208, v24
  v_accvgpr_write_b32 a209, v25
  v_accvgpr_read_b32 v24, a210
  v_accvgpr_read_b32 v25, a211
  v_mul_f32 v24, v24, v29
  v_mul_f32 v25, v25, v29
  v_accvgpr_write_b32 a210, v24
  v_accvgpr_write_b32 a211, v25
  v_accvgpr_read_b32 v24, a212
  v_accvgpr_read_b32 v25, a213
  v_mul_f32 v24, v24, v29
  v_mul_f32 v25, v25, v29
  v_accvgpr_write_b32 a212, v24
  v_accvgpr_write_b32 a213, v25
  v_accvgpr_read_b32 v24, a214
  v_accvgpr_read_b32 v25, a215
  v_mul_f32 v24, v24, v29
  v_mul_f32 v25, v25, v29
  v_accvgpr_write_b32 a214, v24
  v_accvgpr_write_b32 a215, v25
  v_accvgpr_read_b32 v24, a216
  v_accvgpr_read_b32 v25, a217
  v_mul_f32 v24, v24, v29
  v_mul_f32 v25, v25, v29
  v_accvgpr_write_b32 a216, v24
  v_accvgpr_write_b32 a217, v25
  v_accvgpr_read_b32 v24, a218
  v_accvgpr_read_b32 v25, a219
  v_mul_f32 v24, v24, v29
  v_mul_f32 v25, v25, v29
  v_accvgpr_write_b32 a218, v24
  v_accvgpr_write_b32 a219, v25
  v_accvgpr_read_b32 v24, a220
  v_accvgpr_read_b32 v25, a221
  v_mul_f32 v24, v24, v29
  v_mul_f32 v25, v25, v29
  v_accvgpr_write_b32 a220, v24
  v_accvgpr_write_b32 a221, v25
  v_accvgpr_read_b32 v24, a222
  v_accvgpr_read_b32 v25, a223
  v_mul_f32 v24, v24, v29
  v_mul_f32 v25, v25, v29
  v_accvgpr_write_b32 a222, v24
  v_accvgpr_write_b32 a223, v25
  v_accvgpr_read_b32 v24, a224
  v_accvgpr_read_b32 v25, a225
  v_mul_f32 v24, v24, v29
  v_mul_f32 v25, v25, v29
  v_accvgpr_write_b32 a224, v24
  v_accvgpr_write_b32 a225, v25
  v_accvgpr_read_b32 v24, a226
  v_accvgpr_read_b32 v25, a227
  v_mul_f32 v24, v24, v29
  v_mul_f32 v25, v25, v29
  v_accvgpr_write_b32 a226, v24
  v_accvgpr_write_b32 a227, v25
  v_accvgpr_read_b32 v24, a228
  v_accvgpr_read_b32 v25, a229
  v_mul_f32 v24, v24, v29
  v_mul_f32 v25, v25, v29
  v_accvgpr_write_b32 a228, v24
  v_accvgpr_write_b32 a229, v25
  v_accvgpr_read_b32 v24, a230
  v_accvgpr_read_b32 v25, a231
  v_mul_f32 v24, v24, v29
  v_mul_f32 v25, v25, v29
  v_accvgpr_write_b32 a230, v24
  v_accvgpr_write_b32 a231, v25
  v_accvgpr_read_b32 v24, a232
  v_accvgpr_read_b32 v25, a233
  v_mul_f32 v24, v24, v29
  v_mul_f32 v25, v25, v29
  v_accvgpr_write_b32 a232, v24
  v_accvgpr_write_b32 a233, v25
  v_accvgpr_read_b32 v24, a234
  v_accvgpr_read_b32 v25, a235
  v_mul_f32 v24, v24, v29
  v_mul_f32 v25, v25, v29
  v_accvgpr_write_b32 a234, v24
  v_accvgpr_write_b32 a235, v25
  v_accvgpr_read_b32 v24, a236
  v_accvgpr_read_b32 v25, a237
  v_mul_f32 v24, v24, v29
  v_mul_f32 v25, v25, v29
  v_accvgpr_write_b32 a236, v24
  v_accvgpr_write_b32 a237, v25
  v_accvgpr_read_b32 v24, a238
  v_accvgpr_read_b32 v25, a239
  v_mul_f32 v24, v24, v29
  v_mul_f32 v25, v25, v29
  v_accvgpr_write_b32 a238, v24
  v_accvgpr_write_b32 a239, v25
  v_accvgpr_read_b32 v24, a240
  v_accvgpr_read_b32 v25, a241
  v_mul_f32 v24, v24, v29
  v_mul_f32 v25, v25, v29
  v_accvgpr_write_b32 a240, v24
  v_accvgpr_write_b32 a241, v25
  v_accvgpr_read_b32 v24, a242
  v_accvgpr_read_b32 v25, a243
  v_mul_f32 v24, v24, v29
  v_mul_f32 v25, v25, v29
  v_accvgpr_write_b32 a242, v24
  v_accvgpr_write_b32 a243, v25
  v_accvgpr_read_b32 v24, a244
  v_accvgpr_read_b32 v25, a245
  v_mul_f32 v24, v24, v29
  v_mul_f32 v25, v25, v29
  v_accvgpr_write_b32 a244, v24
  v_accvgpr_write_b32 a245, v25
  v_accvgpr_read_b32 v24, a246
  v_accvgpr_read_b32 v25, a247
  v_mul_f32 v24, v24, v29
  v_mul_f32 v25, v25, v29
  v_accvgpr_write_b32 a246, v24
  v_accvgpr_write_b32 a247, v25
  v_accvgpr_read_b32 v24, a248
  v_accvgpr_read_b32 v25, a249
  v_mul_f32 v24, v24, v29
  v_mul_f32 v25, v25, v29
  v_accvgpr_write_b32 a248, v24
  v_accvgpr_write_b32 a249, v25
  v_accvgpr_read_b32 v24, a250
  v_accvgpr_read_b32 v25, a251
  v_mul_f32 v24, v24, v29
  v_mul_f32 v25, v25, v29
  v_accvgpr_write_b32 a250, v24
  v_accvgpr_write_b32 a251, v25
  v_accvgpr_read_b32 v24, a252
  v_accvgpr_read_b32 v25, a253
  v_mul_f32 v24, v24, v29
  v_mul_f32 v25, v25, v29
  v_accvgpr_write_b32 a252, v24
  v_accvgpr_write_b32 a253, v25
  v_accvgpr_read_b32 v24, a254
  v_accvgpr_read_b32 v25, a255
  v_mul_f32 v24, v24, v29
  v_mul_f32 v25, v25, v29
  v_accvgpr_write_b32 a254, v24
  v_accvgpr_write_b32 a255, v25
  s_nop 1
  v_exp_f32 v56, v96
  s_nop 1
  v_exp_f32 v24, v97
  s_nop 1
  v_add_f32 v31, v56, v24
  s_nop 1
  v_cvt_pk_bf16_f32 v56, v56, v24
  s_nop 1
  v_exp_f32 v57, v98
  s_nop 1
  v_add_f32 v31, v31, v57
  s_nop 1
  v_exp_f32 v25, v99
  s_nop 1
  v_add_f32 v31, v31, v25
  s_nop 1
  v_cvt_pk_bf16_f32 v57, v57, v25
  s_nop 1
  v_exp_f32 v60, v100
  s_nop 1
  v_add_f32 v31, v31, v60
  s_nop 1
  v_exp_f32 v24, v101
  s_nop 1
  v_add_f32 v31, v31, v24
  s_nop 1
  v_cvt_pk_bf16_f32 v60, v60, v24
  s_nop 1
  v_exp_f32 v61, v102
  s_nop 1
  v_add_f32 v31, v31, v61
  s_nop 1
  v_exp_f32 v25, v103
  s_nop 1
  v_add_f32 v31, v31, v25
  s_nop 1
  v_cvt_pk_bf16_f32 v61, v61, v25
  s_nop 1
  v_exp_f32 v58, v104
  s_nop 1
  v_exp_f32 v24, v105
  s_nop 1
  v_add_f32 v0, v58, v24
  s_nop 1
  v_cvt_pk_bf16_f32 v58, v58, v24
  s_nop 1
  v_permlane16_swap_b32 v56, v58
  s_nop 1
  v_exp_f32 v59, v106
  s_nop 1
  v_add_f32 v0, v0, v59
  s_nop 1
  v_exp_f32 v25, v107
  s_nop 1
  v_add_f32 v0, v0, v25
  s_nop 1
  v_cvt_pk_bf16_f32 v59, v59, v25
  s_nop 1
  v_permlane16_swap_b32 v57, v59
  s_nop 1
  v_exp_f32 v62, v108
  s_nop 1
  v_add_f32 v0, v0, v62
  s_nop 1
  v_exp_f32 v24, v109
  s_nop 1
  v_add_f32 v0, v0, v24
  s_nop 1
  v_cvt_pk_bf16_f32 v62, v62, v24
  s_nop 1
  v_permlane16_swap_b32 v60, v62
  s_nop 1
  v_exp_f32 v63, v110
  s_nop 1
  v_add_f32 v0, v0, v63
  s_nop 1
  v_exp_f32 v25, v111
  s_nop 1
  v_add_f32 v0, v0, v25
  s_nop 1
  v_cvt_pk_bf16_f32 v63, v63, v25
  s_nop 1
  v_permlane16_swap_b32 v61, v63
  s_nop 3
  s_branch RET13
RARE14:
  s_nop 7
  s_nop 7
  v_max3_f32 v29, v80, v81, 0
  v_max3_f32 v29, v29, v82, v83
  v_max3_f32 v29, v29, v84, v85
  v_max3_f32 v29, v29, v86, v87
  v_mov_b32 v30, v29
  s_nop 1
  v_permlane32_swap_b32 v29, v30
  s_nop 1
  v_max_f32 v29, v29, v30
  v_mov_b32 v30, v29
  s_nop 1
  v_permlane16_swap_b32 v29, v30
  s_nop 1
  v_max_f32 v29, v29, v30
  v_add_f32 v10, v10, v29
  v_sub_f32 v80, v80, v29
  v_sub_f32 v81, v81, v29
  v_sub_f32 v82, v82, v29
  v_sub_f32 v83, v83, v29
  v_sub_f32 v84, v84, v29
  v_sub_f32 v85, v85, v29
  v_sub_f32 v86, v86, v29
  v_sub_f32 v87, v87, v29
  v_sub_f32 v31, 0, v29
  v_exp_f32 v31, v31
  s_nop 1
  v_mul_f32 v26, v26, v31
  v_max3_f32 v29, v88, v89, 0
  v_max3_f32 v29, v29, v90, v91
  v_max3_f32 v29, v29, v92, v93
  v_max3_f32 v29, v29, v94, v95
  v_mov_b32 v30, v29
  s_nop 1
  v_permlane32_swap_b32 v29, v30
  s_nop 1
  v_max_f32 v29, v29, v30
  v_mov_b32 v30, v29
  s_nop 1
  v_permlane16_swap_b32 v29, v30
  s_nop 1
  v_max_f32 v29, v29, v30
  v_add_f32 v11, v11, v29
  v_sub_f32 v88, v88, v29
  v_sub_f32 v89, v89, v29
  v_sub_f32 v90, v90, v29
  v_sub_f32 v91, v91, v29
  v_sub_f32 v92, v92, v29
  v_sub_f32 v93, v93, v29
  v_sub_f32 v94, v94, v29
  v_sub_f32 v95, v95, v29
  v_sub_f32 v0, 0, v29
  v_exp_f32 v0, v0
  s_nop 1
  v_mul_f32 v27, v27, v0
  v_cndmask_b32 v29, v31, v0, s[96:97]
  s_nop 1
  v_mov_b32 v28, v29
  s_mov_b32 s26, 1
  s_nop 1
  v_exp_f32 v72, v80
  s_nop 1
  v_exp_f32 v24, v81
  s_nop 1
  v_add_f32 v31, v72, v24
  s_nop 1
  v_cvt_pk_bf16_f32 v72, v72, v24
  s_nop 1
  v_exp_f32 v73, v82
  s_nop 1
  v_add_f32 v31, v31, v73
  s_nop 1
  v_exp_f32 v25, v83
  s_nop 1
  v_add_f32 v31, v31, v25
  s_nop 1
  v_cvt_pk_bf16_f32 v73, v73, v25
  s_nop 1
  v_exp_f32 v76, v84
  s_nop 1
  v_add_f32 v31, v31, v76
  s_nop 1
  v_exp_f32 v24, v85
  s_nop 1
  v_add_f32 v31, v31, v24
  s_nop 1
  v_cvt_pk_bf16_f32 v76, v76, v24
  s_nop 1
  v_exp_f32 v77, v86
  s_nop 1
  v_add_f32 v31, v31, v77
  s_nop 1
  v_exp_f32 v25, v87
  s_nop 1
  v_add_f32 v31, v31, v25
  s_nop 1
  v_cvt_pk_bf16_f32 v77, v77, v25
  s_nop 1
  v_exp_f32 v74, v88
  s_nop 1
  v_exp_f32 v24, v89
  s_nop 1
  v_add_f32 v0, v74, v24
  s_nop 1
  v_cvt_pk_bf16_f32 v74, v74, v24
  s_nop 1
  v_permlane16_swap_b32 v72, v74
  s_nop 1
  v_exp_f32 v75, v90
  s_nop 1
  v_add_f32 v0, v0, v75
  s_nop 1
  v_exp_f32 v25, v91
  s_nop 1
  v_add_f32 v0, v0, v25
  s_nop 1
  v_cvt_pk_bf16_f32 v75, v75, v25
  s_nop 1
  v_permlane16_swap_b32 v73, v75
  s_nop 1
  v_exp_f32 v78, v92
  s_nop 1
  v_add_f32 v0, v0, v78
  s_nop 1
  v_exp_f32 v24, v93
  s_nop 1
  v_add_f32 v0, v0, v24
  s_nop 1
  v_cvt_pk_bf16_f32 v78, v78, v24
  s_nop 1
  v_permlane16_swap_b32 v76, v78
  s_nop 1
  v_exp_f32 v79, v94
  s_nop 1
  v_add_f32 v0, v0, v79
  s_nop 1
  v_exp_f32 v25, v95
  s_nop 1
  v_add_f32 v0, v0, v25
  s_nop 1
  v_cvt_pk_bf16_f32 v79, v79, v25
  s_nop 1
  v_permlane16_swap_b32 v77, v79
  s_nop 3
  s_branch RET14
RARE15:
  s_nop 7
  s_nop 7
  v_mul_f32 v128, v128, v28
  v_mul_f32 v129, v129, v28
  v_mul_f32 v130, v130, v28
  v_mul_f32 v131, v131, v28
  v_mul_f32 v132, v132, v28
  v_mul_f32 v133, v133, v28
  v_mul_f32 v134, v134, v28
  v_mul_f32 v135, v135, v28
  v_mul_f32 v136, v136, v28
  v_mul_f32 v137, v137, v28
  v_mul_f32 v138, v138, v28
  v_mul_f32 v139, v139, v28
  v_mul_f32 v140, v140, v28
  v_mul_f32 v141, v141, v28
  v_mul_f32 v142, v142, v28
  v_mul_f32 v143, v143, v28
  v_mul_f32 v144, v144, v28
  v_mul_f32 v145, v145, v28
  v_mul_f32 v146, v146, v28
  v_mul_f32 v147, v147, v28
  v_mul_f32 v148, v148, v28
  v_mul_f32 v149, v149, v28
  v_mul_f32 v150, v150, v28
  v_mul_f32 v151, v151, v28
  v_mul_f32 v152, v152, v28
  v_mul_f32 v153, v153, v28
  v_mul_f32 v154, v154, v28
  v_mul_f32 v155, v155, v28
  v_mul_f32 v156, v156, v28
  v_mul_f32 v157, v157, v28
  v_mul_f32 v158, v158, v28
  v_mul_f32 v159, v159, v28
  v_mul_f32 v160, v160, v28
  v_mul_f32 v161, v161, v28
  v_mul_f32 v162, v162, v28
  v_mul_f32 v163, v163, v28
  v_mul_f32 v164, v164, v28
  v_mul_f32 v165, v165, v28
  v_mul_f32 v166, v166, v28
  v_mul_f32 v167, v167, v28
  v_mul_f32 v168, v168, v28
  v_mul_f32 v169, v169, v28
  v_mul_f32 v170, v170, v28
  v_mul_f32 v171, v171, v28
  v_mul_f32 v172, v172, v28
  v_mul_f32 v173, v173, v28
  v_mul_f32 v174, v174, v28
  v_mul_f32 v175, v175, v28
  v_mul_f32 v176, v176, v28
  v_mul_f32 v177, v177, v28
  v_mul_f32 v178, v178, v28
  v_mul_f32 v179, v179, v28
  v_mul_f32 v180, v180, v28
  v_mul_f32 v181, v181, v28
  v_mul_f32 v182, v182, v28
  v_mul_f32 v183, v183, v28
  v_mul_f32 v184, v184, v28
  v_mul_f32 v185, v185, v28
  v_mul_f32 v186, v186, v28
  v_mul_f32 v187, v187, v28
  v_mul_f32 v188, v188, v28
  v_mul_f32 v189, v189, v28
  v_mul_f32 v190, v190, v28
  v_mul_f32 v191, v191, v28
  v_mul_f32 v192, v192, v28
  v_mul_f32 v193, v193, v28
  v_mul_f32 v194, v194, v28
  v_mul_f32 v195, v195, v28
  v_mul_f32 v196, v196, v28
  v_mul_f32 v197, v197, v28
  v_mul_f32 v198, v198, v28
  v_mul_f32 v199, v199, v28
  v_mul_f32 v200, v200, v28
  v_mul_f32 v201, v201, v28
  v_mul_f32 v202, v202, v28
  v_mul_f32 v203, v203, v28
  v_mul_f32 v204, v204, v28
  v_mul_f32 v205, v205, v28
  v_mul_f32 v206, v206, v28
  v_mul_f32 v207, v207, v28
  v_mul_f32 v208, v208, v28
  v_mul_f32 v209, v209, v28
  v_mul_f32 v210, v210, v28
  v_mul_f32 v211, v211, v28
  v_mul_f32 v212, v212, v28
  v_mul_f32 v213, v213, v28
  v_mul_f32 v214, v214, v28
  v_mul_f32 v215, v215, v28
  v_mul_f32 v216, v216, v28
  v_mul_f32 v217, v217, v28
  v_mul_f32 v218, v218, v28
  v_mul_f32 v219, v219, v28
  v_mul_f32 v220, v220, v28
  v_mul_f32 v221, v221, v28
  v_mul_f32 v222, v222, v28
  v_mul_f32 v223, v223, v28
  v_mul_f32 v224, v224, v28
  v_mul_f32 v225, v225, v28
  v_mul_f32 v226, v226, v28
  v_mul_f32 v227, v227, v28
  v_mul_f32 v228, v228, v28
  v_mul_f32 v229, v229, v28
  v_mul_f32 v230, v230, v28
  v_mul_f32 v231, v231, v28
  v_mul_f32 v232, v232, v28
  v_mul_f32 v233, v233, v28
  v_mul_f32 v234, v234, v28
  v_mul_f32 v235, v235, v28
  v_mul_f32 v236, v236, v28
  v_mul_f32 v237, v237, v28
  v_mul_f32 v238, v238, v28
  v_mul_f32 v239, v239, v28
  v_mul_f32 v240, v240, v28
  v_mul_f32 v241, v241, v28
  v_mul_f32 v242, v242, v28
  v_mul_f32 v243, v243, v28
  v_mul_f32 v244, v244, v28
  v_mul_f32 v245, v245, v28
  v_mul_f32 v246, v246, v28
  v_mul_f32 v247, v247, v28
  v_mul_f32 v248, v248, v28
  v_mul_f32 v249, v249, v28
  v_mul_f32 v250, v250, v28
  v_mul_f32 v251, v251, v28
  v_mul_f32 v252, v252, v28
  v_mul_f32 v253, v253, v28
  v_mul_f32 v254, v254, v28
  v_mul_f32 v255, v255, v28
  s_mov_b32 s26, 0
  s_nop 3
  s_branch RET15
RARE16:
  s_nop 7
  s_nop 7
  v_max3_f32 v29, v112, v113, 0
  v_max3_f32 v29, v29, v114, v115
  v_max3_f32 v29, v29, v116, v117
  v_max3_f32 v29, v29, v118, v119
  v_mov_b32 v30, v29
  s_nop 1
  v_permlane32_swap_b32 v29, v30
  s_nop 1
  v_max_f32 v29, v29, v30
  v_mov_b32 v30, v29
  s_nop 1
  v_permlane16_swap_b32 v29, v30
  s_nop 1
  v_max_f32 v29, v29, v30
  v_add_f32 v12, v12, v29
  v_sub_f32 v112, v112, v29
  v_sub_f32 v113, v113, v29
  v_sub_f32 v114, v114, v29
  v_sub_f32 v115, v115, v29
  v_sub_f32 v116, v116, v29
  v_sub_f32 v117, v117, v29
  v_sub_f32 v118, v118, v29
  v_sub_f32 v119, v119, v29
  v_sub_f32 v31, 0, v29
  v_exp_f32 v31, v31
  s_nop 1
  v_mul_f32 v22, v22, v31
  v_max3_f32 v29, v120, v121, 0
  v_max3_f32 v29, v29, v122, v123
  v_max3_f32 v29, v29, v124, v125
  v_max3_f32 v29, v29, v126, v127
  v_mov_b32 v30, v29
  s_nop 1
  v_permlane32_swap_b32 v29, v30
  s_nop 1
  v_max_f32 v29, v29, v30
  v_mov_b32 v30, v29
  s_nop 1
  v_permlane16_swap_b32 v29, v30
  s_nop 1
  v_max_f32 v29, v29, v30
  v_add_f32 v13, v13, v29
  v_sub_f32 v120, v120, v29
  v_sub_f32 v121, v121, v29
  v_sub_f32 v122, v122, v29
  v_sub_f32 v123, v123, v29
  v_sub_f32 v124, v124, v29
  v_sub_f32 v125, v125, v29
  v_sub_f32 v126, v126, v29
  v_sub_f32 v127, v127, v29
  v_sub_f32 v0, 0, v29
  v_exp_f32 v0, v0
  s_nop 1
  v_mul_f32 v23, v23, v0
  v_cndmask_b32 v29, v31, v0, s[96:97]
  s_nop 1
  v_accvgpr_read_b32 v24, a128
  v_accvgpr_read_b32 v25, a129
  v_mul_f32 v24, v24, v29
  v_mul_f32 v25, v25, v29
  v_accvgpr_write_b32 a128, v24
  v_accvgpr_write_b32 a129, v25
  v_accvgpr_read_b32 v24, a130
  v_accvgpr_read_b32 v25, a131
  v_mul_f32 v24, v24, v29
  v_mul_f32 v25, v25, v29
  v_accvgpr_write_b32 a130, v24
  v_accvgpr_write_b32 a131, v25
  v_accvgpr_read_b32 v24, a132
  v_accvgpr_read_b32 v25, a133
  v_mul_f32 v24, v24, v29
  v_mul_f32 v25, v25, v29
  v_accvgpr_write_b32 a132, v24
  v_accvgpr_write_b32 a133, v25
  v_accvgpr_read_b32 v24, a134
  v_accvgpr_read_b32 v25, a135
  v_mul_f32 v24, v24, v29
  v_mul_f32 v25, v25, v29
  v_accvgpr_write_b32 a134, v24
  v_accvgpr_write_b32 a135, v25
  v_accvgpr_read_b32 v24, a136
  v_accvgpr_read_b32 v25, a137
  v_mul_f32 v24, v24, v29
  v_mul_f32 v25, v25, v29
  v_accvgpr_write_b32 a136, v24
  v_accvgpr_write_b32 a137, v25
  v_accvgpr_read_b32 v24, a138
  v_accvgpr_read_b32 v25, a139
  v_mul_f32 v24, v24, v29
  v_mul_f32 v25, v25, v29
  v_accvgpr_write_b32 a138, v24
  v_accvgpr_write_b32 a139, v25
  v_accvgpr_read_b32 v24, a140
  v_accvgpr_read_b32 v25, a141
  v_mul_f32 v24, v24, v29
  v_mul_f32 v25, v25, v29
  v_accvgpr_write_b32 a140, v24
  v_accvgpr_write_b32 a141, v25
  v_accvgpr_read_b32 v24, a142
  v_accvgpr_read_b32 v25, a143
  v_mul_f32 v24, v24, v29
  v_mul_f32 v25, v25, v29
  v_accvgpr_write_b32 a142, v24
  v_accvgpr_write_b32 a143, v25
  v_accvgpr_read_b32 v24, a144
  v_accvgpr_read_b32 v25, a145
  v_mul_f32 v24, v24, v29
  v_mul_f32 v25, v25, v29
  v_accvgpr_write_b32 a144, v24
  v_accvgpr_write_b32 a145, v25
  v_accvgpr_read_b32 v24, a146
  v_accvgpr_read_b32 v25, a147
  v_mul_f32 v24, v24, v29
  v_mul_f32 v25, v25, v29
  v_accvgpr_write_b32 a146, v24
  v_accvgpr_write_b32 a147, v25
  v_accvgpr_read_b32 v24, a148
  v_accvgpr_read_b32 v25, a149
  v_mul_f32 v24, v24, v29
  v_mul_f32 v25, v25, v29
  v_accvgpr_write_b32 a148, v24
  v_accvgpr_write_b32 a149, v25
  v_accvgpr_read_b32 v24, a150
  v_accvgpr_read_b32 v25, a151
  v_mul_f32 v24, v24, v29
  v_mul_f32 v25, v25, v29
  v_accvgpr_write_b32 a150, v24
  v_accvgpr_write_b32 a151, v25
  v_accvgpr_read_b32 v24, a152
  v_accvgpr_read_b32 v25, a153
  v_mul_f32 v24, v24, v29
  v_mul_f32 v25, v25, v29
  v_accvgpr_write_b32 a152, v24
  v_accvgpr_write_b32 a153, v25
  v_accvgpr_read_b32 v24, a154
  v_accvgpr_read_b32 v25, a155
  v_mul_f32 v24, v24, v29
  v_mul_f32 v25, v25, v29
  v_accvgpr_write_b32 a154, v24
  v_accvgpr_write_b32 a155, v25
  v_accvgpr_read_b32 v24, a156
  v_accvgpr_read_b32 v25, a157
  v_mul_f32 v24, v24, v29
  v_mul_f32 v25, v25, v29
  v_accvgpr_write_b32 a156, v24
  v_accvgpr_write_b32 a157, v25
  v_accvgpr_read_b32 v24, a158
  v_accvgpr_read_b32 v25, a159
  v_mul_f32 v24, v24, v29
  v_mul_f32 v25, v25, v29
  v_accvgpr_write_b32 a158, v24
  v_accvgpr_write_b32 a159, v25
  v_accvgpr_read_b32 v24, a160
  v_accvgpr_read_b32 v25, a161
  v_mul_f32 v24, v24, v29
  v_mul_f32 v25, v25, v29
  v_accvgpr_write_b32 a160, v24
  v_accvgpr_write_b32 a161, v25
  v_accvgpr_read_b32 v24, a162
  v_accvgpr_read_b32 v25, a163
  v_mul_f32 v24, v24, v29
  v_mul_f32 v25, v25, v29
  v_accvgpr_write_b32 a162, v24
  v_accvgpr_write_b32 a163, v25
  v_accvgpr_read_b32 v24, a164
  v_accvgpr_read_b32 v25, a165
  v_mul_f32 v24, v24, v29
  v_mul_f32 v25, v25, v29
  v_accvgpr_write_b32 a164, v24
  v_accvgpr_write_b32 a165, v25
  v_accvgpr_read_b32 v24, a166
  v_accvgpr_read_b32 v25, a167
  v_mul_f32 v24, v24, v29
  v_mul_f32 v25, v25, v29
  v_accvgpr_write_b32 a166, v24
  v_accvgpr_write_b32 a167, v25
  v_accvgpr_read_b32 v24, a168
  v_accvgpr_read_b32 v25, a169
  v_mul_f32 v24, v24, v29
  v_mul_f32 v25, v25, v29
  v_accvgpr_write_b32 a168, v24
  v_accvgpr_write_b32 a169, v25
  v_accvgpr_read_b32 v24, a170
  v_accvgpr_read_b32 v25, a171
  v_mul_f32 v24, v24, v29
  v_mul_f32 v25, v25, v29
  v_accvgpr_write_b32 a170, v24
  v_accvgpr_write_b32 a171, v25
  v_accvgpr_read_b32 v24, a172
  v_accvgpr_read_b32 v25, a173
  v_mul_f32 v24, v24, v29
  v_mul_f32 v25, v25, v29
  v_accvgpr_write_b32 a172, v24
  v_accvgpr_write_b32 a173, v25
  v_accvgpr_read_b32 v24, a174
  v_accvgpr_read_b32 v25, a175
  v_mul_f32 v24, v24, v29
  v_mul_f32 v25, v25, v29
  v_accvgpr_write_b32 a174, v24
  v_accvgpr_write_b32 a175, v25
  v_accvgpr_read_b32 v24, a176
  v_accvgpr_read_b32 v25, a177
  v_mul_f32 v24, v24, v29
  v_mul_f32 v25, v25, v29
  v_accvgpr_write_b32 a176, v24
  v_accvgpr_write_b32 a177, v25
  v_accvgpr_read_b32 v24, a178
  v_accvgpr_read_b32 v25, a179
  v_mul_f32 v24, v24, v29
  v_mul_f32 v25, v25, v29
  v_accvgpr_write_b32 a178, v24
  v_accvgpr_write_b32 a179, v25
  v_accvgpr_read_b32 v24, a180
  v_accvgpr_read_b32 v25, a181
  v_mul_f32 v24, v24, v29
  v_mul_f32 v25, v25, v29
  v_accvgpr_write_b32 a180, v24
  v_accvgpr_write_b32 a181, v25
  v_accvgpr_read_b32 v24, a182
  v_accvgpr_read_b32 v25, a183
  v_mul_f32 v24, v24, v29
  v_mul_f32 v25, v25, v29
  v_accvgpr_write_b32 a182, v24
  v_accvgpr_write_b32 a183, v25
  v_accvgpr_read_b32 v24, a184
  v_accvgpr_read_b32 v25, a185
  v_mul_f32 v24, v24, v29
  v_mul_f32 v25, v25, v29
  v_accvgpr_write_b32 a184, v24
  v_accvgpr_write_b32 a185, v25
  v_accvgpr_read_b32 v24, a186
  v_accvgpr_read_b32 v25, a187
  v_mul_f32 v24, v24, v29
  v_mul_f32 v25, v25, v29
  v_accvgpr_write_b32 a186, v24
  v_accvgpr_write_b32 a187, v25
  v_accvgpr_read_b32 v24, a188
  v_accvgpr_read_b32 v25, a189
  v_mul_f32 v24, v24, v29
  v_mul_f32 v25, v25, v29
  v_accvgpr_write_b32 a188, v24
  v_accvgpr_write_b32 a189, v25
  v_accvgpr_read_b32 v24, a190
  v_accvgpr_read_b32 v25, a191
  v_mul_f32 v24, v24, v29
  v_mul_f32 v25, v25, v29
  v_accvgpr_write_b32 a190, v24
  v_accvgpr_write_b32 a191, v25
  v_accvgpr_read_b32 v24, a192
  v_accvgpr_read_b32 v25, a193
  v_mul_f32 v24, v24, v29
  v_mul_f32 v25, v25, v29
  v_accvgpr_write_b32 a192, v24
  v_accvgpr_write_b32 a193, v25
  v_accvgpr_read_b32 v24, a194
  v_accvgpr_read_b32 v25, a195
  v_mul_f32 v24, v24, v29
  v_mul_f32 v25, v25, v29
  v_accvgpr_write_b32 a194, v24
  v_accvgpr_write_b32 a195, v25
  v_accvgpr_read_b32 v24, a196
  v_accvgpr_read_b32 v25, a197
  v_mul_f32 v24, v24, v29
  v_mul_f32 v25, v25, v29
  v_accvgpr_write_b32 a196, v24
  v_accvgpr_write_b32 a197, v25
  v_accvgpr_read_b32 v24, a198
  v_accvgpr_read_b32 v25, a199
  v_mul_f32 v24, v24, v29
  v_mul_f32 v25, v25, v29
  v_accvgpr_write_b32 a198, v24
  v_accvgpr_write_b32 a199, v25
  v_accvgpr_read_b32 v24, a200
  v_accvgpr_read_b32 v25, a201
  v_mul_f32 v24, v24, v29
  v_mul_f32 v25, v25, v29
  v_accvgpr_write_b32 a200, v24
  v_accvgpr_write_b32 a201, v25
  v_accvgpr_read_b32 v24, a202
  v_accvgpr_read_b32 v25, a203
  v_mul_f32 v24, v24, v29
  v_mul_f32 v25, v25, v29
  v_accvgpr_write_b32 a202, v24
  v_accvgpr_write_b32 a203, v25
  v_accvgpr_read_b32 v24, a204
  v_accvgpr_read_b32 v25, a205
  v_mul_f32 v24, v24, v29
  v_mul_f32 v25, v25, v29
  v_accvgpr_write_b32 a204, v24
  v_accvgpr_write_b32 a205, v25
  v_accvgpr_read_b32 v24, a206
  v_accvgpr_read_b32 v25, a207
  v_mul_f32 v24, v24, v29
  v_mul_f32 v25, v25, v29
  v_accvgpr_write_b32 a206, v24
  v_accvgpr_write_b32 a207, v25
  v_accvgpr_read_b32 v24, a208
  v_accvgpr_read_b32 v25, a209
  v_mul_f32 v24, v24, v29
  v_mul_f32 v25, v25, v29
  v_accvgpr_write_b32 a208, v24
  v_accvgpr_write_b32 a209, v25
  v_accvgpr_read_b32 v24, a210
  v_accvgpr_read_b32 v25, a211
  v_mul_f32 v24, v24, v29
  v_mul_f32 v25, v25, v29
  v_accvgpr_write_b32 a210, v24
  v_accvgpr_write_b32 a211, v25
  v_accvgpr_read_b32 v24, a212
  v_accvgpr_read_b32 v25, a213
  v_mul_f32 v24, v24, v29
  v_mul_f32 v25, v25, v29
  v_accvgpr_write_b32 a212, v24
  v_accvgpr_write_b32 a213, v25
  v_accvgpr_read_b32 v24, a214
  v_accvgpr_read_b32 v25, a215
  v_mul_f32 v24, v24, v29
  v_mul_f32 v25, v25, v29
  v_accvgpr_write_b32 a214, v24
  v_accvgpr_write_b32 a215, v25
  v_accvgpr_read_b32 v24, a216
  v_accvgpr_read_b32 v25, a217
  v_mul_f32 v24, v24, v29
  v_mul_f32 v25, v25, v29
  v_accvgpr_write_b32 a216, v24
  v_accvgpr_write_b32 a217, v25
  v_accvgpr_read_b32 v24, a218
  v_accvgpr_read_b32 v25, a219
  v_mul_f32 v24, v24, v29
  v_mul_f32 v25, v25, v29
  v_accvgpr_write_b32 a218, v24
  v_accvgpr_write_b32 a219, v25
  v_accvgpr_read_b32 v24, a220
  v_accvgpr_read_b32 v25, a221
  v_mul_f32 v24, v24, v29
  v_mul_f32 v25, v25, v29
  v_accvgpr_write_b32 a220, v24
  v_accvgpr_write_b32 a221, v25
  v_accvgpr_read_b32 v24, a222
  v_accvgpr_read_b32 v25, a223
  v_mul_f32 v24, v24, v29
  v_mul_f32 v25, v25, v29
  v_accvgpr_write_b32 a222, v24
  v_accvgpr_write_b32 a223, v25
  v_accvgpr_read_b32 v24, a224
  v_accvgpr_read_b32 v25, a225
  v_mul_f32 v24, v24, v29
  v_mul_f32 v25, v25, v29
  v_accvgpr_write_b32 a224, v24
  v_accvgpr_write_b32 a225, v25
  v_accvgpr_read_b32 v24, a226
  v_accvgpr_read_b32 v25, a227
  v_mul_f32 v24, v24, v29
  v_mul_f32 v25, v25, v29
  v_accvgpr_write_b32 a226, v24
  v_accvgpr_write_b32 a227, v25
  v_accvgpr_read_b32 v24, a228
  v_accvgpr_read_b32 v25, a229
  v_mul_f32 v24, v24, v29
  v_mul_f32 v25, v25, v29
  v_accvgpr_write_b32 a228, v24
  v_accvgpr_write_b32 a229, v25
  v_accvgpr_read_b32 v24, a230
  v_accvgpr_read_b32 v25, a231
  v_mul_f32 v24, v24, v29
  v_mul_f32 v25, v25, v29
  v_accvgpr_write_b32 a230, v24
  v_accvgpr_write_b32 a231, v25
  v_accvgpr_read_b32 v24, a232
  v_accvgpr_read_b32 v25, a233
  v_mul_f32 v24, v24, v29
  v_mul_f32 v25, v25, v29
  v_accvgpr_write_b32 a232, v24
  v_accvgpr_write_b32 a233, v25
  v_accvgpr_read_b32 v24, a234
  v_accvgpr_read_b32 v25, a235
  v_mul_f32 v24, v24, v29
  v_mul_f32 v25, v25, v29
  v_accvgpr_write_b32 a234, v24
  v_accvgpr_write_b32 a235, v25
  v_accvgpr_read_b32 v24, a236
  v_accvgpr_read_b32 v25, a237
  v_mul_f32 v24, v24, v29
  v_mul_f32 v25, v25, v29
  v_accvgpr_write_b32 a236, v24
  v_accvgpr_write_b32 a237, v25
  v_accvgpr_read_b32 v24, a238
  v_accvgpr_read_b32 v25, a239
  v_mul_f32 v24, v24, v29
  v_mul_f32 v25, v25, v29
  v_accvgpr_write_b32 a238, v24
  v_accvgpr_write_b32 a239, v25
  v_accvgpr_read_b32 v24, a240
  v_accvgpr_read_b32 v25, a241
  v_mul_f32 v24, v24, v29
  v_mul_f32 v25, v25, v29
  v_accvgpr_write_b32 a240, v24
  v_accvgpr_write_b32 a241, v25
  v_accvgpr_read_b32 v24, a242
  v_accvgpr_read_b32 v25, a243
  v_mul_f32 v24, v24, v29
  v_mul_f32 v25, v25, v29
  v_accvgpr_write_b32 a242, v24
  v_accvgpr_write_b32 a243, v25
  v_accvgpr_read_b32 v24, a244
  v_accvgpr_read_b32 v25, a245
  v_mul_f32 v24, v24, v29
  v_mul_f32 v25, v25, v29
  v_accvgpr_write_b32 a244, v24
  v_accvgpr_write_b32 a245, v25
  v_accvgpr_read_b32 v24, a246
  v_accvgpr_read_b32 v25, a247
  v_mul_f32 v24, v24, v29
  v_mul_f32 v25, v25, v29
  v_accvgpr_write_b32 a246, v24
  v_accvgpr_write_b32 a247, v25
  v_accvgpr_read_b32 v24, a248
  v_accvgpr_read_b32 v25, a249
  v_mul_f32 v24, v24, v29
  v_mul_f32 v25, v25, v29
  v_accvgpr_write_b32 a248, v24
  v_accvgpr_write_b32 a249, v25
  v_accvgpr_read_b32 v24, a250
  v_accvgpr_read_b32 v25, a251
  v_mul_f32 v24, v24, v29
  v_mul_f32 v25, v25, v29
  v_accvgpr_write_b32 a250, v24
  v_accvgpr_write_b32 a251, v25
  v_accvgpr_read_b32 v24, a252
  v_accvgpr_read_b32 v25, a253
  v_mul_f32 v24, v24, v29
  v_mul_f32 v25, v25, v29
  v_accvgpr_write_b32 a252, v24
  v_accvgpr_write_b32 a253, v25
  v_accvgpr_read_b32 v24, a254
  v_accvgpr_read_b32 v25, a255
  v_mul_f32 v24, v24, v29
  v_mul_f32 v25, v25, v29
  v_accvgpr_write_b32 a254, v24
  v_accvgpr_write_b32 a255, v25
  s_nop 1
  v_exp_f32 v64, v112
  s_nop 1
  v_exp_f32 v24, v113
  s_nop 1
  v_add_f32 v31, v64, v24
  s_nop 1
  v_cvt_pk_bf16_f32 v64, v64, v24
  s_nop 1
  v_exp_f32 v65, v114
  s_nop 1
  v_add_f32 v31, v31, v65
  s_nop 1
  v_exp_f32 v25, v115
  s_nop 1
  v_add_f32 v31, v31, v25
  s_nop 1
  v_cvt_pk_bf16_f32 v65, v65, v25
  s_nop 1
  v_exp_f32 v68, v116
  s_nop 1
  v_add_f32 v31, v31, v68
  s_nop 1
  v_exp_f32 v24, v117
  s_nop 1
  v_add_f32 v31, v31, v24
  s_nop 1
  v_cvt_pk_bf16_f32 v68, v68, v24
  s_nop 1
  v_exp_f32 v69, v118
  s_nop 1
  v_add_f32 v31, v31, v69
  s_nop 1
  v_exp_f32 v25, v119
  s_nop 1
  v_add_f32 v31, v31, v25
  s_nop 1
  v_cvt_pk_bf16_f32 v69, v69, v25
  s_nop 1
  v_exp_f32 v66, v120
  s_nop 1
  v_exp_f32 v24, v121
  s_nop 1
  v_add_f32 v0, v66, v24
  s_nop 1
  v_cvt_pk_bf16_f32 v66, v66, v24
  s_nop 1
  v_permlane16_swap_b32 v64, v66
  s_nop 1
  v_exp_f32 v67, v122
  s_nop 1
  v_add_f32 v0, v0, v67
  s_nop 1
  v_exp_f32 v25, v123
  s_nop 1
  v_add_f32 v0, v0, v25
  s_nop 1
  v_cvt_pk_bf16_f32 v67, v67, v25
  s_nop 1
  v_permlane16_swap_b32 v65, v67
  s_nop 1
  v_exp_f32 v70, v124
  s_nop 1
  v_add_f32 v0, v0, v70
  s_nop 1
  v_exp_f32 v24, v125
  s_nop 1
  v_add_f32 v0, v0, v24
  s_nop 1
  v_cvt_pk_bf16_f32 v70, v70, v24
  s_nop 1
  v_permlane16_swap_b32 v68, v70
  s_nop 1
  v_exp_f32 v71, v126
  s_nop 1
  v_add_f32 v0, v0, v71
  s_nop 1
  v_exp_f32 v25, v127
  s_nop 1
  v_add_f32 v0, v0, v25
  s_nop 1
  v_cvt_pk_bf16_f32 v71, v71, v25
  s_nop 1
  v_permlane16_swap_b32 v69, v71
  s_nop 3
  s_branch RET16
RARE17:
  s_nop 7
  s_nop 7
  v_max3_f32 v29, v96, v97, 0
  v_max3_f32 v29, v29, v98, v99
  v_max3_f32 v29, v29, v100, v101
  v_max3_f32 v29, v29, v102, v103
  v_mov_b32 v30, v29
  s_nop 1
  v_permlane32_swap_b32 v29, v30
  s_nop 1
  v_max_f32 v29, v29, v30
  v_mov_b32 v30, v29
  s_nop 1
  v_permlane16_swap_b32 v29, v30
  s_nop 1
  v_max_f32 v29, v29, v30
  v_add_f32 v10, v10, v29
  v_sub_f32 v96, v96, v29
  v_sub_f32 v97, v97, v29
  v_sub_f32 v98, v98, v29
  v_sub_f32 v99, v99, v29
  v_sub_f32 v100, v100, v29
  v_sub_f32 v101, v101, v29
  v_sub_f32 v102, v102, v29
  v_sub_f32 v103, v103, v29
  v_sub_f32 v31, 0, v29
  v_exp_f32 v31, v31
  s_nop 1
  v_mul_f32 v26, v26, v31
  v_max3_f32 v29, v104, v105, 0
  v_max3_f32 v29, v29, v106, v107
  v_max3_f32 v29, v29, v108, v109
  v_max3_f32 v29, v29, v110, v111
  v_mov_b32 v30, v29
  s_nop 1
  v_permlane32_swap_b32 v29, v30
  s_nop 1
  v_max_f32 v29, v29, v30
  v_mov_b32 v30, v29
  s_nop 1
  v_permlane16_swap_b32 v29, v30
  s_nop 1
  v_max_f32 v29, v29, v30
  v_add_f32 v11, v11, v29
  v_sub_f32 v104, v104, v29
  v_sub_f32 v105, v105, v29
  v_sub_f32 v106, v106, v29
  v_sub_f32 v107, v107, v29
  v_sub_f32 v108, v108, v29
  v_sub_f32 v109, v109, v29
  v_sub_f32 v110, v110, v29
  v_sub_f32 v111, v111, v29
  v_sub_f32 v0, 0, v29
  v_exp_f32 v0, v0
  s_nop 1
  v_mul_f32 v27, v27, v0
  v_cndmask_b32 v29, v31, v0, s[96:97]
  s_nop 1
  v_mov_b32 v28, v29
  s_mov_b32 s26, 1
  s_nop 1
  v_exp_f32 v56, v96
  s_nop 1
  v_exp_f32 v24, v97
  s_nop 1
  v_add_f32 v31, v56, v24
  s_nop 1
  v_cvt_pk_bf16_f32 v56, v56, v24
  s_nop 1
  v_exp_f32 v57, v98
  s_nop 1
  v_add_f32 v31, v31, v57
  s_nop 1
  v_exp_f32 v25, v99
  s_nop 1
  v_add_f32 v31, v31, v25
  s_nop 1
  v_cvt_pk_bf16_f32 v57, v57, v25
  s_nop 1
  v_exp_f32 v60, v100
  s_nop 1
  v_add_f32 v31, v31, v60
  s_nop 1
  v_exp_f32 v24, v101
  s_nop 1
  v_add_f32 v31, v31, v24
  s_nop 1
  v_cvt_pk_bf16_f32 v60, v60, v24
  s_nop 1
  v_exp_f32 v61, v102
  s_nop 1
  v_add_f32 v31, v31, v61
  s_nop 1
  v_exp_f32 v25, v103
  s_nop 1
  v_add_f32 v31, v31, v25
  s_nop 1
  v_cvt_pk_bf16_f32 v61, v61, v25
  s_nop 1
  v_exp_f32 v58, v104
  s_nop 1
  v_exp_f32 v24, v105
  s_nop 1
  v_add_f32 v0, v58, v24
  s_nop 1
  v_cvt_pk_bf16_f32 v58, v58, v24
  s_nop 1
  v_permlane16_swap_b32 v56, v58
  s_nop 1
  v_exp_f32 v59, v106
  s_nop 1
  v_add_f32 v0, v0, v59
  s_nop 1
  v_exp_f32 v25, v107
  s_nop 1
  v_add_f32 v0, v0, v25
  s_nop 1
  v_cvt_pk_bf16_f32 v59, v59, v25
  s_nop 1
  v_permlane16_swap_b32 v57, v59
  s_nop 1
  v_exp_f32 v62, v108
  s_nop 1
  v_add_f32 v0, v0, v62
  s_nop 1
  v_exp_f32 v24, v109
  s_nop 1
  v_add_f32 v0, v0, v24
  s_nop 1
  v_cvt_pk_bf16_f32 v62, v62, v24
  s_nop 1
  v_permlane16_swap_b32 v60, v62
  s_nop 1
  v_exp_f32 v63, v110
  s_nop 1
  v_add_f32 v0, v0, v63
  s_nop 1
  v_exp_f32 v25, v111
  s_nop 1
  v_add_f32 v0, v0, v25
  s_nop 1
  v_cvt_pk_bf16_f32 v63, v63, v25
  s_nop 1
  v_permlane16_swap_b32 v61, v63
  s_nop 3
  s_branch RET17
RARE18:
  s_nop 7
  s_nop 7
  v_mul_f32 v128, v128, v28
  v_mul_f32 v129, v129, v28
  v_mul_f32 v130, v130, v28
  v_mul_f32 v131, v131, v28
  v_mul_f32 v132, v132, v28
  v_mul_f32 v133, v133, v28
  v_mul_f32 v134, v134, v28
  v_mul_f32 v135, v135, v28
  v_mul_f32 v136, v136, v28
  v_mul_f32 v137, v137, v28
  v_mul_f32 v138, v138, v28
  v_mul_f32 v139, v139, v28
  v_mul_f32 v140, v140, v28
  v_mul_f32 v141, v141, v28
  v_mul_f32 v142, v142, v28
  v_mul_f32 v143, v143, v28
  v_mul_f32 v144, v144, v28
  v_mul_f32 v145, v145, v28
  v_mul_f32 v146, v146, v28
  v_mul_f32 v147, v147, v28
  v_mul_f32 v148, v148, v28
  v_mul_f32 v149, v149, v28
  v_mul_f32 v150, v150, v28
  v_mul_f32 v151, v151, v28
  v_mul_f32 v152, v152, v28
  v_mul_f32 v153, v153, v28
  v_mul_f32 v154, v154, v28
  v_mul_f32 v155, v155, v28
  v_mul_f32 v156, v156, v28
  v_mul_f32 v157, v157, v28
  v_mul_f32 v158, v158, v28
  v_mul_f32 v159, v159, v28
  v_mul_f32 v160, v160, v28
  v_mul_f32 v161, v161, v28
  v_mul_f32 v162, v162, v28
  v_mul_f32 v163, v163, v28
  v_mul_f32 v164, v164, v28
  v_mul_f32 v165, v165, v28
  v_mul_f32 v166, v166, v28
  v_mul_f32 v167, v167, v28
  v_mul_f32 v168, v168, v28
  v_mul_f32 v169, v169, v28
  v_mul_f32 v170, v170, v28
  v_mul_f32 v171, v171, v28
  v_mul_f32 v172, v172, v28
  v_mul_f32 v173, v173, v28
  v_mul_f32 v174, v174, v28
  v_mul_f32 v175, v175, v28
  v_mul_f32 v176, v176, v28
  v_mul_f32 v177, v177, v28
  v_mul_f32 v178, v178, v28
  v_mul_f32 v179, v179, v28
  v_mul_f32 v180, v180, v28
  v_mul_f32 v181, v181, v28
  v_mul_f32 v182, v182, v28
  v_mul_f32 v183, v183, v28
  v_mul_f32 v184, v184, v28
  v_mul_f32 v185, v185, v28
  v_mul_f32 v186, v186, v28
  v_mul_f32 v187, v187, v28
  v_mul_f32 v188, v188, v28
  v_mul_f32 v189, v189, v28
  v_mul_f32 v190, v190, v28
  v_mul_f32 v191, v191, v28
  v_mul_f32 v192, v192, v28
  v_mul_f32 v193, v193, v28
  v_mul_f32 v194, v194, v28
  v_mul_f32 v195, v195, v28
  v_mul_f32 v196, v196, v28
  v_mul_f32 v197, v197, v28
  v_mul_f32 v198, v198, v28
  v_mul_f32 v199, v199, v28
  v_mul_f32 v200, v200, v28
  v_mul_f32 v201, v201, v28
  v_mul_f32 v202, v202, v28
  v_mul_f32 v203, v203, v28
  v_mul_f32 v204, v204, v28
  v_mul_f32 v205, v205, v28
  v_mul_f32 v206, v206, v28
  v_mul_f32 v207, v207, v28
  v_mul_f32 v208, v208, v28
  v_mul_f32 v209, v209, v28
  v_mul_f32 v210, v210, v28
  v_mul_f32 v211, v211, v28
  v_mul_f32 v212, v212, v28
  v_mul_f32 v213, v213, v28
  v_mul_f32 v214, v214, v28
  v_mul_f32 v215, v215, v28
  v_mul_f32 v216, v216, v28
  v_mul_f32 v217, v217, v28
  v_mul_f32 v218, v218, v28
  v_mul_f32 v219, v219, v28
  v_mul_f32 v220, v220, v28
  v_mul_f32 v221, v221, v28
  v_mul_f32 v222, v222, v28
  v_mul_f32 v223, v223, v28
  v_mul_f32 v224, v224, v28
  v_mul_f32 v225, v225, v28
  v_mul_f32 v226, v226, v28
  v_mul_f32 v227, v227, v28
  v_mul_f32 v228, v228, v28
  v_mul_f32 v229, v229, v28
  v_mul_f32 v230, v230, v28
  v_mul_f32 v231, v231, v28
  v_mul_f32 v232, v232, v28
  v_mul_f32 v233, v233, v28
  v_mul_f32 v234, v234, v28
  v_mul_f32 v235, v235, v28
  v_mul_f32 v236, v236, v28
  v_mul_f32 v237, v237, v28
  v_mul_f32 v238, v238, v28
  v_mul_f32 v239, v239, v28
  v_mul_f32 v240, v240, v28
  v_mul_f32 v241, v241, v28
  v_mul_f32 v242, v242, v28
  v_mul_f32 v243, v243, v28
  v_mul_f32 v244, v244, v28
  v_mul_f32 v245, v245, v28
  v_mul_f32 v246, v246, v28
  v_mul_f32 v247, v247, v28
  v_mul_f32 v248, v248, v28
  v_mul_f32 v249, v249, v28
  v_mul_f32 v250, v250, v28
  v_mul_f32 v251, v251, v28
  v_mul_f32 v252, v252, v28
  v_mul_f32 v253, v253, v28
  v_mul_f32 v254, v254, v28
  v_mul_f32 v255, v255, v28
  s_mov_b32 s26, 0
  s_nop 3
  s_branch RET18
RARE19:
  s_nop 7
  s_nop 7
  v_max3_f32 v29, v80, v81, 0
  v_max3_f32 v29, v29, v82, v83
  v_max3_f32 v29, v29, v84, v85
  v_max3_f32 v29, v29, v86, v87
  v_mov_b32 v30, v29
  s_nop 1
  v_permlane32_swap_b32 v29, v30
  s_nop 1
  v_max_f32 v29, v29, v30
  v_mov_b32 v30, v29
  s_nop 1
  v_permlane16_swap_b32 v29, v30
  s_nop 1
  v_max_f32 v29, v29, v30
  v_add_f32 v12, v12, v29
  v_sub_f32 v80, v80, v29
  v_sub_f32 v81, v81, v29
  v_sub_f32 v82, v82, v29
  v_sub_f32 v83, v83, v29
  v_sub_f32 v84, v84, v29
  v_sub_f32 v85, v85, v29
  v_sub_f32 v86, v86, v29
  v_sub_f32 v87, v87, v29
  v_sub_f32 v31, 0, v29
  v_exp_f32 v31, v31
  s_nop 1
  v_mul_f32 v22, v22, v31
  v_max3_f32 v29, v88, v89, 0
  v_max3_f32 v29, v29, v90, v91
  v_max3_f32 v29, v29, v92, v93
  v_max3_f32 v29, v29, v94, v95
  v_mov_b32 v30, v29
  s_nop 1
  v_permlane32_swap_b32 v29, v30
  s_nop 1
  v_max_f32 v29, v29, v30
  v_mov_b32 v30, v29
  s_nop 1
  v_permlane16_swap_b32 v29, v30
  s_nop 1
  v_max_f32 v29, v29, v30
  v_add_f32 v13, v13, v29
  v_sub_f32 v88, v88, v29
  v_sub_f32 v89, v89, v29
  v_sub_f32 v90, v90, v29
  v_sub_f32 v91, v91, v29
  v_sub_f32 v92, v92, v29
  v_sub_f32 v93, v93, v29
  v_sub_f32 v94, v94, v29
  v_sub_f32 v95, v95, v29
  v_sub_f32 v0, 0, v29
  v_exp_f32 v0, v0
  s_nop 1
  v_mul_f32 v23, v23, v0
  v_cndmask_b32 v29, v31, v0, s[96:97]
  s_nop 1
  v_accvgpr_read_b32 v24, a128
  v_accvgpr_read_b32 v25, a129
  v_mul_f32 v24, v24, v29
  v_mul_f32 v25, v25, v29
  v_accvgpr_write_b32 a128, v24
  v_accvgpr_write_b32 a129, v25
  v_accvgpr_read_b32 v24, a130
  v_accvgpr_read_b32 v25, a131
  v_mul_f32 v24, v24, v29
  v_mul_f32 v25, v25, v29
  v_accvgpr_write_b32 a130, v24
  v_accvgpr_write_b32 a131, v25
  v_accvgpr_read_b32 v24, a132
  v_accvgpr_read_b32 v25, a133
  v_mul_f32 v24, v24, v29
  v_mul_f32 v25, v25, v29
  v_accvgpr_write_b32 a132, v24
  v_accvgpr_write_b32 a133, v25
  v_accvgpr_read_b32 v24, a134
  v_accvgpr_read_b32 v25, a135
  v_mul_f32 v24, v24, v29
  v_mul_f32 v25, v25, v29
  v_accvgpr_write_b32 a134, v24
  v_accvgpr_write_b32 a135, v25
  v_accvgpr_read_b32 v24, a136
  v_accvgpr_read_b32 v25, a137
  v_mul_f32 v24, v24, v29
  v_mul_f32 v25, v25, v29
  v_accvgpr_write_b32 a136, v24
  v_accvgpr_write_b32 a137, v25
  v_accvgpr_read_b32 v24, a138
  v_accvgpr_read_b32 v25, a139
  v_mul_f32 v24, v24, v29
  v_mul_f32 v25, v25, v29
  v_accvgpr_write_b32 a138, v24
  v_accvgpr_write_b32 a139, v25
  v_accvgpr_read_b32 v24, a140
  v_accvgpr_read_b32 v25, a141
  v_mul_f32 v24, v24, v29
  v_mul_f32 v25, v25, v29
  v_accvgpr_write_b32 a140, v24
  v_accvgpr_write_b32 a141, v25
  v_accvgpr_read_b32 v24, a142
  v_accvgpr_read_b32 v25, a143
  v_mul_f32 v24, v24, v29
  v_mul_f32 v25, v25, v29
  v_accvgpr_write_b32 a142, v24
  v_accvgpr_write_b32 a143, v25
  v_accvgpr_read_b32 v24, a144
  v_accvgpr_read_b32 v25, a145
  v_mul_f32 v24, v24, v29
  v_mul_f32 v25, v25, v29
  v_accvgpr_write_b32 a144, v24
  v_accvgpr_write_b32 a145, v25
  v_accvgpr_read_b32 v24, a146
  v_accvgpr_read_b32 v25, a147
  v_mul_f32 v24, v24, v29
  v_mul_f32 v25, v25, v29
  v_accvgpr_write_b32 a146, v24
  v_accvgpr_write_b32 a147, v25
  v_accvgpr_read_b32 v24, a148
  v_accvgpr_read_b32 v25, a149
  v_mul_f32 v24, v24, v29
  v_mul_f32 v25, v25, v29
  v_accvgpr_write_b32 a148, v24
  v_accvgpr_write_b32 a149, v25
  v_accvgpr_read_b32 v24, a150
  v_accvgpr_read_b32 v25, a151
  v_mul_f32 v24, v24, v29
  v_mul_f32 v25, v25, v29
  v_accvgpr_write_b32 a150, v24
  v_accvgpr_write_b32 a151, v25
  v_accvgpr_read_b32 v24, a152
  v_accvgpr_read_b32 v25, a153
  v_mul_f32 v24, v24, v29
  v_mul_f32 v25, v25, v29
  v_accvgpr_write_b32 a152, v24
  v_accvgpr_write_b32 a153, v25
  v_accvgpr_read_b32 v24, a154
  v_accvgpr_read_b32 v25, a155
  v_mul_f32 v24, v24, v29
  v_mul_f32 v25, v25, v29
  v_accvgpr_write_b32 a154, v24
  v_accvgpr_write_b32 a155, v25
  v_accvgpr_read_b32 v24, a156
  v_accvgpr_read_b32 v25, a157
  v_mul_f32 v24, v24, v29
  v_mul_f32 v25, v25, v29
  v_accvgpr_write_b32 a156, v24
  v_accvgpr_write_b32 a157, v25
  v_accvgpr_read_b32 v24, a158
  v_accvgpr_read_b32 v25, a159
  v_mul_f32 v24, v24, v29
  v_mul_f32 v25, v25, v29
  v_accvgpr_write_b32 a158, v24
  v_accvgpr_write_b32 a159, v25
  v_accvgpr_read_b32 v24, a160
  v_accvgpr_read_b32 v25, a161
  v_mul_f32 v24, v24, v29
  v_mul_f32 v25, v25, v29
  v_accvgpr_write_b32 a160, v24
  v_accvgpr_write_b32 a161, v25
  v_accvgpr_read_b32 v24, a162
  v_accvgpr_read_b32 v25, a163
  v_mul_f32 v24, v24, v29
  v_mul_f32 v25, v25, v29
  v_accvgpr_write_b32 a162, v24
  v_accvgpr_write_b32 a163, v25
  v_accvgpr_read_b32 v24, a164
  v_accvgpr_read_b32 v25, a165
  v_mul_f32 v24, v24, v29
  v_mul_f32 v25, v25, v29
  v_accvgpr_write_b32 a164, v24
  v_accvgpr_write_b32 a165, v25
  v_accvgpr_read_b32 v24, a166
  v_accvgpr_read_b32 v25, a167
  v_mul_f32 v24, v24, v29
  v_mul_f32 v25, v25, v29
  v_accvgpr_write_b32 a166, v24
  v_accvgpr_write_b32 a167, v25
  v_accvgpr_read_b32 v24, a168
  v_accvgpr_read_b32 v25, a169
  v_mul_f32 v24, v24, v29
  v_mul_f32 v25, v25, v29
  v_accvgpr_write_b32 a168, v24
  v_accvgpr_write_b32 a169, v25
  v_accvgpr_read_b32 v24, a170
  v_accvgpr_read_b32 v25, a171
  v_mul_f32 v24, v24, v29
  v_mul_f32 v25, v25, v29
  v_accvgpr_write_b32 a170, v24
  v_accvgpr_write_b32 a171, v25
  v_accvgpr_read_b32 v24, a172
  v_accvgpr_read_b32 v25, a173
  v_mul_f32 v24, v24, v29
  v_mul_f32 v25, v25, v29
  v_accvgpr_write_b32 a172, v24
  v_accvgpr_write_b32 a173, v25
  v_accvgpr_read_b32 v24, a174
  v_accvgpr_read_b32 v25, a175
  v_mul_f32 v24, v24, v29
  v_mul_f32 v25, v25, v29
  v_accvgpr_write_b32 a174, v24
  v_accvgpr_write_b32 a175, v25
  v_accvgpr_read_b32 v24, a176
  v_accvgpr_read_b32 v25, a177
  v_mul_f32 v24, v24, v29
  v_mul_f32 v25, v25, v29
  v_accvgpr_write_b32 a176, v24
  v_accvgpr_write_b32 a177, v25
  v_accvgpr_read_b32 v24, a178
  v_accvgpr_read_b32 v25, a179
  v_mul_f32 v24, v24, v29
  v_mul_f32 v25, v25, v29
  v_accvgpr_write_b32 a178, v24
  v_accvgpr_write_b32 a179, v25
  v_accvgpr_read_b32 v24, a180
  v_accvgpr_read_b32 v25, a181
  v_mul_f32 v24, v24, v29
  v_mul_f32 v25, v25, v29
  v_accvgpr_write_b32 a180, v24
  v_accvgpr_write_b32 a181, v25
  v_accvgpr_read_b32 v24, a182
  v_accvgpr_read_b32 v25, a183
  v_mul_f32 v24, v24, v29
  v_mul_f32 v25, v25, v29
  v_accvgpr_write_b32 a182, v24
  v_accvgpr_write_b32 a183, v25
  v_accvgpr_read_b32 v24, a184
  v_accvgpr_read_b32 v25, a185
  v_mul_f32 v24, v24, v29
  v_mul_f32 v25, v25, v29
  v_accvgpr_write_b32 a184, v24
  v_accvgpr_write_b32 a185, v25
  v_accvgpr_read_b32 v24, a186
  v_accvgpr_read_b32 v25, a187
  v_mul_f32 v24, v24, v29
  v_mul_f32 v25, v25, v29
  v_accvgpr_write_b32 a186, v24
  v_accvgpr_write_b32 a187, v25
  v_accvgpr_read_b32 v24, a188
  v_accvgpr_read_b32 v25, a189
  v_mul_f32 v24, v24, v29
  v_mul_f32 v25, v25, v29
  v_accvgpr_write_b32 a188, v24
  v_accvgpr_write_b32 a189, v25
  v_accvgpr_read_b32 v24, a190
  v_accvgpr_read_b32 v25, a191
  v_mul_f32 v24, v24, v29
  v_mul_f32 v25, v25, v29
  v_accvgpr_write_b32 a190, v24
  v_accvgpr_write_b32 a191, v25
  v_accvgpr_read_b32 v24, a192
  v_accvgpr_read_b32 v25, a193
  v_mul_f32 v24, v24, v29
  v_mul_f32 v25, v25, v29
  v_accvgpr_write_b32 a192, v24
  v_accvgpr_write_b32 a193, v25
  v_accvgpr_read_b32 v24, a194
  v_accvgpr_read_b32 v25, a195
  v_mul_f32 v24, v24, v29
  v_mul_f32 v25, v25, v29
  v_accvgpr_write_b32 a194, v24
  v_accvgpr_write_b32 a195, v25
  v_accvgpr_read_b32 v24, a196
  v_accvgpr_read_b32 v25, a197
  v_mul_f32 v24, v24, v29
  v_mul_f32 v25, v25, v29
  v_accvgpr_write_b32 a196, v24
  v_accvgpr_write_b32 a197, v25
  v_accvgpr_read_b32 v24, a198
  v_accvgpr_read_b32 v25, a199
  v_mul_f32 v24, v24, v29
  v_mul_f32 v25, v25, v29
  v_accvgpr_write_b32 a198, v24
  v_accvgpr_write_b32 a199, v25
  v_accvgpr_read_b32 v24, a200
  v_accvgpr_read_b32 v25, a201
  v_mul_f32 v24, v24, v29
  v_mul_f32 v25, v25, v29
  v_accvgpr_write_b32 a200, v24
  v_accvgpr_write_b32 a201, v25
  v_accvgpr_read_b32 v24, a202
  v_accvgpr_read_b32 v25, a203
  v_mul_f32 v24, v24, v29
  v_mul_f32 v25, v25, v29
  v_accvgpr_write_b32 a202, v24
  v_accvgpr_write_b32 a203, v25
  v_accvgpr_read_b32 v24, a204
  v_accvgpr_read_b32 v25, a205
  v_mul_f32 v24, v24, v29
  v_mul_f32 v25, v25, v29
  v_accvgpr_write_b32 a204, v24
  v_accvgpr_write_b32 a205, v25
  v_accvgpr_read_b32 v24, a206
  v_accvgpr_read_b32 v25, a207
  v_mul_f32 v24, v24, v29
  v_mul_f32 v25, v25, v29
  v_accvgpr_write_b32 a206, v24
  v_accvgpr_write_b32 a207, v25
  v_accvgpr_read_b32 v24, a208
  v_accvgpr_read_b32 v25, a209
  v_mul_f32 v24, v24, v29
  v_mul_f32 v25, v25, v29
  v_accvgpr_write_b32 a208, v24
  v_accvgpr_write_b32 a209, v25
  v_accvgpr_read_b32 v24, a210
  v_accvgpr_read_b32 v25, a211
  v_mul_f32 v24, v24, v29
  v_mul_f32 v25, v25, v29
  v_accvgpr_write_b32 a210, v24
  v_accvgpr_write_b32 a211, v25
  v_accvgpr_read_b32 v24, a212
  v_accvgpr_read_b32 v25, a213
  v_mul_f32 v24, v24, v29
  v_mul_f32 v25, v25, v29
  v_accvgpr_write_b32 a212, v24
  v_accvgpr_write_b32 a213, v25
  v_accvgpr_read_b32 v24, a214
  v_accvgpr_read_b32 v25, a215
  v_mul_f32 v24, v24, v29
  v_mul_f32 v25, v25, v29
  v_accvgpr_write_b32 a214, v24
  v_accvgpr_write_b32 a215, v25
  v_accvgpr_read_b32 v24, a216
  v_accvgpr_read_b32 v25, a217
  v_mul_f32 v24, v24, v29
  v_mul_f32 v25, v25, v29
  v_accvgpr_write_b32 a216, v24
  v_accvgpr_write_b32 a217, v25
  v_accvgpr_read_b32 v24, a218
  v_accvgpr_read_b32 v25, a219
  v_mul_f32 v24, v24, v29
  v_mul_f32 v25, v25, v29
  v_accvgpr_write_b32 a218, v24
  v_accvgpr_write_b32 a219, v25
  v_accvgpr_read_b32 v24, a220
  v_accvgpr_read_b32 v25, a221
  v_mul_f32 v24, v24, v29
  v_mul_f32 v25, v25, v29
  v_accvgpr_write_b32 a220, v24
  v_accvgpr_write_b32 a221, v25
  v_accvgpr_read_b32 v24, a222
  v_accvgpr_read_b32 v25, a223
  v_mul_f32 v24, v24, v29
  v_mul_f32 v25, v25, v29
  v_accvgpr_write_b32 a222, v24
  v_accvgpr_write_b32 a223, v25
  v_accvgpr_read_b32 v24, a224
  v_accvgpr_read_b32 v25, a225
  v_mul_f32 v24, v24, v29
  v_mul_f32 v25, v25, v29
  v_accvgpr_write_b32 a224, v24
  v_accvgpr_write_b32 a225, v25
  v_accvgpr_read_b32 v24, a226
  v_accvgpr_read_b32 v25, a227
  v_mul_f32 v24, v24, v29
  v_mul_f32 v25, v25, v29
  v_accvgpr_write_b32 a226, v24
  v_accvgpr_write_b32 a227, v25
  v_accvgpr_read_b32 v24, a228
  v_accvgpr_read_b32 v25, a229
  v_mul_f32 v24, v24, v29
  v_mul_f32 v25, v25, v29
  v_accvgpr_write_b32 a228, v24
  v_accvgpr_write_b32 a229, v25
  v_accvgpr_read_b32 v24, a230
  v_accvgpr_read_b32 v25, a231
  v_mul_f32 v24, v24, v29
  v_mul_f32 v25, v25, v29
  v_accvgpr_write_b32 a230, v24
  v_accvgpr_write_b32 a231, v25
  v_accvgpr_read_b32 v24, a232
  v_accvgpr_read_b32 v25, a233
  v_mul_f32 v24, v24, v29
  v_mul_f32 v25, v25, v29
  v_accvgpr_write_b32 a232, v24
  v_accvgpr_write_b32 a233, v25
  v_accvgpr_read_b32 v24, a234
  v_accvgpr_read_b32 v25, a235
  v_mul_f32 v24, v24, v29
  v_mul_f32 v25, v25, v29
  v_accvgpr_write_b32 a234, v24
  v_accvgpr_write_b32 a235, v25
  v_accvgpr_read_b32 v24, a236
  v_accvgpr_read_b32 v25, a237
  v_mul_f32 v24, v24, v29
  v_mul_f32 v25, v25, v29
  v_accvgpr_write_b32 a236, v24
  v_accvgpr_write_b32 a237, v25
  v_accvgpr_read_b32 v24, a238
  v_accvgpr_read_b32 v25, a239
  v_mul_f32 v24, v24, v29
  v_mul_f32 v25, v25, v29
  v_accvgpr_write_b32 a238, v24
  v_accvgpr_write_b32 a239, v25
  v_accvgpr_read_b32 v24, a240
  v_accvgpr_read_b32 v25, a241
  v_mul_f32 v24, v24, v29
  v_mul_f32 v25, v25, v29
  v_accvgpr_write_b32 a240, v24
  v_accvgpr_write_b32 a241, v25
  v_accvgpr_read_b32 v24, a242
  v_accvgpr_read_b32 v25, a243
  v_mul_f32 v24, v24, v29
  v_mul_f32 v25, v25, v29
  v_accvgpr_write_b32 a242, v24
  v_accvgpr_write_b32 a243, v25
  v_accvgpr_read_b32 v24, a244
  v_accvgpr_read_b32 v25, a245
  v_mul_f32 v24, v24, v29
  v_mul_f32 v25, v25, v29
  v_accvgpr_write_b32 a244, v24
  v_accvgpr_write_b32 a245, v25
  v_accvgpr_read_b32 v24, a246
  v_accvgpr_read_b32 v25, a247
  v_mul_f32 v24, v24, v29
  v_mul_f32 v25, v25, v29
  v_accvgpr_write_b32 a246, v24
  v_accvgpr_write_b32 a247, v25
  v_accvgpr_read_b32 v24, a248
  v_accvgpr_read_b32 v25, a249
  v_mul_f32 v24, v24, v29
  v_mul_f32 v25, v25, v29
  v_accvgpr_write_b32 a248, v24
  v_accvgpr_write_b32 a249, v25
  v_accvgpr_read_b32 v24, a250
  v_accvgpr_read_b32 v25, a251
  v_mul_f32 v24, v24, v29
  v_mul_f32 v25, v25, v29
  v_accvgpr_write_b32 a250, v24
  v_accvgpr_write_b32 a251, v25
  v_accvgpr_read_b32 v24, a252
  v_accvgpr_read_b32 v25, a253
  v_mul_f32 v24, v24, v29
  v_mul_f32 v25, v25, v29
  v_accvgpr_write_b32 a252, v24
  v_accvgpr_write_b32 a253, v25
  v_accvgpr_read_b32 v24, a254
  v_accvgpr_read_b32 v25, a255
  v_mul_f32 v24, v24, v29
  v_mul_f32 v25, v25, v29
  v_accvgpr_write_b32 a254, v24
  v_accvgpr_write_b32 a255, v25
  s_nop 1
  v_exp_f32 v72, v80
  s_nop 1
  v_exp_f32 v24, v81
  s_nop 1
  v_add_f32 v31, v72, v24
  s_nop 1
  v_cvt_pk_bf16_f32 v72, v72, v24
  s_nop 1
  v_exp_f32 v73, v82
  s_nop 1
  v_add_f32 v31, v31, v73
  s_nop 1
  v_exp_f32 v25, v83
  s_nop 1
  v_add_f32 v31, v31, v25
  s_nop 1
  v_cvt_pk_bf16_f32 v73, v73, v25
  s_nop 1
  v_exp_f32 v76, v84
  s_nop 1
  v_add_f32 v31, v31, v76
  s_nop 1
  v_exp_f32 v24, v85
  s_nop 1
  v_add_f32 v31, v31, v24
  s_nop 1
  v_cvt_pk_bf16_f32 v76, v76, v24
  s_nop 1
  v_exp_f32 v77, v86
  s_nop 1
  v_add_f32 v31, v31, v77
  s_nop 1
  v_exp_f32 v25, v87
  s_nop 1
  v_add_f32 v31, v31, v25
  s_nop 1
  v_cvt_pk_bf16_f32 v77, v77, v25
  s_nop 1
  v_exp_f32 v74, v88
  s_nop 1
  v_exp_f32 v24, v89
  s_nop 1
  v_add_f32 v0, v74, v24
  s_nop 1
  v_cvt_pk_bf16_f32 v74, v74, v24
  s_nop 1
  v_permlane16_swap_b32 v72, v74
  s_nop 1
  v_exp_f32 v75, v90
  s_nop 1
  v_add_f32 v0, v0, v75
  s_nop 1
  v_exp_f32 v25, v91
  s_nop 1
  v_add_f32 v0, v0, v25
  s_nop 1
  v_cvt_pk_bf16_f32 v75, v75, v25
  s_nop 1
  v_permlane16_swap_b32 v73, v75
  s_nop 1
  v_exp_f32 v78, v92
  s_nop 1
  v_add_f32 v0, v0, v78
  s_nop 1
  v_exp_f32 v24, v93
  s_nop 1
  v_add_f32 v0, v0, v24
  s_nop 1
  v_cvt_pk_bf16_f32 v78, v78, v24
  s_nop 1
  v_permlane16_swap_b32 v76, v78
  s_nop 1
  v_exp_f32 v79, v94
  s_nop 1
  v_add_f32 v0, v0, v79
  s_nop 1
  v_exp_f32 v25, v95
  s_nop 1
  v_add_f32 v0, v0, v25
  s_nop 1
  v_cvt_pk_bf16_f32 v79, v79, v25
  s_nop 1
  v_permlane16_swap_b32 v77, v79
  s_nop 3
  s_branch RET19
.section .rodata,"a"
.p2align 6
.amdhsa_kernel standalone__mha_softmax__near_ridge_kernel
  .amdhsa_next_free_vgpr 512
  .amdhsa_next_free_sgpr 102
  .amdhsa_accum_offset 256
  .amdhsa_group_segment_fixed_size 0
  .amdhsa_kernarg_size 48
  .amdhsa_user_sgpr_count 2
  .amdhsa_user_sgpr_kernarg_segment_ptr 1
  .amdhsa_system_sgpr_workgroup_id_x 1
.end_amdhsa_kernel
```
